```python
import torch

def _softmax(x, axis=-1):
    return torch.softmax(x, dim=axis)
def _gelu(x):
    return torch.nn.functional.gelu(x, approximate="tanh")
def _silu(x):
    return torch.nn.functional.silu(x)
def _sigmoid(x):
    return torch.sigmoid(x)
def _layernorm(x, axis=-1, eps=1e-5):
    m = x.mean(dim=axis, keepdim=True)
    v = x.var(dim=axis, keepdim=True, unbiased=False)
    return (x - m) / torch.sqrt(v + eps)
def _scatter_add(tgt, idx, src, axis=0):
    return tgt.clone().index_add_(axis, idx, src)
def _segment_sum(src, seg, n):
    out = torch.zeros((n,) + src.shape[1:], dtype=src.dtype)
    return out.index_add_(0, seg, src)
def _pad(x, pw):
    flat = tuple(v for pair in reversed(pw) for v in pair)
    return torch.nn.functional.pad(x, flat)

kernel_name = 'standalone__swiglu_ffn__prompt'

def setup_inputs():

    _w = (lambda a: (lambda t: t.to(torch.bfloat16) if t.is_floating_point() else t)(torch.as_tensor(a)))
    B, S, D, F = 1, 2048, 1024, 3584
    return {
        "x": _w((lambda *s: torch.randn(*s, dtype=torch.bfloat16) * 0.05)(B, S, D)),
        "w_gate": _w((lambda *s: torch.randn(*s, dtype=torch.bfloat16) * 0.05)(D, F)),
        "w_up": _w((lambda *s: torch.randn(*s, dtype=torch.bfloat16) * 0.05)(D, F)),
        "w_down": _w((lambda *s: torch.randn(*s, dtype=torch.bfloat16) * 0.05)(F, D)),
    }

def reference(x, w_gate, w_up, w_down):
    g = _silu(x @ w_gate)
    u = x @ w_up
    return (g * u) @ w_down
```

```asm
; @launch grid=(256,1,1) block=(256,1,1) lds=163840
.amdgcn_target "amdgcn-amd-amdhsa--gfx950"
.text
.globl standalone__swiglu_ffn__prompt_kernel
.p2align 8
.type standalone__swiglu_ffn__prompt_kernel,@function
standalone__swiglu_ffn__prompt_kernel:
    s_load_dwordx8 s[80:87], s[0:1], 0
    s_load_dwordx4 s[88:91], s[0:1], 32
    s_load_dwordx2 s[32:33], s[0:1], 48
    s_cmp_ge_u32 s2, 256
    s_cbranch_scc1 L_end
    v_lshrrev_b32 v2, 6, v0
    v_and_b32 v0, 63, v0
    v_readfirstlane_b32 s40, v2
    s_and_b32 s41, s2, 1
    s_bfe_u32 s42, s2, 0x20001
    s_bfe_u32 s43, s2, 0x20003
    s_lshr_b32 s44, s2, 5
    s_xor_b32 s45, s41, s42
    s_and_b32 s45, s45, 1
    s_lshl2_add_u32 s45, s45, s43
    v_lshrrev_b32 v25, 3, v0
    v_lshrrev_b32 v26, 4, v0
    v_and_b32 v27, 7, v0
    v_xor_b32 v23, v27, v26
    v_lshlrev_b32 v25, 11, v25
    v_lshl_add_u32 v1, v23, 4, v25
    v_xor_b32 v2, 64, v1
    s_lshr_b32 s58, s44, 1
    s_add_u32 s58, s58, s43
    s_and_b32 s58, s58, 3
    s_lshl2_add_u32 s58, s41, s58
    s_lshl_b32 s68, s58, 2
    s_lshr_b32 s72, 0xccdc0010, s68
    s_and_b32 s72, s72, 15
    s_lshl_b32 s73, s72, 7
    s_lshl2_add_u32 s69, s45, s40
    s_lshl_b32 s69, s69, 17
    s_mov_b32 s10, 129152
    s_mov_b32 s11, 0x20000
    s_lshl_b32 s56, s40, 14
    s_mov_b32 m0, s56
    s_mov_b32 s48, 0
    s_mov_b32 s49, 15360
    s_mov_b32 s50, 30720
    s_mov_b32 s51, 46080
    s_getpc_b64 s[4:5]
L_pc:
    s_lshr_b32 s62, s2, 3
    s_lshl2_add_u32 s62, s62, s40
    s_lshl_b32 s62, s62, 9
    v_min_u32 v31, 3, v0
    v_lshl_add_u32 v31, v31, 7, s62
    v_min_u32 v31, L_end-L_pc, v31
    global_load_dword v21, v31, s[4:5]
    v_lshlrev_b32 v18, 4, v0
    v_mul_u32_u24 v22, 4682, v0
    s_movk_i32 s59, 14112
    s_movk_i32 s60, -7168
    v_lshrrev_b32 v23, 16, v22
    v_and_b32 v24, 3, v23
    v_mad_u32_u24 v23, v23, s59, v18
    v_mad_i32_i24 v5, v24, s60, v23
    v_add_u32 v22, 299648, v22
    v_lshrrev_b32 v23, 16, v22
    v_and_b32 v24, 3, v23
    v_mad_u32_u24 v23, v23, s59, v18
    v_mad_i32_i24 v6, v24, s60, v23
    v_add_u32 v22, 299648, v22
    v_lshrrev_b32 v23, 16, v22
    v_and_b32 v24, 3, v23
    v_mad_u32_u24 v23, v23, s59, v18
    v_mad_i32_i24 v7, v24, s60, v23
    v_add_u32 v22, 299648, v22
    v_lshrrev_b32 v23, 16, v22
    v_and_b32 v24, 3, v23
    v_mad_u32_u24 v23, v23, s59, v18
    v_mad_i32_i24 v8, v24, s60, v23
    s_lshl3_add_u32 s46, s42, s44
    s_mul_i32 s72, s72, 458752
    s_lshr_b32 s68, s40, 1
    s_mul_i32 s68, s68, 28672
    s_mul_i32 s61, s46, 224
    s_add_u32 s68, s68, s61
    s_mov_b32 s14, 7311360
    s_mov_b32 s15, 0x20000
    s_mul_i32 s57, s40, 7168
    s_waitcnt lgkmcnt(0)
    s_add_u32 s6, s80, s69
    s_addc_u32 s7, s81, 0
    s_add_u32 s8, s6, s73
    s_addc_u32 s9, s7, 0
    buffer_load_dwordx4 v1, s[8:11], s48 offen offset:0 lds
    buffer_load_dwordx4 v2, s[8:11], s49 offen offset:1024 lds
    buffer_load_dwordx4 v1, s[8:11], s50 offen offset:2048 lds
    buffer_load_dwordx4 v2, s[8:11], s51 offen offset:3072 lds
    s_bitcmp1_b32 s40, 0
    s_cselect_b32 s12, s84, s82
    s_cselect_b32 s13, s85, s83
    s_add_u32 s12, s12, s68
    s_addc_u32 s13, s13, 0
    s_add_u32 m0, s57, 65536
    s_nop 0
    buffer_load_dwordx4 v5, s[12:15], s72 offen offset:0 lds
    buffer_load_dwordx4 v6, s[12:15], s72 offen offset:1024 lds
    buffer_load_dwordx4 v7, s[12:15], s72 offen offset:2048 lds
    buffer_load_dwordx4 v8, s[12:15], s72 offen offset:3072 lds
    s_mov_b32 s52, 65536
    s_mov_b32 s53, 80896
    s_mov_b32 s54, 96256
    s_mov_b32 s55, 111616
    s_add_u32 m0, s56, 4096
    s_nop 0
    buffer_load_dwordx4 v1, s[8:11], s52 offen offset:0 lds
    buffer_load_dwordx4 v2, s[8:11], s53 offen offset:1024 lds
    buffer_load_dwordx4 v1, s[8:11], s54 offen offset:2048 lds
    buffer_load_dwordx4 v2, s[8:11], s55 offen offset:3072 lds
    s_mov_b32 s70, 0x86534210
    s_mov_b32 s71, 0xfedcba97
    s_cmp_eq_u32 s58, 1
    s_cselect_b32 s70, 0x76453201, s70
    s_cselect_b32 s71, 0xfedcba89, s71
    s_cmp_eq_u32 s58, 2
    s_cselect_b32 s70, 0x75643120, s70
    s_cselect_b32 s71, 0xfedcb9a8, s71
    s_cmp_eq_u32 s58, 3
    s_cselect_b32 s70, 0x67542310, s70
    s_cselect_b32 s71, 0xfedcab98, s71
    s_cmp_eq_u32 s58, 4
    s_cselect_b32 s70, 0x3210fedc, s70
    s_cselect_b32 s71, 0xba987654, s71
    s_cmp_eq_u32 s58, 5
    s_cselect_b32 s70, 0x3210fecd, s70
    s_cselect_b32 s71, 0xba987654, s71
    s_cmp_eq_u32 s58, 6
    s_cselect_b32 s70, 0x3210fdec, s70
    s_cselect_b32 s71, 0xba987654, s71
    s_cmp_eq_u32 s58, 7
    s_cselect_b32 s70, 0x3210efdc, s70
    s_cselect_b32 s71, 0xba987654, s71
    v_add_u32 v28, 4096, v18
    v_add_u32 v22, 299648, v22
    v_lshrrev_b32 v23, 16, v22
    v_and_b32 v24, 3, v23
    v_mad_u32_u24 v23, v23, s59, v28
    v_mad_i32_i24 v9, v24, s60, v23
    v_add_u32 v22, 299648, v22
    v_lshrrev_b32 v23, 16, v22
    v_and_b32 v24, 3, v23
    v_mad_u32_u24 v23, v23, s59, v28
    v_mad_i32_i24 v10, v24, s60, v23
    v_add_u32 v22, 299648, v22
    v_lshrrev_b32 v23, 16, v22
    v_and_b32 v24, 3, v23
    v_mad_u32_u24 v23, v23, s59, v28
    v_mad_i32_i24 v11, v24, s60, v23
    s_lshl3_add_u32 s47, s41, s44
    s_and_b32 s68, s42, 1
    s_lshl2_add_u32 s68, s68, s43
    s_lshr_b32 s41, s42, 1
    s_xor_b32 s41, s41, 1
    s_and_b32 s69, s40, 1
    s_lshl1_add_u32 s3, s68, s69
    s_lshr_b32 s68, s40, 1
    s_lshl1_add_u32 s67, s41, s68
    s_lshr_b32 s42, s46, 3
    s_and_b32 s44, s46, 7
    s_lshl_b32 s0, s68, 14
    s_bfe_u32 s92, s47, 0x20002
    s_xor_b32 s74, s92, 0
    s_mul_i32 s74, s74, 229376
    s_xor_b32 s75, s92, 1
    s_mul_i32 s75, s75, 229376
    s_xor_b32 s76, s92, 2
    s_mul_i32 s76, s76, 229376
    s_xor_b32 s77, s92, 3
    s_mul_i32 s77, s77, 229376
    s_xor_b32 s61, s92, s69
    s_and_b32 s61, s61, 1
    s_lshl_b32 s61, s61, 10
    v_add_u32 v29, s61, v18
    s_and_b32 s92, s92, 2
    s_lshl_b32 s92, s92, 13
    s_xor_b32 s93, s92, 16384
    s_lshl_b32 s69, s69, 10
    v_add_u32 v28, s0, v18
    s_add_u32 s0, s0, s69
    v_lshlrev_b32 v23, 1, v26
    v_xor_b32 v23, v27, v23
    v_lshl_add_u32 v13, v23, 4, v25
    v_and_b32 v22, 15, v0
    v_lshrrev_b32 v24, 1, v22
    v_xor_b32 v24, v24, v26
    v_lshlrev_b32 v24, 4, v24
    v_lshl_add_u32 v24, v22, 7, v24
    v_add_u32 v3, s56, v24
    v_xor_b32 v4, 64, v3
    v_lshlrev_b32 v20, 2, v22
    v_lshrrev_b32 v24, 2, v0
    v_and_b32 v25, 3, v0
    v_mul_u32_u24 v26, 224, v24
    v_lshl_add_u32 v26, v25, 3, v26
    v_add_u32 v12, 65536, v26
    v_add_u32 v30, 131072, v26
    v_lshlrev_b32 v26, 7, v24
    v_lshl_add_u32 v26, v25, 3, v26
    v_add_u32 v26, s56, v26
    v_bfe_u32 v27, v0, 3, 2
    v_lshl_add_u32 v14, v27, 5, v26
    v_xor_b32 v15, 32, v14
    v_xor_b32 v16, 64, v14
    v_xor_b32 v17, 96, v14
    v_lshrrev_b32 v24, 5, v0
    v_and_b32 v25, 31, v0
    v_lshlrev_b32 v25, 4, v25
    v_lshl_add_u32 v19, v24, 10, v25
    s_mov_b32 s34, 8192
    s_mov_b32 s35, 0x20000
    s_lshr_b32 s68, s40, 1
    s_lshl1_add_u32 s68, s45, s68
    s_lshl2_add_u32 s69, s68, s42
    s_lshl_b32 s63, s69, 7
    s_and_b32 s59, s40, 1
    s_lshl1_add_u32 s60, s44, s59
    s_lshl2_add_u32 s63, s60, s63
    s_cmp_eq_u32 s2, 0
    s_cbranch_scc1 L_clear
L_cleared:
    s_lshl2_add_u32 s68, s2, s40
    s_lshr_b32 s69, s68, 5
    s_mul_i32 s69, s69, 56
    s_and_b32 s68, s68, 31
    s_add_u32 s68, s68, s69
    s_add_u32 s68, s68, 24
    s_lshl_b32 s68, s68, 12
    v_min_u32 v22, 7, v0
    v_lshl_add_u32 v22, v22, 7, s68
    s_mov_b32 s4, s86
    s_mov_b32 s5, s87
    s_mul_i32 s68, s67, 1835008
    s_lshl_b32 s69, s3, 7
    s_add_u32 s68, s68, s69
    s_add_u32 s16, s86, s68
    s_addc_u32 s17, s87, 0
    s_mov_b32 s18, 1833088
    s_mov_b32 s19, 0x20000
    s_lshr_b32 s68, s63, 7
    s_mul_i32 s68, s68, 229376
    s_add_u32 s68, s68, 1048576
    s_add_u32 s20, s32, s68
    s_addc_u32 s21, s33, 0
    s_mov_b32 s22, 229376
    s_mov_b32 s23, 0x20000
    s_lshl2_add_u32 s68, s47, s67
    s_lshl_b32 s64, s68, 7
    s_mul_i32 s68, s68, 229376
    s_add_u32 s68, s68, 1046528
    s_add_u32 s24, s32, s68
    s_addc_u32 s25, s33, 0
    s_mov_b32 s26, 231424
    s_mov_b32 s27, 0x20000
    s_lshl_b32 s68, s59, 1
    s_xor_b32 s68, s68, s42
    s_xor_b32 s68, s68, 3
    s_xor_b32 s69, s68, 1
    s_lshl_b32 s68, s68, 11
    s_lshl_b32 s69, s69, 11
    s_add_u32 s59, s44, 4
    s_lshl_b32 s59, s59, 13
    s_add_u32 s60, s59, s69
    s_add_u32 s59, s59, s68
    s_lshr_b32 s61, s44, 1
    s_lshl_b32 s61, s61, 13
    s_and_b32 s62, s44, 1
    s_lshl_b32 s62, s62, 9
    s_add_u32 s61, s61, s62
    s_add_u32 s62, s61, s69
    s_add_u32 s61, s61, s68
    s_lshl2_add_u32 s68, s47, s67
    s_lshl_b32 s68, s68, 16
    s_lshl_b32 s69, s3, 7
    s_add_u32 s68, s68, s69
    s_add_u32 s28, s88, s68
    s_addc_u32 s29, s89, 0
    s_mov_b32 s30, 63616
    s_mov_b32 s31, 0x20000
    s_mov_b32 s36, s90
    s_mov_b32 s37, s91
    s_mov_b32 s38, 256
    s_mov_b32 s39, 0x20000
    s_or_b32 s65, s2, s40
    s_mov_b32 s66, 0xbfb8aa3b
    s_lshl2_add_u32 s42, s3, s64
    s_add_u32 s42, s42, 64
    s_xor_b32 s43, s42, 256
    s_lshr_b32 s68, s64, 3
    s_add_u32 s68, s68, s3
    s_lshl_b32 s1, s68, 13
    s_xor_b32 s41, s1, 262144
    s_mov_b64 vcc, 1
    s_cmp_eq_u32 s40, 0
    s_cbranch_scc1 L_pad0
    s_cmp_eq_u32 s40, 1
    s_cbranch_scc1 L_pad1
    s_cmp_eq_u32 s40, 2
    s_cbranch_scc1 L_pad2
    s_branch L_pad3
L_warm:
    s_mov_b64 vcc, 0
    s_add_u32 m0, s57, 69632
    s_nop 0
    buffer_load_dwordx4 v9, s[12:15], s72 offen offset:0 lds
    buffer_load_dwordx4 v10, s[12:15], s72 offen offset:1024 lds
    buffer_load_dwordx4 v11, s[12:15], s72 offen offset:2048 lds
    s_add_u32 m0, s56, 8192
    s_bfe_u32 s73, s70, 0x40004
    s_lshl_b32 s73, s73, 7
    s_add_u32 s8, s6, s73
    s_addc_u32 s9, s7, 0
    buffer_load_dwordx4 v1, s[8:11], s48 offen offset:0 lds
    buffer_load_dwordx4 v2, s[8:11], s49 offen offset:1024 lds
    s_branch L_main
L_clear:
    v_mov_b32 v24, 0
    v_mov_b32 v25, 0
    v_mov_b32 v26, 0
    v_mov_b32 v27, 0
    s_lshl_b32 s68, s40, 11
    buffer_store_dwordx4 v[24:27], v18, s[32:35], s68 offen sc1
    buffer_store_dwordx4 v[24:27], v18, s[32:35], s68 offen offset:1024 sc1
    s_branch L_cleared
L_announce:
    v_mov_b32 v21, 1
    s_mov_b64 exec, 1
    buffer_store_dword v21, off, s[36:39], 0 sc1
    s_mov_b64 exec, -1
    s_branch L_announced
L_slow_cnt:
    s_mov_b32 s67, 0
L_spin_cnt:
    buffer_load_dword v21, off, s[36:39], 0 sc1
    s_add_u32 s67, s67, 1
    s_cmp_gt_u32 s67, 0x40000
    s_cbranch_scc1 L_end
    s_waitcnt vmcnt(0)
    v_cmp_gt_u32 vcc, 1, v21
    s_cbranch_vccnz L_spin_cnt
    s_branch L_back_cnt
L_slow_f1:
    s_mov_b32 s67, 0
L_spin_f1:
    buffer_load_dword v21, v20, s[32:35], s64 offen sc1
    s_add_u32 s67, s67, 1
    s_cmp_gt_u32 s67, 0x40000
    s_cbranch_scc1 L_end
    s_waitcnt vmcnt(0)
    v_cmp_gt_u32 vcc, 1, v21
    s_cbranch_vccnz L_spin_f1
    s_branch L_back_f1
L_slow_f2:
    s_mov_b32 s67, 0
L_spin_f2:
    buffer_load_dword v21, v20, s[32:35], s64 offen sc1
    s_add_u32 s67, s67, 1
    s_cmp_gt_u32 s67, 0x40000
    s_cbranch_scc1 L_end
    s_waitcnt vmcnt(0)
    v_cmp_gt_u32 vcc, 2, v21
    s_cbranch_vccnz L_spin_f2
    s_branch L_back_f2
L_slow_f4:
    s_mov_b32 s67, 0
L_spin_f4:
    buffer_load_dword v21, v20, s[32:35], s64 offen sc1
    s_add_u32 s67, s67, 1
    s_cmp_gt_u32 s67, 0x40000
    s_cbranch_scc1 L_end
    s_waitcnt vmcnt(0)
    v_cmp_gt_u32 vcc, 4, v21
    s_cbranch_vccnz L_spin_f4
    s_branch L_back_f4
L_slow_fx0:
    s_mov_b32 s67, 0
L_spin_fx0:
    buffer_load_dword v21, off, s[32:35], s43 sc1
    s_add_u32 s67, s67, 1
    s_cmp_gt_u32 s67, 0x40000
    s_cbranch_scc1 L_end
    s_waitcnt vmcnt(0)
    v_cmp_gt_u32 vcc, 1, v21
    s_cbranch_vccnz L_spin_fx0
    s_branch L_back_fx0
L_slow_fx1:
    s_mov_b32 s67, 0
L_spin_fx1:
    buffer_load_dword v21, off, s[32:35], s43 sc1
    s_add_u32 s67, s67, 1
    s_cmp_gt_u32 s67, 0x40000
    s_cbranch_scc1 L_end
    s_waitcnt vmcnt(0)
    v_cmp_gt_u32 vcc, 2, v21
    s_cbranch_vccnz L_spin_fx1
    s_branch L_back_fx1
    .p2align 12
L_main:
L_pad0:
    s_cbranch_vccnz L_pad4
    s_waitcnt vmcnt(9)
    s_barrier
    ds_read_b64_tr_b16 a[64:65], v12 offset:0
    ds_read_b64_tr_b16 a[66:67], v12 offset:14336
    ds_read_b64_tr_b16 a[68:69], v12 offset:7168
    ds_read_b64_tr_b16 a[70:71], v12 offset:21504
    ds_read_b128 a[0:3], v3 offset:0
    ds_read_b128 a[4:7], v3 offset:2048
    s_waitcnt vmcnt(7)
    ds_read_b128 a[8:11], v3 offset:4096
    s_waitcnt vmcnt(5)
    ds_read_b128 a[12:15], v3 offset:6144
    ds_read_b64_tr_b16 a[72:73], v12 offset:32
    ds_read_b64_tr_b16 a[74:75], v12 offset:14368
    s_waitcnt lgkmcnt(5)
    v_mfma_f32_16x16x32_bf16 v[32:35], a[64:67], a[0:3], 0
    s_waitcnt lgkmcnt(4)
    ds_read_b64_tr_b16 a[76:77], v12 offset:7200
    v_mfma_f32_16x16x32_bf16 v[36:39], a[64:67], a[4:7], 0
    s_waitcnt lgkmcnt(4)
    buffer_load_dwordx4 v1, s[8:11], s50 offen offset:2048 lds
    v_mfma_f32_16x16x32_bf16 v[40:43], a[64:67], a[8:11], 0
    s_waitcnt lgkmcnt(3)
    ds_read_b128 a[16:19], v4 offset:0
    v_mfma_f32_16x16x32_bf16 v[44:47], a[64:67], a[12:15], 0
    ds_read_b64_tr_b16 a[78:79], v12 offset:21536
    v_mfma_f32_16x16x32_bf16 v[60:63], a[68:71], a[12:15], 0
    ds_read_b64_tr_b16 a[80:81], v12 offset:64
    v_mfma_f32_16x16x32_bf16 v[56:59], a[68:71], a[8:11], 0
    ds_read_b128 a[20:23], v4 offset:2048
    v_mfma_f32_16x16x32_bf16 v[52:55], a[68:71], a[4:7], 0
    buffer_load_dwordx4 v2, s[8:11], s51 offen offset:3072 lds
    v_mfma_f32_16x16x32_bf16 v[48:51], a[68:71], a[0:3], 0
    s_waitcnt lgkmcnt(5)
    ds_read_b64_tr_b16 a[82:83], v12 offset:14400
    v_mfma_f32_16x16x32_bf16 v[64:67], a[72:75], a[0:3], 0
    ds_read_b128 a[24:27], v4 offset:4096
    v_mfma_f32_16x16x32_bf16 v[68:71], a[72:75], a[4:7], 0
    ds_read_b64_tr_b16 a[84:85], v12 offset:7232
    v_mfma_f32_16x16x32_bf16 v[72:75], a[72:75], a[8:11], 0
    s_mov_b32 m0, s56
    ds_read_b64_tr_b16 a[86:87], v12 offset:21568
    v_mfma_f32_16x16x32_bf16 v[76:79], a[72:75], a[12:15], 0
    s_waitcnt lgkmcnt(6)
    ds_read_b128 a[28:31], v4 offset:6144
    s_waitcnt lgkmcnt(5)
    v_mfma_f32_16x16x32_bf16 v[92:95], a[76:79], a[12:15], 0
    buffer_load_dwordx4 v1, s[8:11], s52 offen offset:0 lds
    v_mfma_f32_16x16x32_bf16 v[88:91], a[76:79], a[8:11], 0
    ds_read_b64_tr_b16 a[248:249], v12 offset:96
    v_mfma_f32_16x16x32_bf16 v[84:87], a[76:79], a[4:7], 0
    ds_read_b64_tr_b16 a[250:251], v12 offset:14432
    v_mfma_f32_16x16x32_bf16 v[80:83], a[76:79], a[0:3], 0
    s_waitcnt lgkmcnt(6)
    ds_read_b64_tr_b16 a[252:253], v12 offset:7264
    v_mfma_f32_16x16x32_bf16 v[96:99], a[80:83], a[0:3], 0
    ds_read_b64_tr_b16 a[254:255], v12 offset:21600
    v_mfma_f32_16x16x32_bf16 v[100:103], a[80:83], a[4:7], 0
    ds_read_b64_tr_b16 a[64:65], v12 offset:128
    v_mfma_f32_16x16x32_bf16 v[104:107], a[80:83], a[8:11], 0
    buffer_load_dwordx4 v2, s[8:11], s53 offen offset:1024 lds
    v_mfma_f32_16x16x32_bf16 v[108:111], a[80:83], a[12:15], 0
    s_waitcnt lgkmcnt(6)
    ds_read_b64_tr_b16 a[66:67], v12 offset:14464
    v_mfma_f32_16x16x32_bf16 v[124:127], a[84:87], a[12:15], 0
    ds_read_b64_tr_b16 a[68:69], v12 offset:7296
    v_mfma_f32_16x16x32_bf16 v[120:123], a[84:87], a[8:11], 0
    ds_read_b64_tr_b16 a[70:71], v12 offset:21632
    v_mfma_f32_16x16x32_bf16 v[116:119], a[84:87], a[4:7], 0
    ds_read_b64_tr_b16 a[72:73], v12 offset:160
    v_mfma_f32_16x16x32_bf16 v[112:115], a[84:87], a[0:3], 0
    s_waitcnt lgkmcnt(7)
    ds_read_b64_tr_b16 a[74:75], v12 offset:14496
    v_mfma_f32_16x16x32_bf16 v[128:131], a[248:251], a[0:3], 0
    buffer_load_dwordx4 v1, s[8:11], s54 offen offset:2048 lds
    v_mfma_f32_16x16x32_bf16 v[132:135], a[248:251], a[4:7], 0
    ds_read_b64_tr_b16 a[76:77], v12 offset:7328
    v_mfma_f32_16x16x32_bf16 v[136:139], a[248:251], a[8:11], 0
    ds_read_b64_tr_b16 a[78:79], v12 offset:21664
    v_mfma_f32_16x16x32_bf16 v[140:143], a[248:251], a[12:15], 0
    s_waitcnt lgkmcnt(8)
    v_mfma_f32_16x16x32_bf16 v[156:159], a[252:255], a[12:15], 0
    ds_read_b64_tr_b16 a[80:81], v12 offset:192
    v_mfma_f32_16x16x32_bf16 v[152:155], a[252:255], a[8:11], 0
    ds_read_b64_tr_b16 a[82:83], v12 offset:14528
    v_mfma_f32_16x16x32_bf16 v[148:151], a[252:255], a[4:7], 0
    buffer_load_dwordx4 v2, s[8:11], s55 offen offset:3072 lds
    v_mfma_f32_16x16x32_bf16 v[144:147], a[252:255], a[0:3], 0
    s_waitcnt lgkmcnt(8)
    s_add_u32 m0, s57, 131072
    v_mfma_f32_16x16x32_bf16 v[160:163], a[64:67], a[0:3], 0
    s_bfe_u32 s72, s70, 0x40004
    ds_read_b64_tr_b16 a[84:85], v12 offset:7360
    v_mfma_f32_16x16x32_bf16 v[164:167], a[64:67], a[4:7], 0
    s_mul_i32 s72, s72, 458752
    ds_read_b64_tr_b16 a[86:87], v12 offset:21696
    v_mfma_f32_16x16x32_bf16 v[168:171], a[64:67], a[8:11], 0
    v_mfma_f32_16x16x32_bf16 v[172:175], a[64:67], a[12:15], 0
    s_waitcnt lgkmcnt(8)
    buffer_load_dwordx4 v5, s[12:15], s72 offen offset:0 lds
    v_mfma_f32_16x16x32_bf16 v[188:191], a[68:71], a[12:15], 0
    v_mfma_f32_16x16x32_bf16 v[184:187], a[68:71], a[8:11], 0
    v_mfma_f32_16x16x32_bf16 v[180:183], a[68:71], a[4:7], 0
    v_mfma_f32_16x16x32_bf16 v[176:179], a[68:71], a[0:3], 0
    s_waitcnt lgkmcnt(6)
    v_mfma_f32_16x16x32_bf16 v[192:195], a[72:75], a[0:3], 0
    v_mfma_f32_16x16x32_bf16 v[196:199], a[72:75], a[4:7], 0
    buffer_load_dwordx4 v6, s[12:15], s72 offen offset:1024 lds
    v_mfma_f32_16x16x32_bf16 v[200:203], a[72:75], a[8:11], 0
    s_waitcnt vmcnt(10) lgkmcnt(0)
    v_mfma_f32_16x16x32_bf16 v[204:207], a[72:75], a[12:15], 0
    s_barrier
    v_mfma_f32_16x16x32_bf16 v[220:223], a[76:79], a[12:15], 0
    ds_read_b64_tr_b16 a[248:249], v12 offset:3584
    v_mfma_f32_16x16x32_bf16 v[216:219], a[76:79], a[8:11], 0
    ds_read_b64_tr_b16 a[250:251], v12 offset:17920
    v_mfma_f32_16x16x32_bf16 v[212:215], a[76:79], a[4:7], 0
    ds_read_b64_tr_b16 a[252:253], v12 offset:10752
    v_mfma_f32_16x16x32_bf16 v[208:211], a[76:79], a[0:3], 0
    buffer_load_dwordx4 v7, s[12:15], s72 offen offset:2048 lds
    v_mfma_f32_16x16x32_bf16 v[224:227], a[80:83], a[0:3], 0
    ds_read_b64_tr_b16 a[254:255], v12 offset:25088
    v_mfma_f32_16x16x32_bf16 v[228:231], a[80:83], a[4:7], 0
    ds_read_b64_tr_b16 a[64:65], v12 offset:3616
    v_mfma_f32_16x16x32_bf16 v[232:235], a[80:83], a[8:11], 0
    ds_read_b64_tr_b16 a[66:67], v12 offset:17952
    v_mfma_f32_16x16x32_bf16 v[236:239], a[80:83], a[12:15], 0
    ds_read_b64_tr_b16 a[68:69], v12 offset:10784
    v_mfma_f32_16x16x32_bf16 v[252:255], a[84:87], a[12:15], 0
    ds_read_b64_tr_b16 a[70:71], v12 offset:25120
    v_mfma_f32_16x16x32_bf16 v[248:251], a[84:87], a[8:11], 0
    buffer_load_dwordx4 v8, s[12:15], s72 offen offset:3072 lds
    v_mfma_f32_16x16x32_bf16 v[244:247], a[84:87], a[4:7], 0
    ds_read_b64_tr_b16 a[72:73], v12 offset:3648
    v_mfma_f32_16x16x32_bf16 v[240:243], a[84:87], a[0:3], 0
    s_waitcnt lgkmcnt(7)
    ds_read_b64_tr_b16 a[74:75], v12 offset:17984
    v_mfma_f32_16x16x32_bf16 v[32:35], a[248:251], a[16:19], v[32:35]
    s_add_u32 m0, s57, 135168
    ds_read_b64_tr_b16 a[76:77], v12 offset:10816
    v_mfma_f32_16x16x32_bf16 v[36:39], a[248:251], a[20:23], v[36:39]
    ds_read_b64_tr_b16 a[78:79], v12 offset:25152
    v_mfma_f32_16x16x32_bf16 v[40:43], a[248:251], a[24:27], v[40:43]
    buffer_load_dwordx4 v9, s[12:15], s72 offen offset:0 lds
    v_mfma_f32_16x16x32_bf16 v[44:47], a[248:251], a[28:31], v[44:47]
    s_waitcnt lgkmcnt(8)
    v_mfma_f32_16x16x32_bf16 v[60:63], a[252:255], a[28:31], v[60:63]
    ds_read_b64_tr_b16 a[80:81], v12 offset:3680
    v_mfma_f32_16x16x32_bf16 v[56:59], a[252:255], a[24:27], v[56:59]
    ds_read_b64_tr_b16 a[82:83], v12 offset:18016
    v_mfma_f32_16x16x32_bf16 v[52:55], a[252:255], a[20:23], v[52:55]
    v_mfma_f32_16x16x32_bf16 v[48:51], a[252:255], a[16:19], v[48:51]
    s_waitcnt lgkmcnt(8)
    v_mfma_f32_16x16x32_bf16 v[64:67], a[64:67], a[16:19], v[64:67]
    buffer_load_dwordx4 v10, s[12:15], s72 offen offset:1024 lds
    v_mfma_f32_16x16x32_bf16 v[68:71], a[64:67], a[20:23], v[68:71]
    ds_read_b64_tr_b16 a[84:85], v12 offset:10848
    v_mfma_f32_16x16x32_bf16 v[72:75], a[64:67], a[24:27], v[72:75]
    ds_read_b64_tr_b16 a[86:87], v12 offset:25184
    v_mfma_f32_16x16x32_bf16 v[76:79], a[64:67], a[28:31], v[76:79]
    s_waitcnt lgkmcnt(8)
    v_mfma_f32_16x16x32_bf16 v[92:95], a[68:71], a[28:31], v[92:95]
    ds_read_b64_tr_b16 a[248:249], v12 offset:3712
    v_mfma_f32_16x16x32_bf16 v[88:91], a[68:71], a[24:27], v[88:91]
    ds_read_b64_tr_b16 a[250:251], v12 offset:18048
    v_mfma_f32_16x16x32_bf16 v[84:87], a[68:71], a[20:23], v[84:87]
    buffer_load_dwordx4 v11, s[12:15], s72 offen offset:2048 lds
    v_mfma_f32_16x16x32_bf16 v[80:83], a[68:71], a[16:19], v[80:83]
    s_waitcnt lgkmcnt(8)
    s_add_u32 m0, s56, 4096
    v_mfma_f32_16x16x32_bf16 v[96:99], a[72:75], a[16:19], v[96:99]
    s_bfe_u32 s73, s70, 0x40008
    ds_read_b64_tr_b16 a[252:253], v12 offset:10880
    v_mfma_f32_16x16x32_bf16 v[100:103], a[72:75], a[20:23], v[100:103]
    s_waitcnt vmcnt(11)
    ds_read_b64_tr_b16 a[254:255], v12 offset:25216
    s_lshl_b32 s73, s73, 7
    v_mfma_f32_16x16x32_bf16 v[104:107], a[72:75], a[24:27], v[104:107]
    s_add_u32 s8, s6, s73
    s_addc_u32 s9, s7, 0
    ds_read_b128 a[32:35], v3 offset:8192
    v_mfma_f32_16x16x32_bf16 v[108:111], a[72:75], a[28:31], v[108:111]
    s_waitcnt lgkmcnt(9)
    ds_read_b128 a[48:51], v4 offset:8192
    v_mfma_f32_16x16x32_bf16 v[124:127], a[76:79], a[28:31], v[124:127]
    buffer_load_dwordx4 v1, s[8:11], s48 offen offset:0 lds
    v_mfma_f32_16x16x32_bf16 v[120:123], a[76:79], a[24:27], v[120:123]
    ds_read_b128 a[36:39], v3 offset:10240
    v_mfma_f32_16x16x32_bf16 v[116:119], a[76:79], a[20:23], v[116:119]
    ds_read_b128 a[52:55], v4 offset:10240
    v_mfma_f32_16x16x32_bf16 v[112:115], a[76:79], a[16:19], v[112:115]
    s_waitcnt lgkmcnt(10)
    ds_read_b64_tr_b16 a[64:65], v12 offset:3744
    v_mfma_f32_16x16x32_bf16 v[128:131], a[80:83], a[16:19], v[128:131]
    ds_read_b64_tr_b16 a[66:67], v12 offset:18080
    v_mfma_f32_16x16x32_bf16 v[132:135], a[80:83], a[20:23], v[132:135]
    ds_read_b64_tr_b16 a[68:69], v12 offset:10912
    v_mfma_f32_16x16x32_bf16 v[136:139], a[80:83], a[24:27], v[136:139]
    buffer_load_dwordx4 v2, s[8:11], s49 offen offset:1024 lds
    v_mfma_f32_16x16x32_bf16 v[140:143], a[80:83], a[28:31], v[140:143]
    s_waitcnt lgkmcnt(11)
    ds_read_b64_tr_b16 a[70:71], v12 offset:25248
    v_mfma_f32_16x16x32_bf16 v[156:159], a[84:87], a[28:31], v[156:159]
    ds_read_b64_tr_b16 a[72:73], v12 offset:3776
    v_mfma_f32_16x16x32_bf16 v[152:155], a[84:87], a[24:27], v[152:155]
    ds_read_b64_tr_b16 a[74:75], v12 offset:18112
    v_mfma_f32_16x16x32_bf16 v[148:151], a[84:87], a[20:23], v[148:151]
    v_mfma_f32_16x16x32_bf16 v[144:147], a[84:87], a[16:19], v[144:147]
    s_waitcnt lgkmcnt(12)
    buffer_load_dwordx4 v1, s[8:11], s50 offen offset:2048 lds
    v_mfma_f32_16x16x32_bf16 v[160:163], a[248:251], a[16:19], v[160:163]
    ds_read_b64_tr_b16 a[76:77], v12 offset:10944
    v_mfma_f32_16x16x32_bf16 v[164:167], a[248:251], a[20:23], v[164:167]
    s_waitcnt vmcnt(10)
    ds_read_b64_tr_b16 a[78:79], v12 offset:25280
    v_mfma_f32_16x16x32_bf16 v[168:171], a[248:251], a[24:27], v[168:171]
    ds_read_b128 a[40:43], v3 offset:0
    v_mfma_f32_16x16x32_bf16 v[172:175], a[248:251], a[28:31], v[172:175]
    s_waitcnt lgkmcnt(13)
    ds_read_b128 a[56:59], v4 offset:0
    v_mfma_f32_16x16x32_bf16 v[188:191], a[252:255], a[28:31], v[188:191]
    ds_read_b128 a[44:47], v3 offset:2048
    v_mfma_f32_16x16x32_bf16 v[184:187], a[252:255], a[24:27], v[184:187]
    buffer_load_dwordx4 v2, s[8:11], s51 offen offset:3072 lds
    v_mfma_f32_16x16x32_bf16 v[180:183], a[252:255], a[20:23], v[180:183]
    ds_read_b128 a[60:63], v4 offset:2048
    v_mfma_f32_16x16x32_bf16 v[176:179], a[252:255], a[16:19], v[176:179]
    s_waitcnt lgkmcnt(10)
    v_mfma_f32_16x16x32_bf16 v[192:195], a[64:67], a[16:19], v[192:195]
    v_mfma_f32_16x16x32_bf16 v[196:199], a[64:67], a[20:23], v[196:199]
    s_add_u32 m0, s56, 8192
    v_mfma_f32_16x16x32_bf16 v[200:203], a[64:67], a[24:27], v[200:203]
    s_waitcnt vmcnt(4) lgkmcnt(4)
    v_mfma_f32_16x16x32_bf16 v[204:207], a[64:67], a[28:31], v[204:207]
    s_barrier
    buffer_load_dwordx4 v1, s[8:11], s52 offen offset:0 lds
    v_mfma_f32_16x16x32_bf16 v[220:223], a[68:71], a[28:31], v[220:223]
    ds_read_b64_tr_b16 a[80:81], v30 offset:0
    v_mfma_f32_16x16x32_bf16 v[216:219], a[68:71], a[24:27], v[216:219]
    ds_read_b64_tr_b16 a[82:83], v30 offset:14336
    v_mfma_f32_16x16x32_bf16 v[212:215], a[68:71], a[20:23], v[212:215]
    ds_read_b64_tr_b16 a[84:85], v30 offset:3584
    v_mfma_f32_16x16x32_bf16 v[208:211], a[68:71], a[16:19], v[208:211]
    ds_read_b64_tr_b16 a[86:87], v30 offset:17920
    v_mfma_f32_16x16x32_bf16 v[224:227], a[72:75], a[16:19], v[224:227]
    ds_read_b64_tr_b16 a[248:249], v30 offset:7168
    v_mfma_f32_16x16x32_bf16 v[228:231], a[72:75], a[20:23], v[228:231]
    buffer_load_dwordx4 v2, s[8:11], s53 offen offset:1024 lds
    v_mfma_f32_16x16x32_bf16 v[232:235], a[72:75], a[24:27], v[232:235]
    ds_read_b64_tr_b16 a[250:251], v30 offset:21504
    v_mfma_f32_16x16x32_bf16 v[236:239], a[72:75], a[28:31], v[236:239]
    ds_read_b64_tr_b16 a[252:253], v30 offset:10752
    v_mfma_f32_16x16x32_bf16 v[252:255], a[76:79], a[28:31], v[252:255]
    ds_read_b64_tr_b16 a[254:255], v30 offset:25088
    v_mfma_f32_16x16x32_bf16 v[248:251], a[76:79], a[24:27], v[248:251]
    ds_read_b64_tr_b16 a[64:65], v30 offset:32
    v_mfma_f32_16x16x32_bf16 v[244:247], a[76:79], a[20:23], v[244:247]
    ds_read_b64_tr_b16 a[66:67], v30 offset:14368
    v_mfma_f32_16x16x32_bf16 v[240:243], a[76:79], a[16:19], v[240:243]
    s_waitcnt lgkmcnt(8)
    buffer_load_dwordx4 v1, s[8:11], s54 offen offset:2048 lds
    v_mfma_f32_16x16x32_bf16 v[32:35], a[80:83], a[32:35], v[32:35]
    s_waitcnt lgkmcnt(6)
    ds_read_b64_tr_b16 a[68:69], v30 offset:3616
    v_mfma_f32_16x16x32_bf16 v[32:35], a[84:87], a[48:51], v[32:35]
    ds_read_b64_tr_b16 a[70:71], v30 offset:17952
    v_mfma_f32_16x16x32_bf16 v[36:39], a[84:87], a[52:55], v[36:39]
    v_mfma_f32_16x16x32_bf16 v[36:39], a[80:83], a[36:39], v[36:39]
    v_mfma_f32_16x16x32_bf16 v[40:43], a[80:83], a[40:43], v[40:43]
    buffer_load_dwordx4 v2, s[8:11], s55 offen offset:3072 lds
    v_mfma_f32_16x16x32_bf16 v[40:43], a[84:87], a[56:59], v[40:43]
    ds_read_b64_tr_b16 a[72:73], v30 offset:7200
    v_mfma_f32_16x16x32_bf16 v[44:47], a[84:87], a[60:63], v[44:47]
    s_add_u32 m0, s57, 94208
    ds_read_b64_tr_b16 a[74:75], v30 offset:21536
    v_mfma_f32_16x16x32_bf16 v[44:47], a[80:83], a[44:47], v[44:47]
    s_waitcnt lgkmcnt(8)
    ds_read_b64_tr_b16 a[76:77], v30 offset:10784
    s_bfe_u32 s72, s70, 0x40008
    v_mfma_f32_16x16x32_bf16 v[60:63], a[248:251], a[44:47], v[60:63]
    s_waitcnt lgkmcnt(7)
    ds_read_b64_tr_b16 a[78:79], v30 offset:25120
    s_mul_i32 s72, s72, 458752
    v_mfma_f32_16x16x32_bf16 v[60:63], a[252:255], a[60:63], v[60:63]
    v_mfma_f32_16x16x32_bf16 v[56:59], a[252:255], a[56:59], v[56:59]
    buffer_load_dwordx4 v5, s[12:15], s72 offen offset:0 lds
    v_mfma_f32_16x16x32_bf16 v[56:59], a[248:251], a[40:43], v[56:59]
    v_mfma_f32_16x16x32_bf16 v[52:55], a[248:251], a[36:39], v[52:55]
    ds_read_b64_tr_b16 a[80:81], v30 offset:64
    v_mfma_f32_16x16x32_bf16 v[52:55], a[252:255], a[52:55], v[52:55]
    ds_read_b64_tr_b16 a[82:83], v30 offset:14400
    v_mfma_f32_16x16x32_bf16 v[48:51], a[252:255], a[48:51], v[48:51]
    ds_read_b64_tr_b16 a[84:85], v30 offset:3648
    v_mfma_f32_16x16x32_bf16 v[48:51], a[248:251], a[32:35], v[48:51]
    s_waitcnt lgkmcnt(9)
    ds_read_b64_tr_b16 a[86:87], v30 offset:17984
    v_mfma_f32_16x16x32_bf16 v[64:67], a[64:67], a[32:35], v[64:67]
    s_waitcnt lgkmcnt(8)
    buffer_load_dwordx4 v6, s[12:15], s72 offen offset:1024 lds
    v_mfma_f32_16x16x32_bf16 v[64:67], a[68:71], a[48:51], v[64:67]
    v_mfma_f32_16x16x32_bf16 v[68:71], a[68:71], a[52:55], v[68:71]
    v_mfma_f32_16x16x32_bf16 v[68:71], a[64:67], a[36:39], v[68:71]
    v_mfma_f32_16x16x32_bf16 v[72:75], a[64:67], a[40:43], v[72:75]
    ds_read_b64_tr_b16 a[248:249], v30 offset:7232
    v_mfma_f32_16x16x32_bf16 v[72:75], a[68:71], a[56:59], v[72:75]
    ds_read_b64_tr_b16 a[250:251], v30 offset:21568
    v_mfma_f32_16x16x32_bf16 v[76:79], a[68:71], a[60:63], v[76:79]
    buffer_load_dwordx4 v7, s[12:15], s72 offen offset:2048 lds
    v_mfma_f32_16x16x32_bf16 v[76:79], a[64:67], a[44:47], v[76:79]
    s_waitcnt lgkmcnt(8)
    ds_read_b64_tr_b16 a[252:253], v30 offset:10816
    v_mfma_f32_16x16x32_bf16 v[92:95], a[72:75], a[44:47], v[92:95]
    s_waitcnt lgkmcnt(7)
    ds_read_b64_tr_b16 a[254:255], v30 offset:25152
    v_mfma_f32_16x16x32_bf16 v[92:95], a[76:79], a[60:63], v[92:95]
    v_mfma_f32_16x16x32_bf16 v[88:91], a[76:79], a[56:59], v[88:91]
    v_mfma_f32_16x16x32_bf16 v[88:91], a[72:75], a[40:43], v[88:91]
    v_mfma_f32_16x16x32_bf16 v[84:87], a[72:75], a[36:39], v[84:87]
    buffer_load_dwordx4 v8, s[12:15], s72 offen offset:3072 lds
    v_mfma_f32_16x16x32_bf16 v[84:87], a[76:79], a[52:55], v[84:87]
    ds_read_b64_tr_b16 a[64:65], v30 offset:96
    v_mfma_f32_16x16x32_bf16 v[80:83], a[76:79], a[48:51], v[80:83]
    ds_read_b64_tr_b16 a[66:67], v30 offset:14432
    v_mfma_f32_16x16x32_bf16 v[80:83], a[72:75], a[32:35], v[80:83]
    s_waitcnt lgkmcnt(8)
    ds_read_b64_tr_b16 a[68:69], v30 offset:3680
    v_mfma_f32_16x16x32_bf16 v[96:99], a[80:83], a[32:35], v[96:99]
    s_waitcnt lgkmcnt(7)
    ds_read_b64_tr_b16 a[70:71], v30 offset:18016
    s_add_u32 m0, s57, 98304
    v_mfma_f32_16x16x32_bf16 v[96:99], a[84:87], a[48:51], v[96:99]
    s_waitcnt vmcnt(8)
    v_mfma_f32_16x16x32_bf16 v[100:103], a[84:87], a[52:55], v[100:103]
    buffer_load_dwordx4 v9, s[12:15], s72 offen offset:0 lds
    v_mfma_f32_16x16x32_bf16 v[100:103], a[80:83], a[36:39], v[100:103]
    ds_read_b128 a[0:3], v3 offset:4096
    v_mfma_f32_16x16x32_bf16 v[104:107], a[80:83], a[40:43], v[104:107]
    ds_read_b128 a[16:19], v4 offset:4096
    v_mfma_f32_16x16x32_bf16 v[104:107], a[84:87], a[56:59], v[104:107]
    ds_read_b128 a[4:7], v3 offset:6144
    v_mfma_f32_16x16x32_bf16 v[108:111], a[84:87], a[60:63], v[108:111]
    ds_read_b128 a[20:23], v4 offset:6144
    v_mfma_f32_16x16x32_bf16 v[108:111], a[80:83], a[44:47], v[108:111]
    s_waitcnt lgkmcnt(10)
    buffer_load_dwordx4 v10, s[12:15], s72 offen offset:1024 lds
    v_mfma_f32_16x16x32_bf16 v[124:127], a[248:251], a[44:47], v[124:127]
    s_waitcnt lgkmcnt(8)
    ds_read_b64_tr_b16 a[72:73], v30 offset:7264
    v_mfma_f32_16x16x32_bf16 v[124:127], a[252:255], a[60:63], v[124:127]
    ds_read_b64_tr_b16 a[74:75], v30 offset:21600
    v_mfma_f32_16x16x32_bf16 v[120:123], a[252:255], a[56:59], v[120:123]
    ds_read_b64_tr_b16 a[76:77], v30 offset:10848
    v_mfma_f32_16x16x32_bf16 v[120:123], a[248:251], a[40:43], v[120:123]
    ds_read_b64_tr_b16 a[78:79], v30 offset:25184
    v_mfma_f32_16x16x32_bf16 v[116:119], a[248:251], a[36:39], v[116:119]
    ds_read_b64_tr_b16 a[80:81], v30 offset:128
    v_mfma_f32_16x16x32_bf16 v[116:119], a[252:255], a[52:55], v[116:119]
    buffer_load_dwordx4 v11, s[12:15], s72 offen offset:2048 lds
    v_mfma_f32_16x16x32_bf16 v[112:115], a[252:255], a[48:51], v[112:115]
    s_mov_b32 m0, s56
    ds_read_b64_tr_b16 a[82:83], v30 offset:14464
    v_mfma_f32_16x16x32_bf16 v[112:115], a[248:251], a[32:35], v[112:115]
    s_waitcnt lgkmcnt(12)
    ds_read_b64_tr_b16 a[84:85], v30 offset:3712
    s_bfe_u32 s73, s70, 0x4000c
    v_mfma_f32_16x16x32_bf16 v[128:131], a[64:67], a[32:35], v[128:131]
    s_waitcnt lgkmcnt(11)
    ds_read_b64_tr_b16 a[86:87], v30 offset:18048
    s_lshl_b32 s73, s73, 7
    v_mfma_f32_16x16x32_bf16 v[128:131], a[68:71], a[48:51], v[128:131]
    s_add_u32 s8, s6, s73
    s_addc_u32 s9, s7, 0
    v_mfma_f32_16x16x32_bf16 v[132:135], a[68:71], a[52:55], v[132:135]
    v_mfma_f32_16x16x32_bf16 v[132:135], a[64:67], a[36:39], v[132:135]
    buffer_load_dwordx4 v1, s[8:11], s48 offen offset:0 lds
    v_mfma_f32_16x16x32_bf16 v[136:139], a[64:67], a[40:43], v[136:139]
    ds_read_b64_tr_b16 a[248:249], v30 offset:7296
    v_mfma_f32_16x16x32_bf16 v[136:139], a[68:71], a[56:59], v[136:139]
    ds_read_b64_tr_b16 a[250:251], v30 offset:21632
    v_mfma_f32_16x16x32_bf16 v[140:143], a[68:71], a[60:63], v[140:143]
    ds_read_b64_tr_b16 a[252:253], v30 offset:10880
    v_mfma_f32_16x16x32_bf16 v[140:143], a[64:67], a[44:47], v[140:143]
    s_waitcnt lgkmcnt(9)
    ds_read_b64_tr_b16 a[254:255], v30 offset:25216
    v_mfma_f32_16x16x32_bf16 v[156:159], a[72:75], a[44:47], v[156:159]
    s_waitcnt lgkmcnt(8)
    v_mfma_f32_16x16x32_bf16 v[156:159], a[76:79], a[60:63], v[156:159]
    buffer_load_dwordx4 v2, s[8:11], s49 offen offset:1024 lds
    v_mfma_f32_16x16x32_bf16 v[152:155], a[76:79], a[56:59], v[152:155]
    v_mfma_f32_16x16x32_bf16 v[152:155], a[72:75], a[40:43], v[152:155]
    v_mfma_f32_16x16x32_bf16 v[148:151], a[72:75], a[36:39], v[148:151]
    ds_read_b64_tr_b16 a[64:65], v30 offset:160
    v_mfma_f32_16x16x32_bf16 v[148:151], a[76:79], a[52:55], v[148:151]
    ds_read_b64_tr_b16 a[66:67], v30 offset:14496
    v_mfma_f32_16x16x32_bf16 v[144:147], a[76:79], a[48:51], v[144:147]
    ds_read_b64_tr_b16 a[68:69], v30 offset:3744
    v_mfma_f32_16x16x32_bf16 v[144:147], a[72:75], a[32:35], v[144:147]
    s_waitcnt lgkmcnt(9)
    buffer_load_dwordx4 v1, s[8:11], s50 offen offset:2048 lds
    v_mfma_f32_16x16x32_bf16 v[160:163], a[80:83], a[32:35], v[160:163]
    s_waitcnt lgkmcnt(7)
    ds_read_b64_tr_b16 a[70:71], v30 offset:18080
    v_mfma_f32_16x16x32_bf16 v[160:163], a[84:87], a[48:51], v[160:163]
    v_mfma_f32_16x16x32_bf16 v[164:167], a[84:87], a[52:55], v[164:167]
    v_mfma_f32_16x16x32_bf16 v[164:167], a[80:83], a[36:39], v[164:167]
    v_mfma_f32_16x16x32_bf16 v[168:171], a[80:83], a[40:43], v[168:171]
    buffer_load_dwordx4 v2, s[8:11], s51 offen offset:3072 lds
    v_mfma_f32_16x16x32_bf16 v[168:171], a[84:87], a[56:59], v[168:171]
    ds_read_b64_tr_b16 a[72:73], v30 offset:7328
    v_mfma_f32_16x16x32_bf16 v[172:175], a[84:87], a[60:63], v[172:175]
    ds_read_b64_tr_b16 a[74:75], v30 offset:21664
    v_mfma_f32_16x16x32_bf16 v[172:175], a[80:83], a[44:47], v[172:175]
    s_waitcnt lgkmcnt(8)
    ds_read_b64_tr_b16 a[76:77], v30 offset:10912
    s_add_u32 m0, s56, 12288
    v_mfma_f32_16x16x32_bf16 v[188:191], a[248:251], a[44:47], v[188:191]
    s_waitcnt lgkmcnt(7)
    ds_read_b64_tr_b16 a[78:79], v30 offset:25248
    s_lshl1_add_u32 s68, s74, 0
    v_mfma_f32_16x16x32_bf16 v[188:191], a[252:255], a[60:63], v[188:191]
    v_mfma_f32_16x16x32_bf16 v[184:187], a[252:255], a[56:59], v[184:187]
    buffer_load_dwordx4 v13, s[16:19], s68 offen offset:0 lds
    v_mfma_f32_16x16x32_bf16 v[184:187], a[248:251], a[40:43], v[184:187]
    v_mfma_f32_16x16x32_bf16 v[180:183], a[248:251], a[36:39], v[180:183]
    ds_read_b64_tr_b16 a[80:81], v30 offset:192
    v_mfma_f32_16x16x32_bf16 v[180:183], a[252:255], a[52:55], v[180:183]
    ds_read_b64_tr_b16 a[82:83], v30 offset:14528
    v_mfma_f32_16x16x32_bf16 v[176:179], a[252:255], a[48:51], v[176:179]
    s_lshl1_add_u32 s68, s74, 228352
    ds_read_b64_tr_b16 a[84:85], v30 offset:3776
    v_mfma_f32_16x16x32_bf16 v[176:179], a[248:251], a[32:35], v[176:179]
    s_waitcnt lgkmcnt(9)
    ds_read_b64_tr_b16 a[86:87], v30 offset:18112
    v_mfma_f32_16x16x32_bf16 v[192:195], a[64:67], a[32:35], v[192:195]
    s_waitcnt lgkmcnt(8)
    buffer_load_dwordx4 v13, s[16:19], s68 offen offset:1024 lds
    v_mfma_f32_16x16x32_bf16 v[192:195], a[68:71], a[48:51], v[192:195]
    v_mfma_f32_16x16x32_bf16 v[196:199], a[68:71], a[52:55], v[196:199]
    v_mfma_f32_16x16x32_bf16 v[196:199], a[64:67], a[36:39], v[196:199]
    v_mfma_f32_16x16x32_bf16 v[200:203], a[64:67], a[40:43], v[200:203]
    s_lshl1_add_u32 s68, s74, 14336
    ds_read_b64_tr_b16 a[248:249], v30 offset:7360
    v_mfma_f32_16x16x32_bf16 v[200:203], a[68:71], a[56:59], v[200:203]
    ds_read_b64_tr_b16 a[250:251], v30 offset:21696
    v_mfma_f32_16x16x32_bf16 v[204:207], a[68:71], a[60:63], v[204:207]
    buffer_load_dwordx4 v13, s[16:19], s68 offen offset:2048 lds
    v_mfma_f32_16x16x32_bf16 v[204:207], a[64:67], a[44:47], v[204:207]
    s_waitcnt lgkmcnt(8)
    ds_read_b64_tr_b16 a[252:253], v30 offset:10944
    v_mfma_f32_16x16x32_bf16 v[220:223], a[72:75], a[44:47], v[220:223]
    s_waitcnt lgkmcnt(7)
    ds_read_b64_tr_b16 a[254:255], v30 offset:25280
    v_mfma_f32_16x16x32_bf16 v[220:223], a[76:79], a[60:63], v[220:223]
    s_waitcnt vmcnt(14)
    v_mfma_f32_16x16x32_bf16 v[216:219], a[76:79], a[56:59], v[216:219]
    s_lshl1_add_u32 s68, s74, 242688
    ds_read_b128 a[8:11], v3 offset:8192
    v_mfma_f32_16x16x32_bf16 v[216:219], a[72:75], a[40:43], v[216:219]
    ds_read_b128 a[24:27], v4 offset:8192
    v_mfma_f32_16x16x32_bf16 v[212:215], a[72:75], a[36:39], v[212:215]
    buffer_load_dwordx4 v13, s[16:19], s68 offen offset:3072 lds
    v_mfma_f32_16x16x32_bf16 v[212:215], a[76:79], a[52:55], v[212:215]
    ds_read_b128 a[12:15], v3 offset:10240
    v_mfma_f32_16x16x32_bf16 v[208:211], a[76:79], a[48:51], v[208:211]
    ds_read_b128 a[28:31], v4 offset:10240
    v_mfma_f32_16x16x32_bf16 v[208:211], a[72:75], a[32:35], v[208:211]
    s_waitcnt lgkmcnt(10)
    s_add_u32 m0, s56, 4096
    v_mfma_f32_16x16x32_bf16 v[224:227], a[80:83], a[32:35], v[224:227]
    s_waitcnt lgkmcnt(8)
    v_mfma_f32_16x16x32_bf16 v[224:227], a[84:87], a[48:51], v[224:227]
    buffer_load_dwordx4 v1, s[8:11], s52 offen offset:0 lds
    v_mfma_f32_16x16x32_bf16 v[228:231], a[84:87], a[52:55], v[228:231]
    s_waitcnt vmcnt(9) lgkmcnt(4)
    v_mfma_f32_16x16x32_bf16 v[228:231], a[80:83], a[36:39], v[228:231]
    s_barrier
    v_mfma_f32_16x16x32_bf16 v[232:235], a[80:83], a[40:43], v[232:235]
    ds_read_b64_tr_b16 a[64:65], v12 offset:28672
    v_mfma_f32_16x16x32_bf16 v[232:235], a[84:87], a[56:59], v[232:235]
    ds_read_b64_tr_b16 a[66:67], v12 offset:43008
    v_mfma_f32_16x16x32_bf16 v[236:239], a[84:87], a[60:63], v[236:239]
    ds_read_b64_tr_b16 a[68:69], v12 offset:32256
    s_cmp_eq_u32 s65, 0
    s_cbranch_scc1 L_announce
L_announced:
    v_mfma_f32_16x16x32_bf16 v[236:239], a[80:83], a[44:47], v[236:239]
    buffer_load_dwordx4 v2, s[8:11], s53 offen offset:1024 lds
    v_mfma_f32_16x16x32_bf16 v[252:255], a[248:251], a[44:47], v[252:255]
    ds_read_b64_tr_b16 a[70:71], v12 offset:46592
    v_mfma_f32_16x16x32_bf16 v[252:255], a[252:255], a[60:63], v[252:255]
    ds_read_b64_tr_b16 a[72:73], v12 offset:35840
    v_mfma_f32_16x16x32_bf16 v[248:251], a[252:255], a[56:59], v[248:251]
    ds_read_b64_tr_b16 a[74:75], v12 offset:50176
    v_mfma_f32_16x16x32_bf16 v[248:251], a[248:251], a[40:43], v[248:251]
    ds_read_b64_tr_b16 a[76:77], v12 offset:39424
    v_mfma_f32_16x16x32_bf16 v[244:247], a[248:251], a[36:39], v[244:247]
    ds_read_b64_tr_b16 a[78:79], v12 offset:53760
    v_mfma_f32_16x16x32_bf16 v[244:247], a[252:255], a[52:55], v[244:247]
    buffer_load_dwordx4 v1, s[8:11], s54 offen offset:2048 lds
    v_mfma_f32_16x16x32_bf16 v[240:243], a[252:255], a[48:51], v[240:243]
    ds_read_b64_tr_b16 a[80:81], v12 offset:28704
    v_mfma_f32_16x16x32_bf16 v[240:243], a[248:251], a[32:35], v[240:243]
    s_waitcnt lgkmcnt(7)
    ds_read_b64_tr_b16 a[82:83], v12 offset:43040
    v_mfma_f32_16x16x32_bf16 v[32:35], a[64:67], a[0:3], v[32:35]
    s_waitcnt lgkmcnt(6)
    ds_read_b64_tr_b16 a[84:85], v12 offset:32288
    v_mfma_f32_16x16x32_bf16 v[32:35], a[68:71], a[16:19], v[32:35]
    ds_read_b64_tr_b16 a[86:87], v12 offset:46624
    v_mfma_f32_16x16x32_bf16 v[36:39], a[68:71], a[20:23], v[36:39]
    v_mfma_f32_16x16x32_bf16 v[36:39], a[64:67], a[4:7], v[36:39]
    buffer_load_dwordx4 v2, s[8:11], s55 offen offset:3072 lds
    v_mfma_f32_16x16x32_bf16 v[40:43], a[64:67], a[8:11], v[40:43]
    ds_read_b64_tr_b16 a[248:249], v12 offset:35872
    v_mfma_f32_16x16x32_bf16 v[40:43], a[68:71], a[24:27], v[40:43]
    s_add_u32 m0, s57, 65536
    ds_read_b64_tr_b16 a[250:251], v12 offset:50208
    v_mfma_f32_16x16x32_bf16 v[44:47], a[68:71], a[28:31], v[44:47]
    s_bfe_u32 s72, s70, 0x4000c
    ds_read_b64_tr_b16 a[252:253], v12 offset:39456
    v_mfma_f32_16x16x32_bf16 v[44:47], a[64:67], a[12:15], v[44:47]
    s_waitcnt lgkmcnt(9)
    ds_read_b64_tr_b16 a[254:255], v12 offset:53792
    s_mul_i32 s72, s72, 458752
    v_mfma_f32_16x16x32_bf16 v[60:63], a[72:75], a[12:15], v[60:63]
    s_waitcnt lgkmcnt(8)
    v_mfma_f32_16x16x32_bf16 v[60:63], a[76:79], a[28:31], v[60:63]
    buffer_load_dwordx4 v5, s[12:15], s72 offen offset:0 lds
    v_mfma_f32_16x16x32_bf16 v[56:59], a[76:79], a[24:27], v[56:59]
    v_mfma_f32_16x16x32_bf16 v[56:59], a[72:75], a[8:11], v[56:59]
    v_mfma_f32_16x16x32_bf16 v[52:55], a[72:75], a[4:7], v[52:55]
    ds_read_b64_tr_b16 a[64:65], v12 offset:28736
    v_mfma_f32_16x16x32_bf16 v[52:55], a[76:79], a[20:23], v[52:55]
    ds_read_b64_tr_b16 a[66:67], v12 offset:43072
    v_mfma_f32_16x16x32_bf16 v[48:51], a[76:79], a[16:19], v[48:51]
    buffer_load_dwordx4 v6, s[12:15], s72 offen offset:1024 lds
    v_mfma_f32_16x16x32_bf16 v[48:51], a[72:75], a[0:3], v[48:51]
    s_waitcnt lgkmcnt(8)
    ds_read_b64_tr_b16 a[68:69], v12 offset:32320
    v_mfma_f32_16x16x32_bf16 v[64:67], a[80:83], a[0:3], v[64:67]
    s_waitcnt lgkmcnt(7)
    ds_read_b64_tr_b16 a[70:71], v12 offset:46656
    v_mfma_f32_16x16x32_bf16 v[64:67], a[84:87], a[16:19], v[64:67]
    v_mfma_f32_16x16x32_bf16 v[68:71], a[84:87], a[20:23], v[68:71]
    v_mfma_f32_16x16x32_bf16 v[68:71], a[80:83], a[4:7], v[68:71]
    v_mfma_f32_16x16x32_bf16 v[72:75], a[80:83], a[8:11], v[72:75]
    buffer_load_dwordx4 v7, s[12:15], s72 offen offset:2048 lds
    v_mfma_f32_16x16x32_bf16 v[72:75], a[84:87], a[24:27], v[72:75]
    ds_read_b64_tr_b16 a[72:73], v12 offset:35904
    v_mfma_f32_16x16x32_bf16 v[76:79], a[84:87], a[28:31], v[76:79]
    ds_read_b64_tr_b16 a[74:75], v12 offset:50240
    v_mfma_f32_16x16x32_bf16 v[76:79], a[80:83], a[12:15], v[76:79]
    s_waitcnt lgkmcnt(8)
    ds_read_b64_tr_b16 a[76:77], v12 offset:39488
    v_mfma_f32_16x16x32_bf16 v[92:95], a[248:251], a[12:15], v[92:95]
    s_waitcnt lgkmcnt(7)
    ds_read_b64_tr_b16 a[78:79], v12 offset:53824
    v_mfma_f32_16x16x32_bf16 v[92:95], a[252:255], a[28:31], v[92:95]
L_pad1:
    s_cbranch_vccnz L_pad5
    v_mfma_f32_16x16x32_bf16 v[88:91], a[252:255], a[24:27], v[88:91]
    buffer_load_dwordx4 v8, s[12:15], s72 offen offset:3072 lds
    v_mfma_f32_16x16x32_bf16 v[88:91], a[248:251], a[8:11], v[88:91]
    v_mfma_f32_16x16x32_bf16 v[84:87], a[248:251], a[4:7], v[84:87]
    ds_read_b64_tr_b16 a[80:81], v12 offset:28768
    v_mfma_f32_16x16x32_bf16 v[84:87], a[252:255], a[20:23], v[84:87]
    ds_read_b64_tr_b16 a[82:83], v12 offset:43104
    v_mfma_f32_16x16x32_bf16 v[80:83], a[252:255], a[16:19], v[80:83]
    s_add_u32 m0, s57, 69632
    ds_read_b64_tr_b16 a[84:85], v12 offset:32352
    v_mfma_f32_16x16x32_bf16 v[80:83], a[248:251], a[0:3], v[80:83]
    s_waitcnt lgkmcnt(9)
    ds_read_b64_tr_b16 a[86:87], v12 offset:46688
    v_mfma_f32_16x16x32_bf16 v[96:99], a[64:67], a[0:3], v[96:99]
    s_waitcnt lgkmcnt(8)
    buffer_load_dwordx4 v9, s[12:15], s72 offen offset:0 lds
    v_mfma_f32_16x16x32_bf16 v[96:99], a[68:71], a[16:19], v[96:99]
    s_waitcnt vmcnt(13)
    v_mfma_f32_16x16x32_bf16 v[100:103], a[68:71], a[20:23], v[100:103]
    ds_read_b128 a[32:35], v3 offset:0
    v_mfma_f32_16x16x32_bf16 v[100:103], a[64:67], a[4:7], v[100:103]
    ds_read_b128 a[48:51], v4 offset:0
    v_mfma_f32_16x16x32_bf16 v[104:107], a[64:67], a[8:11], v[104:107]
    ds_read_b128 a[36:39], v3 offset:2048
    v_mfma_f32_16x16x32_bf16 v[104:107], a[68:71], a[24:27], v[104:107]
    ds_read_b128 a[52:55], v4 offset:2048
    v_mfma_f32_16x16x32_bf16 v[108:111], a[68:71], a[28:31], v[108:111]
    buffer_load_dwordx4 v10, s[12:15], s72 offen offset:1024 lds
    v_mfma_f32_16x16x32_bf16 v[108:111], a[64:67], a[12:15], v[108:111]
    s_waitcnt lgkmcnt(10)
    ds_read_b64_tr_b16 a[248:249], v12 offset:35936
    v_mfma_f32_16x16x32_bf16 v[124:127], a[72:75], a[12:15], v[124:127]
    s_waitcnt lgkmcnt(9)
    ds_read_b64_tr_b16 a[250:251], v12 offset:50272
    v_mfma_f32_16x16x32_bf16 v[124:127], a[76:79], a[28:31], v[124:127]
    ds_read_b64_tr_b16 a[252:253], v12 offset:39520
    v_mfma_f32_16x16x32_bf16 v[120:123], a[76:79], a[24:27], v[120:123]
    ds_read_b64_tr_b16 a[254:255], v12 offset:53856
    v_mfma_f32_16x16x32_bf16 v[120:123], a[72:75], a[8:11], v[120:123]
    buffer_load_dwordx4 v11, s[12:15], s72 offen offset:2048 lds
    v_mfma_f32_16x16x32_bf16 v[116:119], a[72:75], a[4:7], v[116:119]
    s_add_u32 m0, s56, 8192
    ds_read_b64_tr_b16 a[64:65], v12 offset:28800
    v_mfma_f32_16x16x32_bf16 v[116:119], a[76:79], a[20:23], v[116:119]
    s_bfe_u32 s73, s70, 0x40010
    ds_read_b64_tr_b16 a[66:67], v12 offset:43136
    v_mfma_f32_16x16x32_bf16 v[112:115], a[76:79], a[16:19], v[112:115]
    s_lshl_b32 s73, s73, 7
    ds_read_b64_tr_b16 a[68:69], v12 offset:32384
    v_mfma_f32_16x16x32_bf16 v[112:115], a[72:75], a[0:3], v[112:115]
    s_waitcnt lgkmcnt(13)
    ds_read_b64_tr_b16 a[70:71], v12 offset:46720
    s_add_u32 s8, s6, s73
    s_addc_u32 s9, s7, 0
    v_mfma_f32_16x16x32_bf16 v[128:131], a[80:83], a[0:3], v[128:131]
    s_waitcnt lgkmcnt(12)
    v_mfma_f32_16x16x32_bf16 v[128:131], a[84:87], a[16:19], v[128:131]
    buffer_load_dwordx4 v1, s[8:11], s48 offen offset:0 lds
    v_mfma_f32_16x16x32_bf16 v[132:135], a[84:87], a[20:23], v[132:135]
    v_mfma_f32_16x16x32_bf16 v[132:135], a[80:83], a[4:7], v[132:135]
    v_mfma_f32_16x16x32_bf16 v[136:139], a[80:83], a[8:11], v[136:139]
    ds_read_b64_tr_b16 a[72:73], v12 offset:35968
    v_mfma_f32_16x16x32_bf16 v[136:139], a[84:87], a[24:27], v[136:139]
    ds_read_b64_tr_b16 a[74:75], v12 offset:50304
    v_mfma_f32_16x16x32_bf16 v[140:143], a[84:87], a[28:31], v[140:143]
    ds_read_b64_tr_b16 a[76:77], v12 offset:39552
    v_mfma_f32_16x16x32_bf16 v[140:143], a[80:83], a[12:15], v[140:143]
    s_waitcnt lgkmcnt(9)
    buffer_load_dwordx4 v2, s[8:11], s49 offen offset:1024 lds
    v_mfma_f32_16x16x32_bf16 v[156:159], a[248:251], a[12:15], v[156:159]
    s_waitcnt lgkmcnt(7)
    ds_read_b64_tr_b16 a[78:79], v12 offset:53888
    v_mfma_f32_16x16x32_bf16 v[156:159], a[252:255], a[28:31], v[156:159]
    v_mfma_f32_16x16x32_bf16 v[152:155], a[252:255], a[24:27], v[152:155]
    v_mfma_f32_16x16x32_bf16 v[152:155], a[248:251], a[8:11], v[152:155]
    s_waitcnt vmcnt(13)
    v_mfma_f32_16x16x32_bf16 v[148:151], a[248:251], a[4:7], v[148:151]
    ds_read_b64_tr_b16 a[88:89], v14 offset:12288
    v_mfma_f32_16x16x32_bf16 v[148:151], a[252:255], a[20:23], v[148:151]
    buffer_load_dwordx4 v1, s[8:11], s50 offen offset:2048 lds
    v_mfma_f32_16x16x32_bf16 v[144:147], a[252:255], a[16:19], v[144:147]
    ds_read_b64_tr_b16 a[92:93], v15 offset:12288
    v_mfma_f32_16x16x32_bf16 v[144:147], a[248:251], a[0:3], v[144:147]
    s_waitcnt lgkmcnt(8)
    ds_read_b64_tr_b16 a[96:97], v16 offset:12288
    v_mfma_f32_16x16x32_bf16 v[160:163], a[64:67], a[0:3], v[160:163]
    s_waitcnt lgkmcnt(7)
    ds_read_b64_tr_b16 a[100:101], v17 offset:12288
    v_mfma_f32_16x16x32_bf16 v[160:163], a[68:71], a[16:19], v[160:163]
    ds_read_b64_tr_b16 a[90:91], v14 offset:14336
    v_mfma_f32_16x16x32_bf16 v[164:167], a[68:71], a[20:23], v[164:167]
    ds_read_b64_tr_b16 a[94:95], v15 offset:14336
    v_mfma_f32_16x16x32_bf16 v[164:167], a[64:67], a[4:7], v[164:167]
    buffer_load_dwordx4 v2, s[8:11], s51 offen offset:3072 lds
    v_mfma_f32_16x16x32_bf16 v[168:171], a[64:67], a[8:11], v[168:171]
    ds_read_b64_tr_b16 a[80:81], v12 offset:28832
    v_mfma_f32_16x16x32_bf16 v[168:171], a[68:71], a[24:27], v[168:171]
    ds_read_b64_tr_b16 a[82:83], v12 offset:43168
    v_mfma_f32_16x16x32_bf16 v[172:175], a[68:71], a[28:31], v[172:175]
    s_mov_b32 m0, s56
    ds_read_b64_tr_b16 a[98:99], v16 offset:14336
    v_mfma_f32_16x16x32_bf16 v[172:175], a[64:67], a[12:15], v[172:175]
    s_waitcnt lgkmcnt(11)
    ds_read_b64_tr_b16 a[84:85], v12 offset:32416
    v_mfma_f32_16x16x32_bf16 v[188:191], a[72:75], a[12:15], v[188:191]
    s_waitcnt lgkmcnt(10)
    buffer_load_dwordx4 v1, s[8:11], s52 offen offset:0 lds
    v_mfma_f32_16x16x32_bf16 v[188:191], a[76:79], a[28:31], v[188:191]
    ds_read_b64_tr_b16 a[86:87], v12 offset:46752
    v_mfma_f32_16x16x32_bf16 v[184:187], a[76:79], a[24:27], v[184:187]
    ds_read_b64_tr_b16 a[102:103], v17 offset:14336
    v_mfma_f32_16x16x32_bf16 v[184:187], a[72:75], a[8:11], v[184:187]
    s_add_u32 m0, s56, 12288
    ds_read_b64_tr_b16 a[248:249], v12 offset:36000
    v_mfma_f32_16x16x32_bf16 v[180:183], a[72:75], a[4:7], v[180:183]
    s_lshl1_add_u32 s68, s75, 0
    global_load_dword v23, v22, s[4:5]
    v_mfma_f32_16x16x32_bf16 v[180:183], a[76:79], a[20:23], v[180:183]
    s_waitcnt lgkmcnt(1)
    ds_read_b64_tr_b16 a[250:251], v12 offset:50336
    v_mfma_f32_16x16x32_bf16 v[176:179], a[76:79], a[16:19], v[176:179]
    buffer_load_dwordx4 v13, s[16:19], s68 offen offset:0 lds
    v_mfma_f32_16x16x32_bf16 v[176:179], a[72:75], a[0:3], v[176:179]
    ds_read_b64_tr_b16 a[252:253], v12 offset:39584
    v_mfma_f32_16x16x32_bf16 v[192:195], a[80:83], a[0:3], v[192:195]
    ds_read_b64_tr_b16 a[254:255], v12 offset:53920
    v_mfma_f32_16x16x32_bf16 v[192:195], a[84:87], a[16:19], v[192:195]
    ds_read_b64_tr_b16 a[64:65], v12 offset:28864
    v_add_u32 v22, 1024, v22
    v_mfma_f32_16x16x32_bf16 v[196:199], a[84:87], a[20:23], v[196:199]
    s_lshl1_add_u32 s68, s75, 228352
    ds_read_b64_tr_b16 a[66:67], v12 offset:43200
    v_mfma_f32_16x16x32_bf16 v[196:199], a[80:83], a[4:7], v[196:199]
    ds_read_b64_tr_b16 a[68:69], v12 offset:32448
    v_mfma_f32_16x16x32_bf16 v[200:203], a[80:83], a[8:11], v[200:203]
    buffer_load_dwordx4 v13, s[16:19], s68 offen offset:1024 lds
    v_mfma_f32_16x16x32_bf16 v[200:203], a[84:87], a[24:27], v[200:203]
    ds_read_b64_tr_b16 a[70:71], v12 offset:46784
    v_mfma_f32_16x16x32_bf16 v[204:207], a[84:87], a[28:31], v[204:207]
    ds_read_b64_tr_b16 a[72:73], v12 offset:36032
    v_mfma_f32_16x16x32_bf16 v[204:207], a[80:83], a[12:15], v[204:207]
    s_waitcnt lgkmcnt(7)
    ds_read_b64_tr_b16 a[74:75], v12 offset:50368
    v_mfma_f32_16x16x32_bf16 v[220:223], a[248:251], a[12:15], v[220:223]
    s_waitcnt lgkmcnt(6)
    ds_read_b64_tr_b16 a[76:77], v12 offset:39616
    s_lshl1_add_u32 s68, s75, 14336
    v_mfma_f32_16x16x32_bf16 v[220:223], a[252:255], a[28:31], v[220:223]
    s_waitcnt vmcnt(15)
    ds_read_b64_tr_b16 a[78:79], v12 offset:53952
    v_mfma_f32_16x16x32_bf16 v[216:219], a[252:255], a[24:27], v[216:219]
    buffer_load_dwordx4 v13, s[16:19], s68 offen offset:2048 lds
    v_mfma_f32_16x16x32_bf16 v[216:219], a[248:251], a[8:11], v[216:219]
    ds_read_b128 a[40:43], v3 offset:4096
    v_mfma_f32_16x16x32_bf16 v[212:215], a[248:251], a[4:7], v[212:215]
    ds_read_b128 a[56:59], v4 offset:4096
    v_mfma_f32_16x16x32_bf16 v[212:215], a[252:255], a[20:23], v[212:215]
    ds_read_b128 a[44:47], v3 offset:6144
    v_mfma_f32_16x16x32_bf16 v[208:211], a[252:255], a[16:19], v[208:211]
    s_lshl1_add_u32 s68, s75, 242688
    ds_read_b128 a[60:63], v4 offset:6144
    v_mfma_f32_16x16x32_bf16 v[208:211], a[248:251], a[0:3], v[208:211]
    s_waitcnt lgkmcnt(10)
    v_mfma_f32_16x16x32_bf16 v[224:227], a[64:67], a[0:3], v[224:227]
    s_waitcnt lgkmcnt(8)
    buffer_load_dwordx4 v13, s[16:19], s68 offen offset:3072 lds
    v_mfma_f32_16x16x32_bf16 v[224:227], a[68:71], a[16:19], v[224:227]
    v_mfma_f32_16x16x32_bf16 v[228:231], a[68:71], a[20:23], v[228:231]
    s_waitcnt vmcnt(10) lgkmcnt(4)
    v_mfma_f32_16x16x32_bf16 v[228:231], a[64:67], a[4:7], v[228:231]
    s_barrier
    s_mov_b32 m0, s56
    v_mfma_f32_16x16x32_bf16 v[232:235], a[64:67], a[8:11], v[232:235]
    ds_read_b64_tr_b16 a[80:81], v12 offset:0
    v_mfma_f32_16x16x32_bf16 v[232:235], a[68:71], a[24:27], v[232:235]
    buffer_load_dwordx4 v2, s[8:11], s53 offen offset:1024 lds
    v_mfma_f32_16x16x32_bf16 v[236:239], a[68:71], a[28:31], v[236:239]
    ds_read_b64_tr_b16 a[82:83], v12 offset:14336
    v_mfma_f32_16x16x32_bf16 v[236:239], a[64:67], a[12:15], v[236:239]
    ds_read_b64_tr_b16 a[84:85], v12 offset:3584
    v_mfma_f32_16x16x32_bf16 v[252:255], a[72:75], a[12:15], v[252:255]
    ds_read_b64_tr_b16 a[86:87], v12 offset:17920
    v_mfma_f32_16x16x32_bf16 v[252:255], a[76:79], a[28:31], v[252:255]
    ds_read_b64_tr_b16 a[248:249], v12 offset:7168
    v_mfma_f32_16x16x32_bf16 v[248:251], a[76:79], a[24:27], v[248:251]
    ds_read_b64_tr_b16 a[250:251], v12 offset:21504
    v_mfma_f32_16x16x32_bf16 v[248:251], a[72:75], a[8:11], v[248:251]
    buffer_load_dwordx4 v1, s[8:11], s54 offen offset:2048 lds
    v_mfma_f32_16x16x32_bf16 v[244:247], a[72:75], a[4:7], v[244:247]
    ds_read_b64_tr_b16 a[252:253], v12 offset:10752
    v_mfma_f32_16x16x32_bf16 v[244:247], a[76:79], a[20:23], v[244:247]
    ds_read_b64_tr_b16 a[254:255], v12 offset:25088
    v_mfma_f32_16x16x32_bf16 v[240:243], a[76:79], a[16:19], v[240:243]
    ds_read_b64_tr_b16 a[64:65], v12 offset:32
    v_mfma_f32_16x16x32_bf16 v[240:243], a[72:75], a[0:3], v[240:243]
    s_waitcnt lgkmcnt(7)
    ds_read_b64_tr_b16 a[66:67], v12 offset:14368
    v_mfma_f32_16x16x32_bf16 v[32:35], a[80:83], a[32:35], v[32:35]
    s_waitcnt lgkmcnt(6)
    ds_read_b64_tr_b16 a[68:69], v12 offset:3616
    v_mfma_f32_16x16x32_bf16 v[32:35], a[84:87], a[48:51], v[32:35]
    buffer_load_dwordx4 v2, s[8:11], s55 offen offset:3072 lds
    v_mfma_f32_16x16x32_bf16 v[36:39], a[84:87], a[52:55], v[36:39]
    ds_read_b64_tr_b16 a[70:71], v12 offset:17952
    v_mfma_f32_16x16x32_bf16 v[36:39], a[80:83], a[36:39], v[36:39]
    s_add_u32 m0, s57, 131072
    v_mfma_f32_16x16x32_bf16 v[40:43], a[80:83], a[40:43], v[40:43]
    s_bfe_u32 s72, s70, 0x40010
    ds_read_b64_tr_b16 a[72:73], v12 offset:7200
    v_mfma_f32_16x16x32_bf16 v[40:43], a[84:87], a[56:59], v[40:43]
    s_mul_i32 s72, s72, 458752
    ds_read_b64_tr_b16 a[74:75], v12 offset:21536
    v_mfma_f32_16x16x32_bf16 v[44:47], a[84:87], a[60:63], v[44:47]
    ds_read_b64_tr_b16 a[76:77], v12 offset:10784
    v_mfma_f32_16x16x32_bf16 v[44:47], a[80:83], a[44:47], v[44:47]
    s_waitcnt lgkmcnt(9)
    buffer_load_dwordx4 v5, s[12:15], s72 offen offset:0 lds
    v_mfma_f32_16x16x32_bf16 v[60:63], a[248:251], a[44:47], v[60:63]
    s_waitcnt lgkmcnt(7)
    ds_read_b64_tr_b16 a[78:79], v12 offset:25120
    v_mfma_f32_16x16x32_bf16 v[60:63], a[252:255], a[60:63], v[60:63]
    v_mfma_f32_16x16x32_bf16 v[56:59], a[252:255], a[56:59], v[56:59]
    v_mfma_f32_16x16x32_bf16 v[56:59], a[248:251], a[40:43], v[56:59]
    v_mfma_f32_16x16x32_bf16 v[52:55], a[248:251], a[36:39], v[52:55]
    ds_read_b64_tr_b16 a[80:81], v12 offset:64
    v_mfma_f32_16x16x32_bf16 v[52:55], a[252:255], a[52:55], v[52:55]
    buffer_load_dwordx4 v6, s[12:15], s72 offen offset:1024 lds
    v_mfma_f32_16x16x32_bf16 v[48:51], a[252:255], a[48:51], v[48:51]
    ds_read_b64_tr_b16 a[82:83], v12 offset:14400
    v_mfma_f32_16x16x32_bf16 v[48:51], a[248:251], a[32:35], v[48:51]
    s_waitcnt lgkmcnt(8)
    ds_read_b64_tr_b16 a[84:85], v12 offset:3648
    v_mfma_f32_16x16x32_bf16 v[64:67], a[64:67], a[32:35], v[64:67]
    s_waitcnt lgkmcnt(7)
    ds_read_b64_tr_b16 a[86:87], v12 offset:17984
    v_mfma_f32_16x16x32_bf16 v[64:67], a[68:71], a[48:51], v[64:67]
    v_mfma_f32_16x16x32_bf16 v[68:71], a[68:71], a[52:55], v[68:71]
    buffer_load_dwordx4 v7, s[12:15], s72 offen offset:2048 lds
    v_mfma_f32_16x16x32_bf16 v[68:71], a[64:67], a[36:39], v[68:71]
    v_mfma_f32_16x16x32_bf16 v[72:75], a[64:67], a[40:43], v[72:75]
    ds_read_b64_tr_b16 a[248:249], v12 offset:7232
    v_mfma_f32_16x16x32_bf16 v[72:75], a[68:71], a[56:59], v[72:75]
    ds_read_b64_tr_b16 a[250:251], v12 offset:21568
    v_mfma_f32_16x16x32_bf16 v[76:79], a[68:71], a[60:63], v[76:79]
    ds_read_b64_tr_b16 a[252:253], v12 offset:10816
    v_mfma_f32_16x16x32_bf16 v[76:79], a[64:67], a[44:47], v[76:79]
    s_waitcnt lgkmcnt(9)
    ds_read_b64_tr_b16 a[254:255], v12 offset:25152
    v_mfma_f32_16x16x32_bf16 v[92:95], a[72:75], a[44:47], v[92:95]
    s_waitcnt lgkmcnt(8)
    buffer_load_dwordx4 v8, s[12:15], s72 offen offset:3072 lds
    v_mfma_f32_16x16x32_bf16 v[92:95], a[76:79], a[60:63], v[92:95]
    v_mfma_f32_16x16x32_bf16 v[88:91], a[76:79], a[56:59], v[88:91]
    v_mfma_f32_16x16x32_bf16 v[88:91], a[72:75], a[40:43], v[88:91]
    v_mfma_f32_16x16x32_bf16 v[84:87], a[72:75], a[36:39], v[84:87]
    s_add_u32 m0, s57, 135168
    ds_read_b64_tr_b16 a[64:65], v12 offset:96
    v_mfma_f32_16x16x32_bf16 v[84:87], a[76:79], a[52:55], v[84:87]
    ds_read_b64_tr_b16 a[66:67], v12 offset:14432
    v_mfma_f32_16x16x32_bf16 v[80:83], a[76:79], a[48:51], v[80:83]
    buffer_load_dwordx4 v9, s[12:15], s72 offen offset:0 lds
    v_mfma_f32_16x16x32_bf16 v[80:83], a[72:75], a[32:35], v[80:83]
    s_waitcnt lgkmcnt(8)
    ds_read_b64_tr_b16 a[68:69], v12 offset:3680
    v_mfma_f32_16x16x32_bf16 v[96:99], a[80:83], a[32:35], v[96:99]
    s_waitcnt lgkmcnt(7)
    ds_read_b64_tr_b16 a[70:71], v12 offset:18016
    v_mfma_f32_16x16x32_bf16 v[96:99], a[84:87], a[48:51], v[96:99]
    s_waitcnt vmcnt(14)
    v_mfma_f32_16x16x32_bf16 v[100:103], a[84:87], a[52:55], v[100:103]
    ds_read_b128 a[0:3], v3 offset:8192
    v_mfma_f32_16x16x32_bf16 v[100:103], a[80:83], a[36:39], v[100:103]
    ds_read_b128 a[16:19], v4 offset:8192
    v_mfma_f32_16x16x32_bf16 v[104:107], a[80:83], a[40:43], v[104:107]
    buffer_load_dwordx4 v10, s[12:15], s72 offen offset:1024 lds
    v_mfma_f32_16x16x32_bf16 v[104:107], a[84:87], a[56:59], v[104:107]
    ds_read_b128 a[4:7], v3 offset:10240
    v_mfma_f32_16x16x32_bf16 v[108:111], a[84:87], a[60:63], v[108:111]
    ds_read_b128 a[20:23], v4 offset:10240
    v_mfma_f32_16x16x32_bf16 v[108:111], a[80:83], a[44:47], v[108:111]
    s_waitcnt lgkmcnt(10)
    ds_read_b64_tr_b16 a[72:73], v12 offset:7264
    v_mfma_f32_16x16x32_bf16 v[124:127], a[248:251], a[44:47], v[124:127]
    s_waitcnt lgkmcnt(9)
    ds_read_b64_tr_b16 a[74:75], v12 offset:21600
    v_mfma_f32_16x16x32_bf16 v[124:127], a[252:255], a[60:63], v[124:127]
    ds_read_b64_tr_b16 a[76:77], v12 offset:10848
    v_mfma_f32_16x16x32_bf16 v[120:123], a[252:255], a[56:59], v[120:123]
    buffer_load_dwordx4 v11, s[12:15], s72 offen offset:2048 lds
    s_add_u32 m0, s56, 4096
    v_mfma_f32_16x16x32_bf16 v[120:123], a[248:251], a[40:43], v[120:123]
    s_bfe_u32 s73, s70, 0x40014
    ds_read_b64_tr_b16 a[78:79], v12 offset:25184
    v_mfma_f32_16x16x32_bf16 v[116:119], a[248:251], a[36:39], v[116:119]
    s_lshl_b32 s73, s73, 7
    ds_read_b64_tr_b16 a[80:81], v12 offset:128
    v_mfma_f32_16x16x32_bf16 v[116:119], a[252:255], a[52:55], v[116:119]
    s_add_u32 s8, s6, s73
    s_addc_u32 s9, s7, 0
    ds_read_b64_tr_b16 a[82:83], v12 offset:14464
    v_mfma_f32_16x16x32_bf16 v[112:115], a[252:255], a[48:51], v[112:115]
    ds_read_b64_tr_b16 a[84:85], v12 offset:3712
    v_mfma_f32_16x16x32_bf16 v[112:115], a[248:251], a[32:35], v[112:115]
    s_waitcnt lgkmcnt(13)
    buffer_load_dwordx4 v1, s[8:11], s48 offen offset:0 lds
    v_mfma_f32_16x16x32_bf16 v[128:131], a[64:67], a[32:35], v[128:131]
    s_waitcnt lgkmcnt(11)
    ds_read_b64_tr_b16 a[86:87], v12 offset:18048
    v_mfma_f32_16x16x32_bf16 v[128:131], a[68:71], a[48:51], v[128:131]
    v_mfma_f32_16x16x32_bf16 v[132:135], a[68:71], a[52:55], v[132:135]
    v_mfma_f32_16x16x32_bf16 v[132:135], a[64:67], a[36:39], v[132:135]
    v_mfma_f32_16x16x32_bf16 v[136:139], a[64:67], a[40:43], v[136:139]
    ds_read_b64_tr_b16 a[248:249], v12 offset:7296
    v_mfma_f32_16x16x32_bf16 v[136:139], a[68:71], a[56:59], v[136:139]
    buffer_load_dwordx4 v2, s[8:11], s49 offen offset:1024 lds
    v_mfma_f32_16x16x32_bf16 v[140:143], a[68:71], a[60:63], v[140:143]
    ds_read_b64_tr_b16 a[250:251], v12 offset:21632
    v_mfma_f32_16x16x32_bf16 v[140:143], a[64:67], a[44:47], v[140:143]
    s_waitcnt lgkmcnt(8)
    ds_read_b64_tr_b16 a[252:253], v12 offset:10880
    v_mfma_f32_16x16x32_bf16 v[156:159], a[72:75], a[44:47], v[156:159]
    s_waitcnt lgkmcnt(7)
    ds_read_b64_tr_b16 a[254:255], v12 offset:25216
    v_mfma_f32_16x16x32_bf16 v[156:159], a[76:79], a[60:63], v[156:159]
    v_mfma_f32_16x16x32_bf16 v[152:155], a[76:79], a[56:59], v[152:155]
    v_mfma_f32_16x16x32_bf16 v[152:155], a[72:75], a[40:43], v[152:155]
    buffer_load_dwordx4 v1, s[8:11], s50 offen offset:2048 lds
    v_mfma_f32_16x16x32_bf16 v[148:151], a[72:75], a[36:39], v[148:151]
    ds_read_b64_tr_b16 a[64:65], v12 offset:160
    v_mfma_f32_16x16x32_bf16 v[148:151], a[76:79], a[52:55], v[148:151]
    ds_read_b64_tr_b16 a[66:67], v12 offset:14496
    v_mfma_f32_16x16x32_bf16 v[144:147], a[76:79], a[48:51], v[144:147]
    ds_read_b64_tr_b16 a[68:69], v12 offset:3744
    v_mfma_f32_16x16x32_bf16 v[144:147], a[72:75], a[32:35], v[144:147]
    s_waitcnt lgkmcnt(9)
    ds_read_b64_tr_b16 a[70:71], v12 offset:18080
    s_waitcnt vmcnt(13)
    v_mfma_f32_16x16x32_bf16 v[160:163], a[80:83], a[32:35], v[160:163]
    s_waitcnt lgkmcnt(8)
    ds_read_b64_tr_b16 a[104:105], v14 offset:12288
    v_mfma_f32_16x16x32_bf16 v[160:163], a[84:87], a[48:51], v[160:163]
    buffer_load_dwordx4 v2, s[8:11], s51 offen offset:3072 lds
    v_mfma_f32_16x16x32_bf16 v[164:167], a[84:87], a[52:55], v[164:167]
    ds_read_b64_tr_b16 a[108:109], v15 offset:12288
    v_mfma_f32_16x16x32_bf16 v[164:167], a[80:83], a[36:39], v[164:167]
    ds_read_b64_tr_b16 a[112:113], v16 offset:12288
    v_mfma_f32_16x16x32_bf16 v[168:171], a[80:83], a[40:43], v[168:171]
    ds_read_b64_tr_b16 a[116:117], v17 offset:12288
    v_mfma_f32_16x16x32_bf16 v[168:171], a[84:87], a[56:59], v[168:171]
    s_add_u32 m0, s56, 8192
    ds_read_b64_tr_b16 a[106:107], v14 offset:14336
    v_mfma_f32_16x16x32_bf16 v[172:175], a[84:87], a[60:63], v[172:175]
    ds_read_b64_tr_b16 a[110:111], v15 offset:14336
    v_mfma_f32_16x16x32_bf16 v[172:175], a[80:83], a[44:47], v[172:175]
    s_waitcnt lgkmcnt(12)
    buffer_load_dwordx4 v1, s[8:11], s52 offen offset:0 lds
    v_mfma_f32_16x16x32_bf16 v[188:191], a[248:251], a[44:47], v[188:191]
    s_waitcnt lgkmcnt(10)
    ds_read_b64_tr_b16 a[114:115], v16 offset:14336
    v_mfma_f32_16x16x32_bf16 v[188:191], a[252:255], a[60:63], v[188:191]
    ds_read_b64_tr_b16 a[118:119], v17 offset:14336
    v_mfma_f32_16x16x32_bf16 v[184:187], a[252:255], a[56:59], v[184:187]
    ds_read_b64_tr_b16 a[72:73], v12 offset:7328
    v_mfma_f32_16x16x32_bf16 v[184:187], a[248:251], a[40:43], v[184:187]
    ds_read_b64_tr_b16 a[74:75], v12 offset:21664
    v_mfma_f32_16x16x32_bf16 v[180:183], a[248:251], a[36:39], v[180:183]
    buffer_load_dwordx4 v2, s[8:11], s53 offen offset:1024 lds
    v_mfma_f32_16x16x32_bf16 v[180:183], a[252:255], a[52:55], v[180:183]
    ds_read_b64_tr_b16 a[76:77], v12 offset:10912
    v_mfma_f32_16x16x32_bf16 v[176:179], a[252:255], a[48:51], v[176:179]
    ds_read_b64_tr_b16 a[78:79], v12 offset:25248
    v_mfma_f32_16x16x32_bf16 v[176:179], a[248:251], a[32:35], v[176:179]
    s_waitcnt lgkmcnt(14)
    ds_read_b64_tr_b16 a[80:81], v12 offset:192
    v_mfma_f32_16x16x32_bf16 v[192:195], a[64:67], a[32:35], v[192:195]
    s_waitcnt lgkmcnt(13)
    ds_read_b64_tr_b16 a[82:83], v12 offset:14528
    v_mfma_f32_16x16x32_bf16 v[192:195], a[68:71], a[48:51], v[192:195]
    ds_read_b64_tr_b16 a[84:85], v12 offset:3776
    v_mfma_f32_16x16x32_bf16 v[196:199], a[68:71], a[52:55], v[196:199]
    buffer_load_dwordx4 v1, s[8:11], s54 offen offset:2048 lds
    v_mfma_f32_16x16x32_bf16 v[196:199], a[64:67], a[36:39], v[196:199]
    ds_read_b64_tr_b16 a[86:87], v12 offset:18112
    v_mfma_f32_16x16x32_bf16 v[200:203], a[64:67], a[40:43], v[200:203]
    ds_read_b64_tr_b16 a[248:249], v12 offset:7360
    v_mfma_f32_16x16x32_bf16 v[200:203], a[68:71], a[56:59], v[200:203]
    ds_read_b64_tr_b16 a[250:251], v12 offset:21696
    v_mfma_f32_16x16x32_bf16 v[204:207], a[68:71], a[60:63], v[204:207]
    ds_read_b64_tr_b16 a[252:253], v12 offset:10944
    v_mfma_f32_16x16x32_bf16 v[204:207], a[64:67], a[44:47], v[204:207]
    s_waitcnt lgkmcnt(9)
    ds_read_b64_tr_b16 a[254:255], v12 offset:25280
    v_mfma_f32_16x16x32_bf16 v[220:223], a[72:75], a[44:47], v[220:223]
    s_waitcnt lgkmcnt(8)
    buffer_load_dwordx4 v2, s[8:11], s55 offen offset:3072 lds
    v_mfma_f32_16x16x32_bf16 v[220:223], a[76:79], a[60:63], v[220:223]
    s_waitcnt vmcnt(15)
    v_mfma_f32_16x16x32_bf16 v[216:219], a[76:79], a[56:59], v[216:219]
    s_add_u32 m0, s57, 94208
    ds_read_b128 a[8:11], v3 offset:0
    v_mfma_f32_16x16x32_bf16 v[216:219], a[72:75], a[40:43], v[216:219]
    s_bfe_u32 s72, s70, 0x40014
    ds_read_b128 a[24:27], v4 offset:0
    v_mfma_f32_16x16x32_bf16 v[212:215], a[72:75], a[36:39], v[212:215]
    s_mul_i32 s72, s72, 458752
    ds_read_b128 a[12:15], v3 offset:2048
    v_mfma_f32_16x16x32_bf16 v[212:215], a[76:79], a[52:55], v[212:215]
    ds_read_b128 a[28:31], v4 offset:2048
    v_mfma_f32_16x16x32_bf16 v[208:211], a[76:79], a[48:51], v[208:211]
    buffer_load_dwordx4 v5, s[12:15], s72 offen offset:0 lds
    v_mfma_f32_16x16x32_bf16 v[208:211], a[72:75], a[32:35], v[208:211]
    s_waitcnt lgkmcnt(10)
    v_mfma_f32_16x16x32_bf16 v[224:227], a[80:83], a[32:35], v[224:227]
    s_waitcnt lgkmcnt(8)
    v_mfma_f32_16x16x32_bf16 v[224:227], a[84:87], a[48:51], v[224:227]
    v_mfma_f32_16x16x32_bf16 v[228:231], a[84:87], a[52:55], v[228:231]
    s_waitcnt vmcnt(9) lgkmcnt(4)
    v_mfma_f32_16x16x32_bf16 v[228:231], a[80:83], a[36:39], v[228:231]
    s_barrier
    v_mfma_f32_16x16x32_bf16 v[232:235], a[80:83], a[40:43], v[232:235]
    buffer_load_dwordx4 v6, s[12:15], s72 offen offset:1024 lds
    v_mfma_f32_16x16x32_bf16 v[232:235], a[84:87], a[56:59], v[232:235]
    ds_read_b64_tr_b16 a[64:65], v30 offset:0
    v_mfma_f32_16x16x32_bf16 v[236:239], a[84:87], a[60:63], v[236:239]
    ds_read_b64_tr_b16 a[66:67], v30 offset:14336
    v_mfma_f32_16x16x32_bf16 v[236:239], a[80:83], a[44:47], v[236:239]
    ds_read_b64_tr_b16 a[68:69], v30 offset:3584
    v_mfma_f32_16x16x32_bf16 v[252:255], a[248:251], a[44:47], v[252:255]
    ds_read_b64_tr_b16 a[70:71], v30 offset:17920
    v_mfma_f32_16x16x32_bf16 v[252:255], a[252:255], a[60:63], v[252:255]
    buffer_load_dwordx4 v7, s[12:15], s72 offen offset:2048 lds
    v_mfma_f32_16x16x32_bf16 v[248:251], a[252:255], a[56:59], v[248:251]
    ds_read_b64_tr_b16 a[72:73], v30 offset:7168
    v_mfma_f32_16x16x32_bf16 v[248:251], a[248:251], a[40:43], v[248:251]
    ds_read_b64_tr_b16 a[74:75], v30 offset:21504
    v_mfma_f32_16x16x32_bf16 v[244:247], a[248:251], a[36:39], v[244:247]
    ds_read_b64_tr_b16 a[76:77], v30 offset:10752
    v_mfma_f32_16x16x32_bf16 v[244:247], a[252:255], a[52:55], v[244:247]
    ds_read_b64_tr_b16 a[78:79], v30 offset:25088
    v_mfma_f32_16x16x32_bf16 v[240:243], a[252:255], a[48:51], v[240:243]
    ds_read_b64_tr_b16 a[80:81], v30 offset:32
    v_mfma_f32_16x16x32_bf16 v[240:243], a[248:251], a[32:35], v[240:243]
    s_waitcnt lgkmcnt(7)
    buffer_load_dwordx4 v8, s[12:15], s72 offen offset:3072 lds
    v_mfma_f32_16x16x32_bf16 v[32:35], a[64:67], a[0:3], v[32:35]
    s_waitcnt lgkmcnt(5)
    ds_read_b64_tr_b16 a[82:83], v30 offset:14368
    v_mfma_f32_16x16x32_bf16 v[32:35], a[68:71], a[16:19], v[32:35]
    ds_read_b64_tr_b16 a[84:85], v30 offset:3616
    v_mfma_f32_16x16x32_bf16 v[36:39], a[68:71], a[20:23], v[36:39]
    ds_read_b64_tr_b16 a[86:87], v30 offset:17952
    v_mfma_f32_16x16x32_bf16 v[36:39], a[64:67], a[4:7], v[36:39]
    s_add_u32 m0, s57, 98304
    v_mfma_f32_16x16x32_bf16 v[40:43], a[64:67], a[8:11], v[40:43]
    ds_read_b64_tr_b16 a[248:249], v30 offset:7200
    v_mfma_f32_16x16x32_bf16 v[40:43], a[68:71], a[24:27], v[40:43]
    buffer_load_dwordx4 v9, s[12:15], s72 offen offset:0 lds
    v_mfma_f32_16x16x32_bf16 v[44:47], a[68:71], a[28:31], v[44:47]
    ds_read_b64_tr_b16 a[250:251], v30 offset:21536
    v_mfma_f32_16x16x32_bf16 v[44:47], a[64:67], a[12:15], v[44:47]
    s_waitcnt lgkmcnt(8)
    ds_read_b64_tr_b16 a[252:253], v30 offset:10784
    v_mfma_f32_16x16x32_bf16 v[60:63], a[72:75], a[12:15], v[60:63]
    s_waitcnt lgkmcnt(7)
    ds_read_b64_tr_b16 a[254:255], v30 offset:25120
    v_mfma_f32_16x16x32_bf16 v[60:63], a[76:79], a[28:31], v[60:63]
    v_mfma_f32_16x16x32_bf16 v[56:59], a[76:79], a[24:27], v[56:59]
    v_mfma_f32_16x16x32_bf16 v[56:59], a[72:75], a[8:11], v[56:59]
    buffer_load_dwordx4 v10, s[12:15], s72 offen offset:1024 lds
    v_mfma_f32_16x16x32_bf16 v[52:55], a[72:75], a[4:7], v[52:55]
    ds_read_b64_tr_b16 a[64:65], v30 offset:64
    v_mfma_f32_16x16x32_bf16 v[52:55], a[76:79], a[20:23], v[52:55]
    ds_read_b64_tr_b16 a[66:67], v30 offset:14400
    v_mfma_f32_16x16x32_bf16 v[48:51], a[76:79], a[16:19], v[48:51]
    ds_read_b64_tr_b16 a[68:69], v30 offset:3648
    v_mfma_f32_16x16x32_bf16 v[48:51], a[72:75], a[0:3], v[48:51]
    s_waitcnt lgkmcnt(9)
    ds_read_b64_tr_b16 a[70:71], v30 offset:17984
    v_mfma_f32_16x16x32_bf16 v[64:67], a[80:83], a[0:3], v[64:67]
    s_waitcnt lgkmcnt(8)
    v_mfma_f32_16x16x32_bf16 v[64:67], a[84:87], a[16:19], v[64:67]
    buffer_load_dwordx4 v11, s[12:15], s72 offen offset:2048 lds
    v_mfma_f32_16x16x32_bf16 v[68:71], a[84:87], a[20:23], v[68:71]
    v_mfma_f32_16x16x32_bf16 v[68:71], a[80:83], a[4:7], v[68:71]
    s_add_u32 m0, s56, 12288
    v_mfma_f32_16x16x32_bf16 v[72:75], a[80:83], a[8:11], v[72:75]
    s_lshl1_add_u32 s68, s76, 0
    ds_read_b64_tr_b16 a[72:73], v30 offset:7232
    v_mfma_f32_16x16x32_bf16 v[72:75], a[84:87], a[24:27], v[72:75]
    ds_read_b64_tr_b16 a[74:75], v30 offset:21568
    v_mfma_f32_16x16x32_bf16 v[76:79], a[84:87], a[28:31], v[76:79]
    buffer_load_dwordx4 v13, s[16:19], s68 offen offset:0 lds
    v_mfma_f32_16x16x32_bf16 v[76:79], a[80:83], a[12:15], v[76:79]
    s_waitcnt lgkmcnt(8)
    ds_read_b64_tr_b16 a[76:77], v30 offset:10816
    v_mfma_f32_16x16x32_bf16 v[92:95], a[248:251], a[12:15], v[92:95]
    s_waitcnt lgkmcnt(7)
    ds_read_b64_tr_b16 a[78:79], v30 offset:25152
    v_mfma_f32_16x16x32_bf16 v[92:95], a[252:255], a[28:31], v[92:95]
    v_mfma_f32_16x16x32_bf16 v[88:91], a[252:255], a[24:27], v[88:91]
    s_lshl1_add_u32 s68, s76, 228352
    v_mfma_f32_16x16x32_bf16 v[88:91], a[248:251], a[8:11], v[88:91]
    v_mfma_f32_16x16x32_bf16 v[84:87], a[248:251], a[4:7], v[84:87]
    buffer_load_dwordx4 v13, s[16:19], s68 offen offset:1024 lds
    v_mfma_f32_16x16x32_bf16 v[84:87], a[252:255], a[20:23], v[84:87]
    ds_read_b64_tr_b16 a[80:81], v30 offset:96
    v_mfma_f32_16x16x32_bf16 v[80:83], a[252:255], a[16:19], v[80:83]
    ds_read_b64_tr_b16 a[82:83], v30 offset:14432
    v_mfma_f32_16x16x32_bf16 v[80:83], a[248:251], a[0:3], v[80:83]
    s_waitcnt lgkmcnt(8)
    ds_read_b64_tr_b16 a[84:85], v30 offset:3680
    v_mfma_f32_16x16x32_bf16 v[96:99], a[64:67], a[0:3], v[96:99]
    s_waitcnt lgkmcnt(7)
    ds_read_b64_tr_b16 a[86:87], v30 offset:18016
    s_lshl1_add_u32 s68, s76, 14336
    v_mfma_f32_16x16x32_bf16 v[96:99], a[68:71], a[16:19], v[96:99]
    s_waitcnt vmcnt(13)
    v_mfma_f32_16x16x32_bf16 v[100:103], a[68:71], a[20:23], v[100:103]
    buffer_load_dwordx4 v13, s[16:19], s68 offen offset:2048 lds
    v_mfma_f32_16x16x32_bf16 v[100:103], a[64:67], a[4:7], v[100:103]
    ds_read_b128 a[32:35], v3 offset:4096
    v_mfma_f32_16x16x32_bf16 v[104:107], a[64:67], a[8:11], v[104:107]
    ds_read_b128 a[48:51], v4 offset:4096
    v_mfma_f32_16x16x32_bf16 v[104:107], a[68:71], a[24:27], v[104:107]
    ds_read_b128 a[36:39], v3 offset:6144
    v_mfma_f32_16x16x32_bf16 v[108:111], a[68:71], a[28:31], v[108:111]
    s_lshl1_add_u32 s68, s76, 242688
    ds_read_b128 a[52:55], v4 offset:6144
    v_mfma_f32_16x16x32_bf16 v[108:111], a[64:67], a[12:15], v[108:111]
    s_waitcnt lgkmcnt(10)
    ds_read_b64_tr_b16 a[248:249], v30 offset:7264
    v_mfma_f32_16x16x32_bf16 v[124:127], a[72:75], a[12:15], v[124:127]
    s_waitcnt lgkmcnt(9)
    buffer_load_dwordx4 v13, s[16:19], s68 offen offset:3072 lds
    v_mfma_f32_16x16x32_bf16 v[124:127], a[76:79], a[28:31], v[124:127]
    s_mov_b32 m0, s56
    ds_read_b64_tr_b16 a[250:251], v30 offset:21600
    v_mfma_f32_16x16x32_bf16 v[120:123], a[76:79], a[24:27], v[120:123]
    s_bfe_u32 s73, s70, 0x40018
    ds_read_b64_tr_b16 a[252:253], v30 offset:10848
    v_mfma_f32_16x16x32_bf16 v[120:123], a[72:75], a[8:11], v[120:123]
    s_lshl_b32 s73, s73, 7
    ds_read_b64_tr_b16 a[254:255], v30 offset:25184
    v_mfma_f32_16x16x32_bf16 v[116:119], a[72:75], a[4:7], v[116:119]
    s_add_u32 s8, s6, s73
    s_addc_u32 s9, s7, 0
    ds_read_b64_tr_b16 a[64:65], v30 offset:128
    v_mfma_f32_16x16x32_bf16 v[116:119], a[76:79], a[20:23], v[116:119]
L_pad2:
    s_cbranch_vccnz L_pad6
    ds_read_b64_tr_b16 a[66:67], v30 offset:14464
    v_mfma_f32_16x16x32_bf16 v[112:115], a[76:79], a[16:19], v[112:115]
    buffer_load_dwordx4 v1, s[8:11], s48 offen offset:0 lds
    v_mfma_f32_16x16x32_bf16 v[112:115], a[72:75], a[0:3], v[112:115]
    s_waitcnt lgkmcnt(12)
    ds_read_b64_tr_b16 a[68:69], v30 offset:3712
    v_mfma_f32_16x16x32_bf16 v[128:131], a[80:83], a[0:3], v[128:131]
    s_waitcnt lgkmcnt(11)
    ds_read_b64_tr_b16 a[70:71], v30 offset:18048
    v_mfma_f32_16x16x32_bf16 v[128:131], a[84:87], a[16:19], v[128:131]
    v_mfma_f32_16x16x32_bf16 v[132:135], a[84:87], a[20:23], v[132:135]
    v_mfma_f32_16x16x32_bf16 v[132:135], a[80:83], a[4:7], v[132:135]
    buffer_load_dwordx4 v2, s[8:11], s49 offen offset:1024 lds
    v_mfma_f32_16x16x32_bf16 v[136:139], a[80:83], a[8:11], v[136:139]
    ds_read_b64_tr_b16 a[72:73], v30 offset:7296
    v_mfma_f32_16x16x32_bf16 v[136:139], a[84:87], a[24:27], v[136:139]
    ds_read_b64_tr_b16 a[74:75], v30 offset:21632
    v_mfma_f32_16x16x32_bf16 v[140:143], a[84:87], a[28:31], v[140:143]
    ds_read_b64_tr_b16 a[76:77], v30 offset:10880
    v_mfma_f32_16x16x32_bf16 v[140:143], a[80:83], a[12:15], v[140:143]
    s_waitcnt lgkmcnt(9)
    ds_read_b64_tr_b16 a[78:79], v30 offset:25216
    v_mfma_f32_16x16x32_bf16 v[156:159], a[248:251], a[12:15], v[156:159]
    s_waitcnt lgkmcnt(8)
    v_mfma_f32_16x16x32_bf16 v[156:159], a[252:255], a[28:31], v[156:159]
    buffer_load_dwordx4 v1, s[8:11], s50 offen offset:2048 lds
    v_mfma_f32_16x16x32_bf16 v[152:155], a[252:255], a[24:27], v[152:155]
    v_mfma_f32_16x16x32_bf16 v[152:155], a[248:251], a[8:11], v[152:155]
    v_mfma_f32_16x16x32_bf16 v[148:151], a[248:251], a[4:7], v[148:151]
    ds_read_b64_tr_b16 a[80:81], v30 offset:160
    v_mfma_f32_16x16x32_bf16 v[148:151], a[252:255], a[20:23], v[148:151]
    ds_read_b64_tr_b16 a[82:83], v30 offset:14496
    v_mfma_f32_16x16x32_bf16 v[144:147], a[252:255], a[16:19], v[144:147]
    ds_read_b64_tr_b16 a[84:85], v30 offset:3744
    v_mfma_f32_16x16x32_bf16 v[144:147], a[248:251], a[0:3], v[144:147]
    s_waitcnt lgkmcnt(9)
    buffer_load_dwordx4 v2, s[8:11], s51 offen offset:3072 lds
    v_mfma_f32_16x16x32_bf16 v[160:163], a[64:67], a[0:3], v[160:163]
    s_waitcnt lgkmcnt(7)
    ds_read_b64_tr_b16 a[86:87], v30 offset:18080
    v_mfma_f32_16x16x32_bf16 v[160:163], a[68:71], a[16:19], v[160:163]
    v_mfma_f32_16x16x32_bf16 v[164:167], a[68:71], a[20:23], v[164:167]
    v_mfma_f32_16x16x32_bf16 v[164:167], a[64:67], a[4:7], v[164:167]
    s_add_u32 m0, s56, 4096
    v_mfma_f32_16x16x32_bf16 v[168:171], a[64:67], a[8:11], v[168:171]
    ds_read_b64_tr_b16 a[248:249], v30 offset:7328
    v_mfma_f32_16x16x32_bf16 v[168:171], a[68:71], a[24:27], v[168:171]
    buffer_load_dwordx4 v1, s[8:11], s52 offen offset:0 lds
    v_mfma_f32_16x16x32_bf16 v[172:175], a[68:71], a[28:31], v[172:175]
    ds_read_b64_tr_b16 a[250:251], v30 offset:21664
    v_mfma_f32_16x16x32_bf16 v[172:175], a[64:67], a[12:15], v[172:175]
    s_waitcnt lgkmcnt(8)
    ds_read_b64_tr_b16 a[252:253], v30 offset:10912
    v_mfma_f32_16x16x32_bf16 v[188:191], a[72:75], a[12:15], v[188:191]
    s_waitcnt lgkmcnt(7)
    ds_read_b64_tr_b16 a[254:255], v30 offset:25248
    v_mfma_f32_16x16x32_bf16 v[188:191], a[76:79], a[28:31], v[188:191]
    v_mfma_f32_16x16x32_bf16 v[184:187], a[76:79], a[24:27], v[184:187]
    v_mfma_f32_16x16x32_bf16 v[184:187], a[72:75], a[8:11], v[184:187]
    buffer_load_dwordx4 v2, s[8:11], s53 offen offset:1024 lds
    v_mfma_f32_16x16x32_bf16 v[180:183], a[72:75], a[4:7], v[180:183]
    ds_read_b64_tr_b16 a[64:65], v30 offset:192
    v_mfma_f32_16x16x32_bf16 v[180:183], a[76:79], a[20:23], v[180:183]
    ds_read_b64_tr_b16 a[66:67], v30 offset:14528
    v_mfma_f32_16x16x32_bf16 v[176:179], a[76:79], a[16:19], v[176:179]
    ds_read_b64_tr_b16 a[68:69], v30 offset:3776
    v_mfma_f32_16x16x32_bf16 v[176:179], a[72:75], a[0:3], v[176:179]
    s_waitcnt lgkmcnt(9)
    ds_read_b64_tr_b16 a[70:71], v30 offset:18112
    v_mfma_f32_16x16x32_bf16 v[192:195], a[80:83], a[0:3], v[192:195]
    s_waitcnt lgkmcnt(8)
    buffer_load_dwordx4 v1, s[8:11], s54 offen offset:2048 lds
    v_mfma_f32_16x16x32_bf16 v[192:195], a[84:87], a[16:19], v[192:195]
    v_mfma_f32_16x16x32_bf16 v[196:199], a[84:87], a[20:23], v[196:199]
    v_mfma_f32_16x16x32_bf16 v[196:199], a[80:83], a[4:7], v[196:199]
    v_mfma_f32_16x16x32_bf16 v[200:203], a[80:83], a[8:11], v[200:203]
    ds_read_b64_tr_b16 a[72:73], v30 offset:7360
    v_mfma_f32_16x16x32_bf16 v[200:203], a[84:87], a[24:27], v[200:203]
    ds_read_b64_tr_b16 a[74:75], v30 offset:21696
    v_mfma_f32_16x16x32_bf16 v[204:207], a[84:87], a[28:31], v[204:207]
    buffer_load_dwordx4 v2, s[8:11], s55 offen offset:3072 lds
    v_mfma_f32_16x16x32_bf16 v[204:207], a[80:83], a[12:15], v[204:207]
    s_waitcnt lgkmcnt(8)
    ds_read_b64_tr_b16 a[76:77], v30 offset:10944
    v_mfma_f32_16x16x32_bf16 v[220:223], a[248:251], a[12:15], v[220:223]
    s_waitcnt lgkmcnt(7)
    ds_read_b64_tr_b16 a[78:79], v30 offset:25280
    s_add_u32 m0, s57, 65536
    v_mfma_f32_16x16x32_bf16 v[220:223], a[252:255], a[28:31], v[220:223]
    s_waitcnt vmcnt(19)
    s_bfe_u32 s72, s70, 0x40018
    v_mfma_f32_16x16x32_bf16 v[216:219], a[252:255], a[24:27], v[216:219]
    s_mul_i32 s72, s72, 458752
    ds_read_b128 a[40:43], v3 offset:8192
    v_mfma_f32_16x16x32_bf16 v[216:219], a[248:251], a[8:11], v[216:219]
    ds_read_b128 a[56:59], v4 offset:8192
    v_mfma_f32_16x16x32_bf16 v[212:215], a[248:251], a[4:7], v[212:215]
    buffer_load_dwordx4 v5, s[12:15], s72 offen offset:0 lds
    v_mfma_f32_16x16x32_bf16 v[212:215], a[252:255], a[20:23], v[212:215]
    ds_read_b128 a[44:47], v3 offset:10240
    v_mfma_f32_16x16x32_bf16 v[208:211], a[252:255], a[16:19], v[208:211]
    ds_read_b128 a[60:63], v4 offset:10240
    v_mfma_f32_16x16x32_bf16 v[208:211], a[248:251], a[0:3], v[208:211]
    s_waitcnt lgkmcnt(10)
    v_mfma_f32_16x16x32_bf16 v[224:227], a[64:67], a[0:3], v[224:227]
    s_waitcnt lgkmcnt(8)
    v_mfma_f32_16x16x32_bf16 v[224:227], a[68:71], a[16:19], v[224:227]
    v_mfma_f32_16x16x32_bf16 v[228:231], a[68:71], a[20:23], v[228:231]
    s_waitcnt vmcnt(13) lgkmcnt(4)
    buffer_load_dwordx4 v6, s[12:15], s72 offen offset:1024 lds
    v_mfma_f32_16x16x32_bf16 v[228:231], a[64:67], a[4:7], v[228:231]
    s_barrier
    v_mfma_f32_16x16x32_bf16 v[232:235], a[64:67], a[8:11], v[232:235]
    ds_read_b64_tr_b16 a[80:81], v12 offset:28672
    v_mfma_f32_16x16x32_bf16 v[232:235], a[68:71], a[24:27], v[232:235]
    ds_read_b64_tr_b16 a[82:83], v12 offset:43008
    v_mfma_f32_16x16x32_bf16 v[236:239], a[68:71], a[28:31], v[236:239]
    ds_read_b64_tr_b16 a[84:85], v12 offset:32256
    v_mfma_f32_16x16x32_bf16 v[236:239], a[64:67], a[12:15], v[236:239]
    ds_read_b64_tr_b16 a[86:87], v12 offset:46592
    v_mfma_f32_16x16x32_bf16 v[252:255], a[72:75], a[12:15], v[252:255]
    buffer_load_dwordx4 v7, s[12:15], s72 offen offset:2048 lds
    v_mfma_f32_16x16x32_bf16 v[252:255], a[76:79], a[28:31], v[252:255]
    ds_read_b64_tr_b16 a[248:249], v12 offset:35840
    v_mfma_f32_16x16x32_bf16 v[248:251], a[76:79], a[24:27], v[248:251]
    ds_read_b64_tr_b16 a[250:251], v12 offset:50176
    v_mfma_f32_16x16x32_bf16 v[248:251], a[72:75], a[8:11], v[248:251]
    ds_read_b64_tr_b16 a[252:253], v12 offset:39424
    v_mfma_f32_16x16x32_bf16 v[244:247], a[72:75], a[4:7], v[244:247]
    ds_read_b64_tr_b16 a[254:255], v12 offset:53760
    v_mfma_f32_16x16x32_bf16 v[244:247], a[76:79], a[20:23], v[244:247]
    buffer_load_dwordx4 v8, s[12:15], s72 offen offset:3072 lds
    v_mfma_f32_16x16x32_bf16 v[240:243], a[76:79], a[16:19], v[240:243]
    ds_read_b64_tr_b16 a[64:65], v12 offset:28704
    v_mfma_f32_16x16x32_bf16 v[240:243], a[72:75], a[0:3], v[240:243]
    s_waitcnt lgkmcnt(7)
    ds_read_b64_tr_b16 a[66:67], v12 offset:43040
    v_mfma_f32_16x16x32_bf16 v[32:35], a[80:83], a[32:35], v[32:35]
    s_waitcnt lgkmcnt(6)
    ds_read_b64_tr_b16 a[68:69], v12 offset:32288
    v_mfma_f32_16x16x32_bf16 v[32:35], a[84:87], a[48:51], v[32:35]
    s_add_u32 m0, s57, 69632
    ds_read_b64_tr_b16 a[70:71], v12 offset:46624
    v_mfma_f32_16x16x32_bf16 v[36:39], a[84:87], a[52:55], v[36:39]
    v_mfma_f32_16x16x32_bf16 v[36:39], a[80:83], a[36:39], v[36:39]
    buffer_load_dwordx4 v9, s[12:15], s72 offen offset:0 lds
    v_mfma_f32_16x16x32_bf16 v[40:43], a[80:83], a[40:43], v[40:43]
    ds_read_b64_tr_b16 a[72:73], v12 offset:35872
    v_mfma_f32_16x16x32_bf16 v[40:43], a[84:87], a[56:59], v[40:43]
    ds_read_b64_tr_b16 a[74:75], v12 offset:50208
    v_mfma_f32_16x16x32_bf16 v[44:47], a[84:87], a[60:63], v[44:47]
    ds_read_b64_tr_b16 a[76:77], v12 offset:39456
    v_mfma_f32_16x16x32_bf16 v[44:47], a[80:83], a[44:47], v[44:47]
    s_waitcnt lgkmcnt(9)
    ds_read_b64_tr_b16 a[78:79], v12 offset:53792
    s_waitcnt vmcnt(13)
    v_mfma_f32_16x16x32_bf16 v[60:63], a[248:251], a[44:47], v[60:63]
    s_waitcnt lgkmcnt(8)
    ds_read_b64_tr_b16 a[120:121], v14 offset:12288
    v_mfma_f32_16x16x32_bf16 v[60:63], a[252:255], a[60:63], v[60:63]
    buffer_load_dwordx4 v10, s[12:15], s72 offen offset:1024 lds
    v_mfma_f32_16x16x32_bf16 v[56:59], a[252:255], a[56:59], v[56:59]
    ds_read_b64_tr_b16 a[124:125], v15 offset:12288
    v_mfma_f32_16x16x32_bf16 v[56:59], a[248:251], a[40:43], v[56:59]
    ds_read_b64_tr_b16 a[128:129], v16 offset:12288
    v_mfma_f32_16x16x32_bf16 v[52:55], a[248:251], a[36:39], v[52:55]
    ds_read_b64_tr_b16 a[132:133], v17 offset:12288
    v_mfma_f32_16x16x32_bf16 v[52:55], a[252:255], a[52:55], v[52:55]
    ds_read_b64_tr_b16 a[122:123], v14 offset:14336
    v_mfma_f32_16x16x32_bf16 v[48:51], a[252:255], a[48:51], v[48:51]
    ds_read_b64_tr_b16 a[126:127], v15 offset:14336
    v_mfma_f32_16x16x32_bf16 v[48:51], a[248:251], a[32:35], v[48:51]
    s_waitcnt lgkmcnt(12)
    buffer_load_dwordx4 v11, s[12:15], s72 offen offset:2048 lds
    v_mfma_f32_16x16x32_bf16 v[64:67], a[64:67], a[32:35], v[64:67]
    s_waitcnt lgkmcnt(10)
    ds_read_b64_tr_b16 a[130:131], v16 offset:14336
    s_add_u32 m0, s56, 8192
    v_mfma_f32_16x16x32_bf16 v[64:67], a[68:71], a[48:51], v[64:67]
    s_bfe_u32 s73, s70, 0x4001c
    ds_read_b64_tr_b16 a[134:135], v17 offset:14336
    v_mfma_f32_16x16x32_bf16 v[68:71], a[68:71], a[52:55], v[68:71]
    s_lshl_b32 s73, s73, 7
    ds_read_b64_tr_b16 a[80:81], v12 offset:28736
    v_mfma_f32_16x16x32_bf16 v[68:71], a[64:67], a[36:39], v[68:71]
    s_add_u32 s8, s6, s73
    s_addc_u32 s9, s7, 0
    ds_read_b64_tr_b16 a[82:83], v12 offset:43072
    v_mfma_f32_16x16x32_bf16 v[72:75], a[64:67], a[40:43], v[72:75]
    ds_read_b64_tr_b16 a[84:85], v12 offset:32320
    v_mfma_f32_16x16x32_bf16 v[72:75], a[68:71], a[56:59], v[72:75]
    buffer_load_dwordx4 v1, s[8:11], s48 offen offset:0 lds
    v_mfma_f32_16x16x32_bf16 v[76:79], a[68:71], a[60:63], v[76:79]
    ds_read_b64_tr_b16 a[86:87], v12 offset:46656
    v_mfma_f32_16x16x32_bf16 v[76:79], a[64:67], a[44:47], v[76:79]
    s_waitcnt lgkmcnt(14)
    ds_read_b64_tr_b16 a[248:249], v12 offset:35904
    s_add_u32 m0, s56, 12288
    v_mfma_f32_16x16x32_bf16 v[92:95], a[72:75], a[44:47], v[92:95]
    s_waitcnt lgkmcnt(13)
    ds_read_b64_tr_b16 a[250:251], v12 offset:50240
    s_lshl1_add_u32 s68, s77, 0
    v_mfma_f32_16x16x32_bf16 v[92:95], a[76:79], a[60:63], v[92:95]
    s_waitcnt lgkmcnt(6)
    ds_read_b64_tr_b16 a[252:253], v12 offset:39488
    v_mfma_f32_16x16x32_bf16 v[88:91], a[76:79], a[56:59], v[88:91]
    buffer_load_dwordx4 v13, s[16:19], s68 offen offset:0 lds
    v_mfma_f32_16x16x32_bf16 v[88:91], a[72:75], a[40:43], v[88:91]
    ds_read_b64_tr_b16 a[254:255], v12 offset:53824
    v_mfma_f32_16x16x32_bf16 v[84:87], a[72:75], a[36:39], v[84:87]
    ds_read_b64_tr_b16 a[64:65], v12 offset:28768
    v_mfma_f32_16x16x32_bf16 v[84:87], a[76:79], a[52:55], v[84:87]
    ds_read_b64_tr_b16 a[66:67], v12 offset:43104
    v_mfma_f32_16x16x32_bf16 v[80:83], a[76:79], a[48:51], v[80:83]
    s_lshl1_add_u32 s68, s77, 228352
    ds_read_b64_tr_b16 a[68:69], v12 offset:32352
    v_mfma_f32_16x16x32_bf16 v[80:83], a[72:75], a[32:35], v[80:83]
    s_waitcnt lgkmcnt(9)
    ds_read_b64_tr_b16 a[70:71], v12 offset:46688
    v_mfma_f32_16x16x32_bf16 v[96:99], a[80:83], a[32:35], v[96:99]
    s_waitcnt lgkmcnt(8)
    buffer_load_dwordx4 v13, s[16:19], s68 offen offset:1024 lds
    v_mfma_f32_16x16x32_bf16 v[96:99], a[84:87], a[48:51], v[96:99]
    s_waitcnt vmcnt(14)
    v_mfma_f32_16x16x32_bf16 v[100:103], a[84:87], a[52:55], v[100:103]
    ds_read_b128 a[0:3], v3 offset:0
    v_mfma_f32_16x16x32_bf16 v[100:103], a[80:83], a[36:39], v[100:103]
    ds_read_b128 a[16:19], v4 offset:0
    v_mfma_f32_16x16x32_bf16 v[104:107], a[80:83], a[40:43], v[104:107]
    s_lshl1_add_u32 s68, s77, 14336
    ds_read_b128 a[4:7], v3 offset:2048
    v_mfma_f32_16x16x32_bf16 v[104:107], a[84:87], a[56:59], v[104:107]
    ds_read_b128 a[20:23], v4 offset:2048
    v_mfma_f32_16x16x32_bf16 v[108:111], a[84:87], a[60:63], v[108:111]
    buffer_load_dwordx4 v13, s[16:19], s68 offen offset:2048 lds
    v_mfma_f32_16x16x32_bf16 v[108:111], a[80:83], a[44:47], v[108:111]
    s_waitcnt lgkmcnt(10)
    ds_read_b64_tr_b16 a[72:73], v12 offset:35936
    v_mfma_f32_16x16x32_bf16 v[124:127], a[248:251], a[44:47], v[124:127]
    s_waitcnt lgkmcnt(9)
    ds_read_b64_tr_b16 a[74:75], v12 offset:50272
    v_mfma_f32_16x16x32_bf16 v[124:127], a[252:255], a[60:63], v[124:127]
    ds_read_b64_tr_b16 a[76:77], v12 offset:39520
    v_mfma_f32_16x16x32_bf16 v[120:123], a[252:255], a[56:59], v[120:123]
    s_lshl1_add_u32 s68, s77, 242688
    ds_read_b64_tr_b16 a[78:79], v12 offset:53856
    v_mfma_f32_16x16x32_bf16 v[120:123], a[248:251], a[40:43], v[120:123]
    v_mfma_f32_16x16x32_bf16 v[116:119], a[248:251], a[36:39], v[116:119]
    buffer_load_dwordx4 v13, s[16:19], s68 offen offset:3072 lds
    v_mfma_f32_16x16x32_bf16 v[116:119], a[252:255], a[52:55], v[116:119]
    ds_read_b64_tr_b16 a[80:81], v12 offset:28800
    v_mfma_f32_16x16x32_bf16 v[112:115], a[252:255], a[48:51], v[112:115]
    ds_read_b64_tr_b16 a[82:83], v12 offset:43136
    v_mfma_f32_16x16x32_bf16 v[112:115], a[248:251], a[32:35], v[112:115]
    s_waitcnt lgkmcnt(12)
    ds_read_b64_tr_b16 a[84:85], v12 offset:32384
    v_mfma_f32_16x16x32_bf16 v[128:131], a[64:67], a[32:35], v[128:131]
    s_waitcnt lgkmcnt(11)
    ds_read_b64_tr_b16 a[86:87], v12 offset:46720
    s_add_u32 m0, s56, 8192
    v_mfma_f32_16x16x32_bf16 v[128:131], a[68:71], a[48:51], v[128:131]
    v_mfma_f32_16x16x32_bf16 v[132:135], a[68:71], a[52:55], v[132:135]
    buffer_load_dwordx4 v2, s[8:11], s49 offen offset:1024 lds
    v_mfma_f32_16x16x32_bf16 v[132:135], a[64:67], a[36:39], v[132:135]
    v_mfma_f32_16x16x32_bf16 v[136:139], a[64:67], a[40:43], v[136:139]
    ds_read_b64_tr_b16 a[248:249], v12 offset:35968
    v_mfma_f32_16x16x32_bf16 v[136:139], a[68:71], a[56:59], v[136:139]
    ds_read_b64_tr_b16 a[250:251], v12 offset:50304
    v_mfma_f32_16x16x32_bf16 v[140:143], a[68:71], a[60:63], v[140:143]
    ds_read_b64_tr_b16 a[252:253], v12 offset:39552
    v_mfma_f32_16x16x32_bf16 v[140:143], a[64:67], a[44:47], v[140:143]
    s_waitcnt lgkmcnt(9)
    buffer_load_dwordx4 v1, s[8:11], s50 offen offset:2048 lds
    v_mfma_f32_16x16x32_bf16 v[156:159], a[72:75], a[44:47], v[156:159]
    s_waitcnt lgkmcnt(7)
    ds_read_b64_tr_b16 a[254:255], v12 offset:53888
    v_mfma_f32_16x16x32_bf16 v[156:159], a[76:79], a[60:63], v[156:159]
    v_mfma_f32_16x16x32_bf16 v[152:155], a[76:79], a[56:59], v[152:155]
    v_mfma_f32_16x16x32_bf16 v[152:155], a[72:75], a[40:43], v[152:155]
    v_mfma_f32_16x16x32_bf16 v[148:151], a[72:75], a[36:39], v[148:151]
    ds_read_b64_tr_b16 a[64:65], v12 offset:28832
    v_mfma_f32_16x16x32_bf16 v[148:151], a[76:79], a[52:55], v[148:151]
    buffer_load_dwordx4 v2, s[8:11], s51 offen offset:3072 lds
    v_mfma_f32_16x16x32_bf16 v[144:147], a[76:79], a[48:51], v[144:147]
    ds_read_b64_tr_b16 a[66:67], v12 offset:43168
    v_mfma_f32_16x16x32_bf16 v[144:147], a[72:75], a[32:35], v[144:147]
    s_waitcnt lgkmcnt(8)
    ds_read_b64_tr_b16 a[68:69], v12 offset:32416
    v_mfma_f32_16x16x32_bf16 v[160:163], a[80:83], a[32:35], v[160:163]
    s_waitcnt lgkmcnt(7)
    ds_read_b64_tr_b16 a[70:71], v12 offset:46752
    v_mfma_f32_16x16x32_bf16 v[160:163], a[84:87], a[48:51], v[160:163]
    s_mov_b32 m0, s56
    v_mfma_f32_16x16x32_bf16 v[164:167], a[84:87], a[52:55], v[164:167]
    v_mfma_f32_16x16x32_bf16 v[164:167], a[80:83], a[36:39], v[164:167]
    buffer_load_dwordx4 v1, s[8:11], s52 offen offset:0 lds
    v_mfma_f32_16x16x32_bf16 v[168:171], a[80:83], a[40:43], v[168:171]
    ds_read_b64_tr_b16 a[72:73], v12 offset:36000
    v_mfma_f32_16x16x32_bf16 v[168:171], a[84:87], a[56:59], v[168:171]
    ds_read_b64_tr_b16 a[74:75], v12 offset:50336
    v_mfma_f32_16x16x32_bf16 v[172:175], a[84:87], a[60:63], v[172:175]
    ds_read_b64_tr_b16 a[76:77], v12 offset:39584
    v_mfma_f32_16x16x32_bf16 v[172:175], a[80:83], a[44:47], v[172:175]
    s_waitcnt lgkmcnt(9)
    ds_read_b64_tr_b16 a[78:79], v12 offset:53920
    v_mfma_f32_16x16x32_bf16 v[188:191], a[248:251], a[44:47], v[188:191]
    s_waitcnt lgkmcnt(8)
    v_mfma_f32_16x16x32_bf16 v[188:191], a[252:255], a[60:63], v[188:191]
    buffer_load_dwordx4 v2, s[8:11], s53 offen offset:1024 lds
    v_mfma_f32_16x16x32_bf16 v[184:187], a[252:255], a[56:59], v[184:187]
    v_mfma_f32_16x16x32_bf16 v[184:187], a[248:251], a[40:43], v[184:187]
    v_mfma_f32_16x16x32_bf16 v[180:183], a[248:251], a[36:39], v[180:183]
    ds_read_b64_tr_b16 a[80:81], v12 offset:28864
    v_mfma_f32_16x16x32_bf16 v[180:183], a[252:255], a[52:55], v[180:183]
    ds_read_b64_tr_b16 a[82:83], v12 offset:43200
    v_mfma_f32_16x16x32_bf16 v[176:179], a[252:255], a[48:51], v[176:179]
    buffer_load_dwordx4 v1, s[8:11], s54 offen offset:2048 lds
    v_mfma_f32_16x16x32_bf16 v[176:179], a[248:251], a[32:35], v[176:179]
    s_waitcnt lgkmcnt(8)
    ds_read_b64_tr_b16 a[84:85], v12 offset:32448
    v_mfma_f32_16x16x32_bf16 v[192:195], a[64:67], a[32:35], v[192:195]
    s_waitcnt lgkmcnt(7)
    ds_read_b64_tr_b16 a[86:87], v12 offset:46784
    v_mfma_f32_16x16x32_bf16 v[192:195], a[68:71], a[48:51], v[192:195]
    v_mfma_f32_16x16x32_bf16 v[196:199], a[68:71], a[52:55], v[196:199]
    v_mfma_f32_16x16x32_bf16 v[196:199], a[64:67], a[36:39], v[196:199]
    v_mfma_f32_16x16x32_bf16 v[200:203], a[64:67], a[40:43], v[200:203]
    buffer_load_dwordx4 v2, s[8:11], s55 offen offset:3072 lds
    v_mfma_f32_16x16x32_bf16 v[200:203], a[68:71], a[56:59], v[200:203]
    ds_read_b64_tr_b16 a[248:249], v12 offset:36032
    v_mfma_f32_16x16x32_bf16 v[204:207], a[68:71], a[60:63], v[204:207]
    s_add_u32 m0, s57, 131072
    ds_read_b64_tr_b16 a[250:251], v12 offset:50368
    v_mfma_f32_16x16x32_bf16 v[204:207], a[64:67], a[44:47], v[204:207]
    s_waitcnt lgkmcnt(8)
    ds_read_b64_tr_b16 a[252:253], v12 offset:39616
    s_bfe_u32 s72, s70, 0x4001c
    v_mfma_f32_16x16x32_bf16 v[220:223], a[72:75], a[44:47], v[220:223]
    s_waitcnt lgkmcnt(7)
    ds_read_b64_tr_b16 a[254:255], v12 offset:53952
    s_mul_i32 s72, s72, 458752
    v_mfma_f32_16x16x32_bf16 v[220:223], a[76:79], a[60:63], v[220:223]
    s_waitcnt vmcnt(19)
    v_mfma_f32_16x16x32_bf16 v[216:219], a[76:79], a[56:59], v[216:219]
    buffer_load_dwordx4 v5, s[12:15], s72 offen offset:0 lds
    v_mfma_f32_16x16x32_bf16 v[216:219], a[72:75], a[40:43], v[216:219]
    ds_read_b128 a[8:11], v3 offset:4096
    v_mfma_f32_16x16x32_bf16 v[212:215], a[72:75], a[36:39], v[212:215]
    ds_read_b128 a[24:27], v4 offset:4096
    v_mfma_f32_16x16x32_bf16 v[212:215], a[76:79], a[52:55], v[212:215]
    ds_read_b128 a[12:15], v3 offset:6144
    v_mfma_f32_16x16x32_bf16 v[208:211], a[76:79], a[48:51], v[208:211]
    ds_read_b128 a[28:31], v4 offset:6144
    v_mfma_f32_16x16x32_bf16 v[208:211], a[72:75], a[32:35], v[208:211]
    s_waitcnt lgkmcnt(10)
    v_mfma_f32_16x16x32_bf16 v[224:227], a[80:83], a[32:35], v[224:227]
    s_waitcnt lgkmcnt(8)
    buffer_load_dwordx4 v6, s[12:15], s72 offen offset:1024 lds
    v_mfma_f32_16x16x32_bf16 v[224:227], a[84:87], a[48:51], v[224:227]
    v_mfma_f32_16x16x32_bf16 v[228:231], a[84:87], a[52:55], v[228:231]
    s_waitcnt vmcnt(14) lgkmcnt(4)
    v_mfma_f32_16x16x32_bf16 v[228:231], a[80:83], a[36:39], v[228:231]
    s_barrier
    v_mfma_f32_16x16x32_bf16 v[232:235], a[80:83], a[40:43], v[232:235]
    ds_read_b64_tr_b16 a[64:65], v12 offset:0
    v_mfma_f32_16x16x32_bf16 v[232:235], a[84:87], a[56:59], v[232:235]
    ds_read_b64_tr_b16 a[66:67], v12 offset:14336
    v_mfma_f32_16x16x32_bf16 v[236:239], a[84:87], a[60:63], v[236:239]
    buffer_load_dwordx4 v7, s[12:15], s72 offen offset:2048 lds
    v_mfma_f32_16x16x32_bf16 v[236:239], a[80:83], a[44:47], v[236:239]
    ds_read_b64_tr_b16 a[68:69], v12 offset:3584
    v_mfma_f32_16x16x32_bf16 v[252:255], a[248:251], a[44:47], v[252:255]
    ds_read_b64_tr_b16 a[70:71], v12 offset:17920
    v_mfma_f32_16x16x32_bf16 v[252:255], a[252:255], a[60:63], v[252:255]
    ds_read_b64_tr_b16 a[72:73], v12 offset:7168
    v_mfma_f32_16x16x32_bf16 v[248:251], a[252:255], a[56:59], v[248:251]
    ds_read_b64_tr_b16 a[74:75], v12 offset:21504
    v_mfma_f32_16x16x32_bf16 v[248:251], a[248:251], a[40:43], v[248:251]
    buffer_load_dwordx4 v8, s[12:15], s72 offen offset:3072 lds
    v_mfma_f32_16x16x32_bf16 v[244:247], a[248:251], a[36:39], v[244:247]
    ds_read_b64_tr_b16 a[76:77], v12 offset:10752
    v_mfma_f32_16x16x32_bf16 v[244:247], a[252:255], a[52:55], v[244:247]
    ds_read_b64_tr_b16 a[78:79], v12 offset:25088
    v_mfma_f32_16x16x32_bf16 v[240:243], a[252:255], a[48:51], v[240:243]
    ds_read_b64_tr_b16 a[80:81], v12 offset:32
    v_mfma_f32_16x16x32_bf16 v[240:243], a[248:251], a[32:35], v[240:243]
    s_waitcnt lgkmcnt(7)
    ds_read_b64_tr_b16 a[82:83], v12 offset:14368
    s_add_u32 m0, s57, 135168
    v_mfma_f32_16x16x32_bf16 v[32:35], a[64:67], a[0:3], v[32:35]
    s_waitcnt lgkmcnt(6)
    ds_read_b64_tr_b16 a[84:85], v12 offset:3616
    v_mfma_f32_16x16x32_bf16 v[32:35], a[68:71], a[16:19], v[32:35]
    buffer_load_dwordx4 v9, s[12:15], s72 offen offset:0 lds
    v_mfma_f32_16x16x32_bf16 v[36:39], a[68:71], a[20:23], v[36:39]
    ds_read_b64_tr_b16 a[86:87], v12 offset:17952
    v_mfma_f32_16x16x32_bf16 v[36:39], a[64:67], a[4:7], v[36:39]
    v_mfma_f32_16x16x32_bf16 v[40:43], a[64:67], a[8:11], v[40:43]
    ds_read_b64_tr_b16 a[248:249], v12 offset:7200
    v_mfma_f32_16x16x32_bf16 v[40:43], a[68:71], a[24:27], v[40:43]
    ds_read_b64_tr_b16 a[250:251], v12 offset:21536
    v_mfma_f32_16x16x32_bf16 v[44:47], a[68:71], a[28:31], v[44:47]
    ds_read_b64_tr_b16 a[252:253], v12 offset:10784
    v_mfma_f32_16x16x32_bf16 v[44:47], a[64:67], a[12:15], v[44:47]
    s_waitcnt lgkmcnt(9)
    buffer_load_dwordx4 v10, s[12:15], s72 offen offset:1024 lds
    v_mfma_f32_16x16x32_bf16 v[60:63], a[72:75], a[12:15], v[60:63]
    s_waitcnt lgkmcnt(7)
    ds_read_b64_tr_b16 a[254:255], v12 offset:25120
    v_mfma_f32_16x16x32_bf16 v[60:63], a[76:79], a[28:31], v[60:63]
    v_mfma_f32_16x16x32_bf16 v[56:59], a[76:79], a[24:27], v[56:59]
    v_mfma_f32_16x16x32_bf16 v[56:59], a[72:75], a[8:11], v[56:59]
    s_waitcnt vmcnt(13)
    v_mfma_f32_16x16x32_bf16 v[52:55], a[72:75], a[4:7], v[52:55]
    ds_read_b64_tr_b16 a[136:137], v14 offset:12288
    v_mfma_f32_16x16x32_bf16 v[52:55], a[76:79], a[20:23], v[52:55]
    buffer_load_dwordx4 v11, s[12:15], s72 offen offset:2048 lds
    v_mfma_f32_16x16x32_bf16 v[48:51], a[76:79], a[16:19], v[48:51]
    s_add_u32 m0, s56, 4096
    ds_read_b64_tr_b16 a[140:141], v15 offset:12288
    v_mfma_f32_16x16x32_bf16 v[48:51], a[72:75], a[0:3], v[48:51]
    s_waitcnt lgkmcnt(8)
    ds_read_b64_tr_b16 a[144:145], v16 offset:12288
    s_bfe_u32 s73, s71, 0x40000
    v_mfma_f32_16x16x32_bf16 v[64:67], a[80:83], a[0:3], v[64:67]
    s_waitcnt lgkmcnt(7)
    ds_read_b64_tr_b16 a[148:149], v17 offset:12288
    s_lshl_b32 s73, s73, 7
    v_mfma_f32_16x16x32_bf16 v[64:67], a[84:87], a[16:19], v[64:67]
    s_add_u32 s8, s6, s73
    s_addc_u32 s9, s7, 0
    ds_read_b64_tr_b16 a[138:139], v14 offset:14336
    v_mfma_f32_16x16x32_bf16 v[68:71], a[84:87], a[20:23], v[68:71]
    ds_read_b64_tr_b16 a[142:143], v15 offset:14336
    v_mfma_f32_16x16x32_bf16 v[68:71], a[80:83], a[4:7], v[68:71]
    buffer_load_dwordx4 v1, s[8:11], s48 offen offset:0 lds
    v_mfma_f32_16x16x32_bf16 v[72:75], a[80:83], a[8:11], v[72:75]
    ds_read_b64_tr_b16 a[64:65], v12 offset:64
    v_mfma_f32_16x16x32_bf16 v[72:75], a[84:87], a[24:27], v[72:75]
    ds_read_b64_tr_b16 a[66:67], v12 offset:14400
    v_mfma_f32_16x16x32_bf16 v[76:79], a[84:87], a[28:31], v[76:79]
    ds_read_b64_tr_b16 a[146:147], v16 offset:14336
    v_mfma_f32_16x16x32_bf16 v[76:79], a[80:83], a[12:15], v[76:79]
    s_waitcnt lgkmcnt(11)
    ds_read_b64_tr_b16 a[68:69], v12 offset:3648
    v_mfma_f32_16x16x32_bf16 v[92:95], a[248:251], a[12:15], v[92:95]
    s_waitcnt lgkmcnt(10)
    buffer_load_dwordx4 v2, s[8:11], s49 offen offset:1024 lds
    v_mfma_f32_16x16x32_bf16 v[92:95], a[252:255], a[28:31], v[92:95]
    ds_read_b64_tr_b16 a[70:71], v12 offset:17984
    v_mfma_f32_16x16x32_bf16 v[88:91], a[252:255], a[24:27], v[88:91]
    ds_read_b64_tr_b16 a[150:151], v17 offset:14336
    v_mfma_f32_16x16x32_bf16 v[88:91], a[248:251], a[8:11], v[88:91]
    ds_read_b64_tr_b16 a[72:73], v12 offset:7232
    v_mfma_f32_16x16x32_bf16 v[84:87], a[248:251], a[4:7], v[84:87]
    global_load_dword v23, v22, s[4:5]
    v_mfma_f32_16x16x32_bf16 v[84:87], a[252:255], a[20:23], v[84:87]
    ds_read_b64_tr_b16 a[74:75], v12 offset:21568
    v_mfma_f32_16x16x32_bf16 v[80:83], a[252:255], a[16:19], v[80:83]
    buffer_load_dwordx4 v1, s[8:11], s50 offen offset:2048 lds
    v_mfma_f32_16x16x32_bf16 v[80:83], a[248:251], a[0:3], v[80:83]
    s_waitcnt lgkmcnt(6)
    ds_read_b64_tr_b16 a[76:77], v12 offset:10816
    v_mfma_f32_16x16x32_bf16 v[96:99], a[64:67], a[0:3], v[96:99]
    s_waitcnt lgkmcnt(4)
    ds_read_b64_tr_b16 a[78:79], v12 offset:25152
    v_mfma_f32_16x16x32_bf16 v[96:99], a[68:71], a[16:19], v[96:99]
    s_waitcnt vmcnt(15)
    ds_read_b64_tr_b16 a[80:81], v12 offset:96
    v_add_u32 v22, 1024, v22
    v_mfma_f32_16x16x32_bf16 v[100:103], a[68:71], a[20:23], v[100:103]
    ds_read_b128 a[32:35], v3 offset:8192
    v_mfma_f32_16x16x32_bf16 v[100:103], a[64:67], a[4:7], v[100:103]
    ds_read_b128 a[48:51], v4 offset:8192
    v_mfma_f32_16x16x32_bf16 v[104:107], a[64:67], a[8:11], v[104:107]
    buffer_load_dwordx4 v2, s[8:11], s51 offen offset:3072 lds
    v_mfma_f32_16x16x32_bf16 v[104:107], a[68:71], a[24:27], v[104:107]
    ds_read_b128 a[36:39], v3 offset:10240
    v_mfma_f32_16x16x32_bf16 v[108:111], a[68:71], a[28:31], v[108:111]
    ds_read_b128 a[52:55], v4 offset:10240
    v_mfma_f32_16x16x32_bf16 v[108:111], a[64:67], a[12:15], v[108:111]
    s_waitcnt lgkmcnt(7)
    ds_read_b64_tr_b16 a[82:83], v12 offset:14432
    s_add_u32 m0, s56, 12288
    v_mfma_f32_16x16x32_bf16 v[124:127], a[72:75], a[12:15], v[124:127]
    s_waitcnt lgkmcnt(6)
    ds_read_b64_tr_b16 a[84:85], v12 offset:3680
    s_add_u32 s68, s74, 32768
    v_mfma_f32_16x16x32_bf16 v[124:127], a[76:79], a[28:31], v[124:127]
    ds_read_b64_tr_b16 a[86:87], v12 offset:18016
    v_mfma_f32_16x16x32_bf16 v[120:123], a[76:79], a[24:27], v[120:123]
    buffer_load_dwordx4 v13, s[16:19], s68 offen offset:0 lds
    v_mfma_f32_16x16x32_bf16 v[120:123], a[72:75], a[8:11], v[120:123]
    ds_read_b64_tr_b16 a[248:249], v12 offset:7264
    v_mfma_f32_16x16x32_bf16 v[116:119], a[72:75], a[4:7], v[116:119]
    ds_read_b64_tr_b16 a[250:251], v12 offset:21600
    v_mfma_f32_16x16x32_bf16 v[116:119], a[76:79], a[20:23], v[116:119]
    ds_read_b64_tr_b16 a[252:253], v12 offset:10848
    v_mfma_f32_16x16x32_bf16 v[112:115], a[76:79], a[16:19], v[112:115]
    s_add_u32 s68, s74, 48128
    ds_read_b64_tr_b16 a[254:255], v12 offset:25184
    v_mfma_f32_16x16x32_bf16 v[112:115], a[72:75], a[0:3], v[112:115]
    s_waitcnt lgkmcnt(6)
    ds_read_b64_tr_b16 a[64:65], v12 offset:128
    v_mfma_f32_16x16x32_bf16 v[128:131], a[80:83], a[0:3], v[128:131]
    s_waitcnt lgkmcnt(5)
    buffer_load_dwordx4 v13, s[16:19], s68 offen offset:1024 lds
    v_mfma_f32_16x16x32_bf16 v[128:131], a[84:87], a[16:19], v[128:131]
    ds_read_b64_tr_b16 a[66:67], v12 offset:14464
    v_mfma_f32_16x16x32_bf16 v[132:135], a[84:87], a[20:23], v[132:135]
    ds_read_b64_tr_b16 a[68:69], v12 offset:3712
    v_mfma_f32_16x16x32_bf16 v[132:135], a[80:83], a[4:7], v[132:135]
    s_add_u32 s68, s74, 63488
    ds_read_b64_tr_b16 a[70:71], v12 offset:18048
    v_mfma_f32_16x16x32_bf16 v[136:139], a[80:83], a[8:11], v[136:139]
    ds_read_b64_tr_b16 a[72:73], v12 offset:7296
    v_mfma_f32_16x16x32_bf16 v[136:139], a[84:87], a[24:27], v[136:139]
    buffer_load_dwordx4 v13, s[16:19], s68 offen offset:2048 lds
    v_mfma_f32_16x16x32_bf16 v[140:143], a[84:87], a[28:31], v[140:143]
    ds_read_b64_tr_b16 a[74:75], v12 offset:21632
    v_mfma_f32_16x16x32_bf16 v[140:143], a[80:83], a[12:15], v[140:143]
    s_waitcnt lgkmcnt(8)
    ds_read_b64_tr_b16 a[76:77], v12 offset:10880
    v_mfma_f32_16x16x32_bf16 v[156:159], a[248:251], a[12:15], v[156:159]
    s_waitcnt lgkmcnt(7)
    ds_read_b64_tr_b16 a[78:79], v12 offset:25216
    v_mfma_f32_16x16x32_bf16 v[156:159], a[252:255], a[28:31], v[156:159]
    s_add_u32 s68, s74, 78848
    v_mfma_f32_16x16x32_bf16 v[152:155], a[252:255], a[24:27], v[152:155]
    v_mfma_f32_16x16x32_bf16 v[152:155], a[248:251], a[8:11], v[152:155]
    buffer_load_dwordx4 v13, s[16:19], s68 offen offset:3072 lds
    v_mfma_f32_16x16x32_bf16 v[148:151], a[248:251], a[4:7], v[148:151]
    ds_read_b64_tr_b16 a[80:81], v12 offset:160
    v_mfma_f32_16x16x32_bf16 v[148:151], a[252:255], a[20:23], v[148:151]
    ds_read_b64_tr_b16 a[82:83], v12 offset:14496
    v_mfma_f32_16x16x32_bf16 v[144:147], a[252:255], a[16:19], v[144:147]
    ds_read_b64_tr_b16 a[84:85], v12 offset:3744
    v_mfma_f32_16x16x32_bf16 v[144:147], a[248:251], a[0:3], v[144:147]
    s_waitcnt lgkmcnt(9)
    ds_read_b64_tr_b16 a[86:87], v12 offset:18080
    s_add_u32 m0, s56, 8192
    v_mfma_f32_16x16x32_bf16 v[160:163], a[64:67], a[0:3], v[160:163]
    s_waitcnt lgkmcnt(8)
    v_mfma_f32_16x16x32_bf16 v[160:163], a[68:71], a[16:19], v[160:163]
    buffer_load_dwordx4 v1, s[8:11], s52 offen offset:0 lds
    v_mfma_f32_16x16x32_bf16 v[164:167], a[68:71], a[20:23], v[164:167]
    v_mfma_f32_16x16x32_bf16 v[164:167], a[64:67], a[4:7], v[164:167]
    v_mfma_f32_16x16x32_bf16 v[168:171], a[64:67], a[8:11], v[168:171]
    ds_read_b64_tr_b16 a[248:249], v12 offset:7328
    v_mfma_f32_16x16x32_bf16 v[168:171], a[68:71], a[24:27], v[168:171]
L_pad3:
    s_cbranch_vccnz L_pad7
    ds_read_b64_tr_b16 a[250:251], v12 offset:21664
    v_mfma_f32_16x16x32_bf16 v[172:175], a[68:71], a[28:31], v[172:175]
    ds_read_b64_tr_b16 a[252:253], v12 offset:10912
    v_mfma_f32_16x16x32_bf16 v[172:175], a[64:67], a[12:15], v[172:175]
    s_waitcnt lgkmcnt(9)
    buffer_load_dwordx4 v2, s[8:11], s53 offen offset:1024 lds
    v_mfma_f32_16x16x32_bf16 v[188:191], a[72:75], a[12:15], v[188:191]
    s_waitcnt lgkmcnt(7)
    ds_read_b64_tr_b16 a[254:255], v12 offset:25248
    v_mfma_f32_16x16x32_bf16 v[188:191], a[76:79], a[28:31], v[188:191]
    v_mfma_f32_16x16x32_bf16 v[184:187], a[76:79], a[24:27], v[184:187]
    v_mfma_f32_16x16x32_bf16 v[184:187], a[72:75], a[8:11], v[184:187]
    v_mfma_f32_16x16x32_bf16 v[180:183], a[72:75], a[4:7], v[180:183]
    ds_read_b64_tr_b16 a[64:65], v12 offset:192
    v_mfma_f32_16x16x32_bf16 v[180:183], a[76:79], a[20:23], v[180:183]
    buffer_load_dwordx4 v1, s[8:11], s54 offen offset:2048 lds
    v_mfma_f32_16x16x32_bf16 v[176:179], a[76:79], a[16:19], v[176:179]
    ds_read_b64_tr_b16 a[66:67], v12 offset:14528
    v_mfma_f32_16x16x32_bf16 v[176:179], a[72:75], a[0:3], v[176:179]
    s_waitcnt lgkmcnt(8)
    ds_read_b64_tr_b16 a[68:69], v12 offset:3776
    v_mfma_f32_16x16x32_bf16 v[192:195], a[80:83], a[0:3], v[192:195]
    s_waitcnt lgkmcnt(7)
    ds_read_b64_tr_b16 a[70:71], v12 offset:18112
    v_mfma_f32_16x16x32_bf16 v[192:195], a[84:87], a[16:19], v[192:195]
    v_mfma_f32_16x16x32_bf16 v[196:199], a[84:87], a[20:23], v[196:199]
    buffer_load_dwordx4 v2, s[8:11], s55 offen offset:3072 lds
    v_mfma_f32_16x16x32_bf16 v[196:199], a[80:83], a[4:7], v[196:199]
    v_mfma_f32_16x16x32_bf16 v[200:203], a[80:83], a[8:11], v[200:203]
    s_add_u32 m0, s57, 94208
    ds_read_b64_tr_b16 a[72:73], v12 offset:7360
    v_mfma_f32_16x16x32_bf16 v[200:203], a[84:87], a[24:27], v[200:203]
    s_bfe_u32 s72, s71, 0x40000
    ds_read_b64_tr_b16 a[74:75], v12 offset:21696
    v_mfma_f32_16x16x32_bf16 v[204:207], a[84:87], a[28:31], v[204:207]
    s_mul_i32 s72, s72, 458752
    ds_read_b64_tr_b16 a[76:77], v12 offset:10944
    v_mfma_f32_16x16x32_bf16 v[204:207], a[80:83], a[12:15], v[204:207]
    s_waitcnt lgkmcnt(9)
    ds_read_b64_tr_b16 a[78:79], v12 offset:25280
    v_mfma_f32_16x16x32_bf16 v[220:223], a[248:251], a[12:15], v[220:223]
    s_waitcnt lgkmcnt(8)
    buffer_load_dwordx4 v5, s[12:15], s72 offen offset:0 lds
    v_mfma_f32_16x16x32_bf16 v[220:223], a[252:255], a[28:31], v[220:223]
    s_waitcnt vmcnt(21)
    global_load_dword v23, v22, s[4:5]
    v_mfma_f32_16x16x32_bf16 v[216:219], a[252:255], a[24:27], v[216:219]
    ds_read_b128 a[40:43], v3 offset:0
    v_mfma_f32_16x16x32_bf16 v[216:219], a[248:251], a[8:11], v[216:219]
    ds_read_b128 a[56:59], v4 offset:0
    v_mfma_f32_16x16x32_bf16 v[212:215], a[248:251], a[4:7], v[212:215]
    ds_read_b128 a[44:47], v3 offset:2048
    v_mfma_f32_16x16x32_bf16 v[212:215], a[252:255], a[20:23], v[212:215]
    ds_read_b128 a[60:63], v4 offset:2048
    v_add_u32 v22, 1024, v22
    v_mfma_f32_16x16x32_bf16 v[208:211], a[252:255], a[16:19], v[208:211]
    buffer_load_dwordx4 v6, s[12:15], s72 offen offset:1024 lds
    v_mfma_f32_16x16x32_bf16 v[208:211], a[248:251], a[0:3], v[208:211]
    s_waitcnt lgkmcnt(10)
    v_mfma_f32_16x16x32_bf16 v[224:227], a[64:67], a[0:3], v[224:227]
    s_waitcnt lgkmcnt(8)
    v_mfma_f32_16x16x32_bf16 v[224:227], a[68:71], a[16:19], v[224:227]
    v_mfma_f32_16x16x32_bf16 v[228:231], a[68:71], a[20:23], v[228:231]
    s_waitcnt vmcnt(16) lgkmcnt(4)
    v_mfma_f32_16x16x32_bf16 v[228:231], a[64:67], a[4:7], v[228:231]
    s_barrier
    v_mfma_f32_16x16x32_bf16 v[232:235], a[64:67], a[8:11], v[232:235]
    buffer_load_dwordx4 v7, s[12:15], s72 offen offset:2048 lds
    v_mfma_f32_16x16x32_bf16 v[232:235], a[68:71], a[24:27], v[232:235]
    ds_read_b64_tr_b16 a[80:81], v30 offset:0
    v_mfma_f32_16x16x32_bf16 v[236:239], a[68:71], a[28:31], v[236:239]
    ds_read_b64_tr_b16 a[82:83], v30 offset:14336
    v_mfma_f32_16x16x32_bf16 v[236:239], a[64:67], a[12:15], v[236:239]
    ds_read_b64_tr_b16 a[84:85], v30 offset:3584
    v_mfma_f32_16x16x32_bf16 v[252:255], a[72:75], a[12:15], v[252:255]
    ds_read_b64_tr_b16 a[86:87], v30 offset:17920
    v_mfma_f32_16x16x32_bf16 v[252:255], a[76:79], a[28:31], v[252:255]
    ds_read_b64_tr_b16 a[248:249], v30 offset:7168
    v_mfma_f32_16x16x32_bf16 v[248:251], a[76:79], a[24:27], v[248:251]
    buffer_load_dwordx4 v8, s[12:15], s72 offen offset:3072 lds
    v_mfma_f32_16x16x32_bf16 v[248:251], a[72:75], a[8:11], v[248:251]
    ds_read_b64_tr_b16 a[250:251], v30 offset:21504
    v_mfma_f32_16x16x32_bf16 v[244:247], a[72:75], a[4:7], v[244:247]
    ds_read_b64_tr_b16 a[252:253], v30 offset:10752
    v_mfma_f32_16x16x32_bf16 v[244:247], a[76:79], a[20:23], v[244:247]
    s_add_u32 m0, s57, 98304
    ds_read_b64_tr_b16 a[254:255], v30 offset:25088
    v_mfma_f32_16x16x32_bf16 v[240:243], a[76:79], a[16:19], v[240:243]
    ds_read_b64_tr_b16 a[64:65], v30 offset:32
    v_mfma_f32_16x16x32_bf16 v[240:243], a[72:75], a[0:3], v[240:243]
    s_waitcnt lgkmcnt(7)
    buffer_load_dwordx4 v9, s[12:15], s72 offen offset:0 lds
    v_mfma_f32_16x16x32_bf16 v[32:35], a[80:83], a[32:35], v[32:35]
    s_waitcnt lgkmcnt(5)
    ds_read_b64_tr_b16 a[66:67], v30 offset:14368
    v_mfma_f32_16x16x32_bf16 v[32:35], a[84:87], a[48:51], v[32:35]
    ds_read_b64_tr_b16 a[68:69], v30 offset:3616
    v_mfma_f32_16x16x32_bf16 v[36:39], a[84:87], a[52:55], v[36:39]
    ds_read_b64_tr_b16 a[70:71], v30 offset:17952
    v_mfma_f32_16x16x32_bf16 v[36:39], a[80:83], a[36:39], v[36:39]
    v_mfma_f32_16x16x32_bf16 v[40:43], a[80:83], a[40:43], v[40:43]
    ds_read_b64_tr_b16 a[72:73], v30 offset:7200
    v_mfma_f32_16x16x32_bf16 v[40:43], a[84:87], a[56:59], v[40:43]
    buffer_load_dwordx4 v10, s[12:15], s72 offen offset:1024 lds
    v_mfma_f32_16x16x32_bf16 v[44:47], a[84:87], a[60:63], v[44:47]
    ds_read_b64_tr_b16 a[74:75], v30 offset:21536
    v_mfma_f32_16x16x32_bf16 v[44:47], a[80:83], a[44:47], v[44:47]
    s_waitcnt lgkmcnt(8)
    ds_read_b64_tr_b16 a[76:77], v30 offset:10784
    v_mfma_f32_16x16x32_bf16 v[60:63], a[248:251], a[44:47], v[60:63]
    s_waitcnt lgkmcnt(7)
    ds_read_b64_tr_b16 a[78:79], v30 offset:25120
    v_mfma_f32_16x16x32_bf16 v[60:63], a[252:255], a[60:63], v[60:63]
    v_mfma_f32_16x16x32_bf16 v[56:59], a[252:255], a[56:59], v[56:59]
    v_mfma_f32_16x16x32_bf16 v[56:59], a[248:251], a[40:43], v[56:59]
    buffer_load_dwordx4 v11, s[12:15], s72 offen offset:2048 lds
    v_mfma_f32_16x16x32_bf16 v[52:55], a[248:251], a[36:39], v[52:55]
    s_mov_b32 m0, s56
    ds_read_b64_tr_b16 a[80:81], v30 offset:64
    v_mfma_f32_16x16x32_bf16 v[52:55], a[252:255], a[52:55], v[52:55]
    s_bfe_u32 s73, s71, 0x40004
    ds_read_b64_tr_b16 a[82:83], v30 offset:14400
    v_mfma_f32_16x16x32_bf16 v[48:51], a[252:255], a[48:51], v[48:51]
    s_lshl_b32 s73, s73, 7
    ds_read_b64_tr_b16 a[84:85], v30 offset:3648
    v_mfma_f32_16x16x32_bf16 v[48:51], a[248:251], a[32:35], v[48:51]
    s_waitcnt lgkmcnt(9)
    ds_read_b64_tr_b16 a[86:87], v30 offset:17984
    s_add_u32 s8, s6, s73
    s_addc_u32 s9, s7, 0
    v_mfma_f32_16x16x32_bf16 v[64:67], a[64:67], a[32:35], v[64:67]
    s_waitcnt lgkmcnt(8)
    v_mfma_f32_16x16x32_bf16 v[64:67], a[68:71], a[48:51], v[64:67]
    buffer_load_dwordx4 v1, s[8:11], s48 offen offset:0 lds
    v_mfma_f32_16x16x32_bf16 v[68:71], a[68:71], a[52:55], v[68:71]
    v_mfma_f32_16x16x32_bf16 v[68:71], a[64:67], a[36:39], v[68:71]
    v_mfma_f32_16x16x32_bf16 v[72:75], a[64:67], a[40:43], v[72:75]
    ds_read_b64_tr_b16 a[248:249], v30 offset:7232
    v_mfma_f32_16x16x32_bf16 v[72:75], a[68:71], a[56:59], v[72:75]
    ds_read_b64_tr_b16 a[250:251], v30 offset:21568
    v_mfma_f32_16x16x32_bf16 v[76:79], a[68:71], a[60:63], v[76:79]
    ds_read_b64_tr_b16 a[252:253], v30 offset:10816
    v_mfma_f32_16x16x32_bf16 v[76:79], a[64:67], a[44:47], v[76:79]
    s_waitcnt lgkmcnt(9)
    buffer_load_dwordx4 v2, s[8:11], s49 offen offset:1024 lds
    v_mfma_f32_16x16x32_bf16 v[92:95], a[72:75], a[44:47], v[92:95]
    s_waitcnt lgkmcnt(7)
    ds_read_b64_tr_b16 a[254:255], v30 offset:25152
    v_mfma_f32_16x16x32_bf16 v[92:95], a[76:79], a[60:63], v[92:95]
    v_mfma_f32_16x16x32_bf16 v[88:91], a[76:79], a[56:59], v[88:91]
    s_waitcnt vmcnt(14)
    v_mfma_f32_16x16x32_bf16 v[88:91], a[72:75], a[40:43], v[88:91]
    ds_read_b64_tr_b16 a[152:153], v14 offset:12288
    v_mfma_f32_16x16x32_bf16 v[84:87], a[72:75], a[36:39], v[84:87]
    buffer_load_dwordx4 v1, s[8:11], s50 offen offset:2048 lds
    v_mfma_f32_16x16x32_bf16 v[84:87], a[76:79], a[52:55], v[84:87]
    ds_read_b64_tr_b16 a[156:157], v15 offset:12288
    v_mfma_f32_16x16x32_bf16 v[80:83], a[76:79], a[48:51], v[80:83]
    ds_read_b64_tr_b16 a[160:161], v16 offset:12288
    v_mfma_f32_16x16x32_bf16 v[80:83], a[72:75], a[32:35], v[80:83]
    s_waitcnt lgkmcnt(9)
    ds_read_b64_tr_b16 a[164:165], v17 offset:12288
    v_mfma_f32_16x16x32_bf16 v[96:99], a[80:83], a[32:35], v[96:99]
    s_waitcnt lgkmcnt(8)
    ds_read_b64_tr_b16 a[154:155], v14 offset:14336
    v_mfma_f32_16x16x32_bf16 v[96:99], a[84:87], a[48:51], v[96:99]
    ds_read_b64_tr_b16 a[158:159], v15 offset:14336
    v_mfma_f32_16x16x32_bf16 v[100:103], a[84:87], a[52:55], v[100:103]
    buffer_load_dwordx4 v2, s[8:11], s51 offen offset:3072 lds
    v_mfma_f32_16x16x32_bf16 v[100:103], a[80:83], a[36:39], v[100:103]
    ds_read_b128 a[0:3], v3 offset:4096
    v_mfma_f32_16x16x32_bf16 v[104:107], a[80:83], a[40:43], v[104:107]
    s_add_u32 m0, s57, 65536
    ds_read_b128 a[16:19], v4 offset:4096
    v_mfma_f32_16x16x32_bf16 v[104:107], a[84:87], a[56:59], v[104:107]
    s_bfe_u32 s72, s71, 0x40004
    ds_read_b128 a[4:7], v3 offset:6144
    v_mfma_f32_16x16x32_bf16 v[108:111], a[84:87], a[60:63], v[108:111]
    s_mul_i32 s72, s72, 458752
    ds_read_b128 a[20:23], v4 offset:6144
    v_mfma_f32_16x16x32_bf16 v[108:111], a[80:83], a[44:47], v[108:111]
    s_waitcnt lgkmcnt(12)
    ds_read_b64_tr_b16 a[162:163], v16 offset:14336
    v_mfma_f32_16x16x32_bf16 v[124:127], a[248:251], a[44:47], v[124:127]
    s_waitcnt lgkmcnt(11)
    buffer_load_dwordx4 v5, s[12:15], s72 offen offset:0 lds
    v_mfma_f32_16x16x32_bf16 v[124:127], a[252:255], a[60:63], v[124:127]
    ds_read_b64_tr_b16 a[64:65], v30 offset:96
    v_mfma_f32_16x16x32_bf16 v[120:123], a[252:255], a[56:59], v[120:123]
    ds_read_b64_tr_b16 a[66:67], v30 offset:14432
    v_mfma_f32_16x16x32_bf16 v[120:123], a[248:251], a[40:43], v[120:123]
    ds_read_b64_tr_b16 a[166:167], v17 offset:14336
    v_mfma_f32_16x16x32_bf16 v[116:119], a[248:251], a[36:39], v[116:119]
    s_add_u32 m0, s56, 4096
    ds_read_b64_tr_b16 a[68:69], v30 offset:3680
    ds_read_b64_tr_b16 a[70:71], v30 offset:18016
    v_mfma_f32_16x16x32_bf16 v[116:119], a[252:255], a[52:55], v[116:119]
    s_waitcnt lgkmcnt(6)
    ds_read_b64_tr_b16 a[72:73], v30 offset:7264
    v_mfma_f32_16x16x32_bf16 v[112:115], a[252:255], a[48:51], v[112:115]
    buffer_load_dwordx4 v1, s[8:11], s52 offen offset:0 lds
    v_mfma_f32_16x16x32_bf16 v[112:115], a[248:251], a[32:35], v[112:115]
    s_waitcnt lgkmcnt(4)
    ds_read_b64_tr_b16 a[74:75], v30 offset:21600
    v_mfma_f32_16x16x32_bf16 v[128:131], a[64:67], a[32:35], v[128:131]
    s_waitcnt lgkmcnt(2)
    ds_read_b64_tr_b16 a[76:77], v30 offset:10848
    v_mfma_f32_16x16x32_bf16 v[128:131], a[68:71], a[48:51], v[128:131]
    ds_read_b64_tr_b16 a[78:79], v30 offset:25184
    v_mfma_f32_16x16x32_bf16 v[132:135], a[68:71], a[52:55], v[132:135]
    ds_read_b64_tr_b16 a[80:81], v30 offset:128
    v_mfma_f32_16x16x32_bf16 v[132:135], a[64:67], a[36:39], v[132:135]
    ds_read_b64_tr_b16 a[82:83], v30 offset:14464
    v_mfma_f32_16x16x32_bf16 v[136:139], a[64:67], a[40:43], v[136:139]
    buffer_load_dwordx4 v2, s[8:11], s53 offen offset:1024 lds
    v_mfma_f32_16x16x32_bf16 v[136:139], a[68:71], a[56:59], v[136:139]
    ds_read_b64_tr_b16 a[84:85], v30 offset:3712
    v_mfma_f32_16x16x32_bf16 v[140:143], a[68:71], a[60:63], v[140:143]
    s_add_u32 m0, s56, 12288
    ds_read_b64_tr_b16 a[86:87], v30 offset:18048
    v_mfma_f32_16x16x32_bf16 v[140:143], a[64:67], a[44:47], v[140:143]
    s_waitcnt lgkmcnt(6)
    ds_read_b64_tr_b16 a[248:249], v30 offset:7296
    s_add_u32 s68, s75, 32768
    v_mfma_f32_16x16x32_bf16 v[156:159], a[72:75], a[44:47], v[156:159]
    s_waitcnt lgkmcnt(5)
    ds_read_b64_tr_b16 a[250:251], v30 offset:21632
    v_mfma_f32_16x16x32_bf16 v[156:159], a[76:79], a[60:63], v[156:159]
    buffer_load_dwordx4 v13, s[16:19], s68 offen offset:0 lds
    v_mfma_f32_16x16x32_bf16 v[152:155], a[76:79], a[56:59], v[152:155]
    ds_read_b64_tr_b16 a[252:253], v30 offset:10880
    v_mfma_f32_16x16x32_bf16 v[152:155], a[72:75], a[40:43], v[152:155]
    ds_read_b64_tr_b16 a[254:255], v30 offset:25216
    v_mfma_f32_16x16x32_bf16 v[148:151], a[72:75], a[36:39], v[148:151]
    ds_read_b64_tr_b16 a[64:65], v30 offset:160
    v_mfma_f32_16x16x32_bf16 v[148:151], a[76:79], a[52:55], v[148:151]
    s_add_u32 s68, s75, 48128
    ds_read_b64_tr_b16 a[66:67], v30 offset:14496
    v_mfma_f32_16x16x32_bf16 v[144:147], a[76:79], a[48:51], v[144:147]
    ds_read_b64_tr_b16 a[68:69], v30 offset:3744
    v_mfma_f32_16x16x32_bf16 v[144:147], a[72:75], a[32:35], v[144:147]
    s_waitcnt lgkmcnt(9)
    buffer_load_dwordx4 v13, s[16:19], s68 offen offset:1024 lds
    v_mfma_f32_16x16x32_bf16 v[160:163], a[80:83], a[32:35], v[160:163]
    s_waitcnt lgkmcnt(7)
    ds_read_b64_tr_b16 a[70:71], v30 offset:18080
    v_mfma_f32_16x16x32_bf16 v[160:163], a[84:87], a[48:51], v[160:163]
    v_mfma_f32_16x16x32_bf16 v[164:167], a[84:87], a[52:55], v[164:167]
    v_mfma_f32_16x16x32_bf16 v[164:167], a[80:83], a[36:39], v[164:167]
    s_add_u32 s68, s75, 63488
    v_mfma_f32_16x16x32_bf16 v[168:171], a[80:83], a[40:43], v[168:171]
    ds_read_b64_tr_b16 a[72:73], v30 offset:7328
    v_mfma_f32_16x16x32_bf16 v[168:171], a[84:87], a[56:59], v[168:171]
    buffer_load_dwordx4 v13, s[16:19], s68 offen offset:2048 lds
    v_mfma_f32_16x16x32_bf16 v[172:175], a[84:87], a[60:63], v[172:175]
    ds_read_b64_tr_b16 a[74:75], v30 offset:21664
    v_mfma_f32_16x16x32_bf16 v[172:175], a[80:83], a[44:47], v[172:175]
    s_waitcnt lgkmcnt(8)
    ds_read_b64_tr_b16 a[76:77], v30 offset:10912
    v_mfma_f32_16x16x32_bf16 v[188:191], a[248:251], a[44:47], v[188:191]
    s_waitcnt lgkmcnt(7)
    ds_read_b64_tr_b16 a[78:79], v30 offset:25248
    v_mfma_f32_16x16x32_bf16 v[188:191], a[252:255], a[60:63], v[188:191]
    s_add_u32 s68, s75, 78848
    v_mfma_f32_16x16x32_bf16 v[184:187], a[252:255], a[56:59], v[184:187]
    v_mfma_f32_16x16x32_bf16 v[184:187], a[248:251], a[40:43], v[184:187]
    buffer_load_dwordx4 v13, s[16:19], s68 offen offset:3072 lds
    v_mfma_f32_16x16x32_bf16 v[180:183], a[248:251], a[36:39], v[180:183]
    ds_read_b64_tr_b16 a[80:81], v30 offset:192
    v_mfma_f32_16x16x32_bf16 v[180:183], a[252:255], a[52:55], v[180:183]
    ds_read_b64_tr_b16 a[82:83], v30 offset:14528
    v_mfma_f32_16x16x32_bf16 v[176:179], a[252:255], a[48:51], v[176:179]
    ds_read_b64_tr_b16 a[84:85], v30 offset:3776
    v_mfma_f32_16x16x32_bf16 v[176:179], a[248:251], a[32:35], v[176:179]
    s_waitcnt lgkmcnt(9)
    ds_read_b64_tr_b16 a[86:87], v30 offset:18112
    s_add_u32 m0, s56, 4096
    v_mfma_f32_16x16x32_bf16 v[192:195], a[64:67], a[32:35], v[192:195]
    s_waitcnt lgkmcnt(8)
    v_mfma_f32_16x16x32_bf16 v[192:195], a[68:71], a[48:51], v[192:195]
    buffer_load_dwordx4 v1, s[8:11], s54 offen offset:2048 lds
    v_mfma_f32_16x16x32_bf16 v[196:199], a[68:71], a[52:55], v[196:199]
    v_mfma_f32_16x16x32_bf16 v[196:199], a[64:67], a[36:39], v[196:199]
    v_mfma_f32_16x16x32_bf16 v[200:203], a[64:67], a[40:43], v[200:203]
    ds_read_b64_tr_b16 a[248:249], v30 offset:7360
    v_mfma_f32_16x16x32_bf16 v[200:203], a[68:71], a[56:59], v[200:203]
    ds_read_b64_tr_b16 a[250:251], v30 offset:21696
    v_mfma_f32_16x16x32_bf16 v[204:207], a[68:71], a[60:63], v[204:207]
    buffer_load_dwordx4 v2, s[8:11], s55 offen offset:3072 lds
    v_mfma_f32_16x16x32_bf16 v[204:207], a[64:67], a[44:47], v[204:207]
    s_waitcnt lgkmcnt(8)
    ds_read_b64_tr_b16 a[252:253], v30 offset:10944
    v_mfma_f32_16x16x32_bf16 v[220:223], a[72:75], a[44:47], v[220:223]
    s_waitcnt lgkmcnt(7)
    ds_read_b64_tr_b16 a[254:255], v30 offset:25280
    v_mfma_f32_16x16x32_bf16 v[220:223], a[76:79], a[60:63], v[220:223]
    s_waitcnt vmcnt(21)
    v_mfma_f32_16x16x32_bf16 v[216:219], a[76:79], a[56:59], v[216:219]
    s_add_u32 m0, s57, 65536
    ds_read_b128 a[8:11], v3 offset:8192
    v_mfma_f32_16x16x32_bf16 v[216:219], a[72:75], a[40:43], v[216:219]
    ds_read_b128 a[24:27], v4 offset:8192
    v_mfma_f32_16x16x32_bf16 v[212:215], a[72:75], a[36:39], v[212:215]
    buffer_load_dwordx4 v6, s[12:15], s72 offen offset:1024 lds
    v_mfma_f32_16x16x32_bf16 v[212:215], a[76:79], a[52:55], v[212:215]
    ds_read_b128 a[12:15], v3 offset:10240
    v_mfma_f32_16x16x32_bf16 v[208:211], a[76:79], a[48:51], v[208:211]
    ds_read_b128 a[28:31], v4 offset:10240
    v_mfma_f32_16x16x32_bf16 v[208:211], a[72:75], a[32:35], v[208:211]
    s_waitcnt lgkmcnt(10)
    v_mfma_f32_16x16x32_bf16 v[224:227], a[80:83], a[32:35], v[224:227]
    s_waitcnt lgkmcnt(8)
    v_mfma_f32_16x16x32_bf16 v[224:227], a[84:87], a[48:51], v[224:227]
    v_mfma_f32_16x16x32_bf16 v[228:231], a[84:87], a[52:55], v[228:231]
    s_waitcnt vmcnt(14) lgkmcnt(4)
    buffer_load_dwordx4 v7, s[12:15], s72 offen offset:2048 lds
    v_mfma_f32_16x16x32_bf16 v[228:231], a[80:83], a[36:39], v[228:231]
    s_barrier
    v_mfma_f32_16x16x32_bf16 v[232:235], a[80:83], a[40:43], v[232:235]
    ds_read_b64_tr_b16 a[64:65], v12 offset:28672
    v_mfma_f32_16x16x32_bf16 v[232:235], a[84:87], a[56:59], v[232:235]
    ds_read_b64_tr_b16 a[66:67], v12 offset:43008
    v_mfma_f32_16x16x32_bf16 v[236:239], a[84:87], a[60:63], v[236:239]
    ds_read_b64_tr_b16 a[68:69], v12 offset:32256
    v_mfma_f32_16x16x32_bf16 v[236:239], a[80:83], a[44:47], v[236:239]
    ds_read_b64_tr_b16 a[70:71], v12 offset:46592
    v_mfma_f32_16x16x32_bf16 v[252:255], a[248:251], a[44:47], v[252:255]
    buffer_load_dwordx4 v8, s[12:15], s72 offen offset:3072 lds
    v_mfma_f32_16x16x32_bf16 v[252:255], a[252:255], a[60:63], v[252:255]
    ds_read_b64_tr_b16 a[72:73], v12 offset:35840
    v_mfma_f32_16x16x32_bf16 v[248:251], a[252:255], a[56:59], v[248:251]
    ds_read_b64_tr_b16 a[74:75], v12 offset:50176
    v_mfma_f32_16x16x32_bf16 v[248:251], a[248:251], a[40:43], v[248:251]
    ds_read_b64_tr_b16 a[76:77], v12 offset:39424
    v_mfma_f32_16x16x32_bf16 v[244:247], a[248:251], a[36:39], v[244:247]
    s_add_u32 m0, s57, 69632
    ds_read_b64_tr_b16 a[78:79], v12 offset:53760
    v_mfma_f32_16x16x32_bf16 v[244:247], a[252:255], a[52:55], v[244:247]
    ds_read_b64_tr_b16 a[80:81], v12 offset:28704
    v_mfma_f32_16x16x32_bf16 v[240:243], a[252:255], a[48:51], v[240:243]
    buffer_load_dwordx4 v9, s[12:15], s72 offen offset:0 lds
    v_mfma_f32_16x16x32_bf16 v[240:243], a[248:251], a[32:35], v[240:243]
    s_waitcnt lgkmcnt(7)
    ds_read_b64_tr_b16 a[82:83], v12 offset:43040
    v_mfma_f32_16x16x32_bf16 v[32:35], a[64:67], a[0:3], v[32:35]
    s_waitcnt lgkmcnt(6)
    ds_read_b64_tr_b16 a[84:85], v12 offset:32288
    v_mfma_f32_16x16x32_bf16 v[32:35], a[68:71], a[16:19], v[32:35]
    ds_read_b64_tr_b16 a[86:87], v12 offset:46624
    v_mfma_f32_16x16x32_bf16 v[36:39], a[68:71], a[20:23], v[36:39]
    v_mfma_f32_16x16x32_bf16 v[36:39], a[64:67], a[4:7], v[36:39]
    buffer_load_dwordx4 v10, s[12:15], s72 offen offset:1024 lds
    v_mfma_f32_16x16x32_bf16 v[40:43], a[64:67], a[8:11], v[40:43]
    ds_read_b64_tr_b16 a[248:249], v12 offset:35872
    v_mfma_f32_16x16x32_bf16 v[40:43], a[68:71], a[24:27], v[40:43]
    ds_read_b64_tr_b16 a[250:251], v12 offset:50208
    v_mfma_f32_16x16x32_bf16 v[44:47], a[68:71], a[28:31], v[44:47]
    ds_read_b64_tr_b16 a[252:253], v12 offset:39456
    v_mfma_f32_16x16x32_bf16 v[44:47], a[64:67], a[12:15], v[44:47]
    s_waitcnt lgkmcnt(9)
    ds_read_b64_tr_b16 a[254:255], v12 offset:53792
    v_mfma_f32_16x16x32_bf16 v[60:63], a[72:75], a[12:15], v[60:63]
    s_waitcnt lgkmcnt(8)
    v_mfma_f32_16x16x32_bf16 v[60:63], a[76:79], a[28:31], v[60:63]
    buffer_load_dwordx4 v11, s[12:15], s72 offen offset:2048 lds
    v_mfma_f32_16x16x32_bf16 v[56:59], a[76:79], a[24:27], v[56:59]
    s_add_u32 m0, s56, 8192
    v_mfma_f32_16x16x32_bf16 v[56:59], a[72:75], a[8:11], v[56:59]
    s_bfe_u32 s73, s71, 0x40008
    v_mfma_f32_16x16x32_bf16 v[52:55], a[72:75], a[4:7], v[52:55]
    s_lshl_b32 s73, s73, 7
    ds_read_b64_tr_b16 a[64:65], v12 offset:28736
    v_mfma_f32_16x16x32_bf16 v[52:55], a[76:79], a[20:23], v[52:55]
    s_add_u32 s8, s6, s73
    s_addc_u32 s9, s7, 0
    ds_read_b64_tr_b16 a[66:67], v12 offset:43072
    v_mfma_f32_16x16x32_bf16 v[48:51], a[76:79], a[16:19], v[48:51]
    ds_read_b64_tr_b16 a[68:69], v12 offset:32320
    v_mfma_f32_16x16x32_bf16 v[48:51], a[72:75], a[0:3], v[48:51]
    s_waitcnt lgkmcnt(9)
    buffer_load_dwordx4 v1, s[8:11], s48 offen offset:0 lds
    v_mfma_f32_16x16x32_bf16 v[64:67], a[80:83], a[0:3], v[64:67]
    s_waitcnt lgkmcnt(7)
    ds_read_b64_tr_b16 a[70:71], v12 offset:46656
    v_mfma_f32_16x16x32_bf16 v[64:67], a[84:87], a[16:19], v[64:67]
    v_mfma_f32_16x16x32_bf16 v[68:71], a[84:87], a[20:23], v[68:71]
    v_mfma_f32_16x16x32_bf16 v[68:71], a[80:83], a[4:7], v[68:71]
    v_mfma_f32_16x16x32_bf16 v[72:75], a[80:83], a[8:11], v[72:75]
    ds_read_b64_tr_b16 a[72:73], v12 offset:35904
    v_mfma_f32_16x16x32_bf16 v[72:75], a[84:87], a[24:27], v[72:75]
    buffer_load_dwordx4 v2, s[8:11], s49 offen offset:1024 lds
    v_mfma_f32_16x16x32_bf16 v[76:79], a[84:87], a[28:31], v[76:79]
    ds_read_b64_tr_b16 a[74:75], v12 offset:50240
    v_mfma_f32_16x16x32_bf16 v[76:79], a[80:83], a[12:15], v[76:79]
    s_waitcnt lgkmcnt(8)
    ds_read_b64_tr_b16 a[76:77], v12 offset:39488
    v_mfma_f32_16x16x32_bf16 v[92:95], a[248:251], a[12:15], v[92:95]
    s_waitcnt lgkmcnt(7)
    ds_read_b64_tr_b16 a[78:79], v12 offset:53824
    v_mfma_f32_16x16x32_bf16 v[92:95], a[252:255], a[28:31], v[92:95]
    v_mfma_f32_16x16x32_bf16 v[88:91], a[252:255], a[24:27], v[88:91]
    v_mfma_f32_16x16x32_bf16 v[88:91], a[248:251], a[8:11], v[88:91]
    buffer_load_dwordx4 v1, s[8:11], s50 offen offset:2048 lds
    v_mfma_f32_16x16x32_bf16 v[84:87], a[248:251], a[4:7], v[84:87]
    ds_read_b64_tr_b16 a[80:81], v12 offset:28768
    v_mfma_f32_16x16x32_bf16 v[84:87], a[252:255], a[20:23], v[84:87]
    ds_read_b64_tr_b16 a[82:83], v12 offset:43104
    v_mfma_f32_16x16x32_bf16 v[80:83], a[252:255], a[16:19], v[80:83]
    ds_read_b64_tr_b16 a[84:85], v12 offset:32352
    v_mfma_f32_16x16x32_bf16 v[80:83], a[248:251], a[0:3], v[80:83]
    s_waitcnt lgkmcnt(9)
    ds_read_b64_tr_b16 a[86:87], v12 offset:46688
    v_mfma_f32_16x16x32_bf16 v[96:99], a[64:67], a[0:3], v[96:99]
    s_waitcnt lgkmcnt(8)
    buffer_load_dwordx4 v2, s[8:11], s51 offen offset:3072 lds
    v_mfma_f32_16x16x32_bf16 v[96:99], a[68:71], a[16:19], v[96:99]
    s_waitcnt vmcnt(19)
    v_mfma_f32_16x16x32_bf16 v[100:103], a[68:71], a[20:23], v[100:103]
    s_add_u32 m0, s57, 131072
    ds_read_b128 a[32:35], v3 offset:0
    v_mfma_f32_16x16x32_bf16 v[100:103], a[64:67], a[4:7], v[100:103]
    s_bfe_u32 s72, s71, 0x40008
    ds_read_b128 a[48:51], v4 offset:0
    v_mfma_f32_16x16x32_bf16 v[104:107], a[64:67], a[8:11], v[104:107]
    s_mul_i32 s72, s72, 458752
    ds_read_b128 a[36:39], v3 offset:2048
    v_mfma_f32_16x16x32_bf16 v[104:107], a[68:71], a[24:27], v[104:107]
    ds_read_b128 a[52:55], v4 offset:2048
    v_mfma_f32_16x16x32_bf16 v[108:111], a[68:71], a[28:31], v[108:111]
    buffer_load_dwordx4 v5, s[12:15], s72 offen offset:0 lds
    v_mfma_f32_16x16x32_bf16 v[108:111], a[64:67], a[12:15], v[108:111]
    s_waitcnt lgkmcnt(10)
    ds_read_b64_tr_b16 a[248:249], v12 offset:35936
    v_mfma_f32_16x16x32_bf16 v[124:127], a[72:75], a[12:15], v[124:127]
    s_waitcnt lgkmcnt(9)
    ds_read_b64_tr_b16 a[250:251], v12 offset:50272
    v_mfma_f32_16x16x32_bf16 v[124:127], a[76:79], a[28:31], v[124:127]
    ds_read_b64_tr_b16 a[252:253], v12 offset:39520
    v_mfma_f32_16x16x32_bf16 v[120:123], a[76:79], a[24:27], v[120:123]
    s_mov_b32 m0, s56
    ds_read_b64_tr_b16 a[254:255], v12 offset:53856
    s_waitcnt vmcnt(13)
    v_mfma_f32_16x16x32_bf16 v[120:123], a[72:75], a[8:11], v[120:123]
    s_waitcnt lgkmcnt(4)
    ds_read_b64_tr_b16 a[168:169], v14 offset:12288
    v_mfma_f32_16x16x32_bf16 v[116:119], a[72:75], a[4:7], v[116:119]
    buffer_load_dwordx4 v1, s[8:11], s52 offen offset:0 lds
    v_mfma_f32_16x16x32_bf16 v[116:119], a[76:79], a[20:23], v[116:119]
    ds_read_b64_tr_b16 a[172:173], v15 offset:12288
    v_mfma_f32_16x16x32_bf16 v[112:115], a[76:79], a[16:19], v[112:115]
    ds_read_b64_tr_b16 a[176:177], v16 offset:12288
    v_mfma_f32_16x16x32_bf16 v[112:115], a[72:75], a[0:3], v[112:115]
    ds_read_b64_tr_b16 a[180:181], v17 offset:12288
    v_mfma_f32_16x16x32_bf16 v[128:131], a[80:83], a[0:3], v[128:131]
    ds_read_b64_tr_b16 a[170:171], v14 offset:14336
    v_mfma_f32_16x16x32_bf16 v[128:131], a[84:87], a[16:19], v[128:131]
    ds_read_b64_tr_b16 a[174:175], v15 offset:14336
    v_mfma_f32_16x16x32_bf16 v[132:135], a[84:87], a[20:23], v[132:135]
    buffer_load_dwordx4 v2, s[8:11], s53 offen offset:1024 lds
    v_mfma_f32_16x16x32_bf16 v[132:135], a[80:83], a[4:7], v[132:135]
    buffer_load_dword v21, off, s[36:39], 0 sc1
    v_mfma_f32_16x16x32_bf16 v[136:139], a[80:83], a[8:11], v[136:139]
    ds_read_b64_tr_b16 a[178:179], v16 offset:14336
    v_mfma_f32_16x16x32_bf16 v[136:139], a[84:87], a[24:27], v[136:139]
    ds_read_b64_tr_b16 a[64:65], v12 offset:28800
    v_mfma_f32_16x16x32_bf16 v[140:143], a[84:87], a[28:31], v[140:143]
    ds_read_b64_tr_b16 a[66:67], v12 offset:43136
    v_mfma_f32_16x16x32_bf16 v[140:143], a[80:83], a[12:15], v[140:143]
    s_waitcnt lgkmcnt(11)
    ds_read_b64_tr_b16 a[182:183], v17 offset:14336
    v_mfma_f32_16x16x32_bf16 v[156:159], a[248:251], a[12:15], v[156:159]
    s_waitcnt lgkmcnt(10)
    buffer_load_dwordx4 v1, s[8:11], s54 offen offset:2048 lds
    v_mfma_f32_16x16x32_bf16 v[156:159], a[252:255], a[28:31], v[156:159]
    ds_read_b64_tr_b16 a[68:69], v12 offset:32384
    v_mfma_f32_16x16x32_bf16 v[152:155], a[252:255], a[24:27], v[152:155]
    ds_read_b64_tr_b16 a[70:71], v12 offset:46720
    v_mfma_f32_16x16x32_bf16 v[152:155], a[248:251], a[8:11], v[152:155]
    ds_read_b64_tr_b16 a[72:73], v12 offset:35968
    v_mfma_f32_16x16x32_bf16 v[148:151], a[248:251], a[4:7], v[148:151]
    ds_read_b64_tr_b16 a[74:75], v12 offset:50304
    v_mfma_f32_16x16x32_bf16 v[148:151], a[252:255], a[20:23], v[148:151]
    buffer_load_dwordx4 v2, s[8:11], s55 offen offset:3072 lds
    v_mfma_f32_16x16x32_bf16 v[144:147], a[252:255], a[16:19], v[144:147]
    ds_read_b64_tr_b16 a[76:77], v12 offset:39552
    v_mfma_f32_16x16x32_bf16 v[144:147], a[248:251], a[0:3], v[144:147]
    s_waitcnt lgkmcnt(6)
    ds_read_b64_tr_b16 a[78:79], v12 offset:53888
    v_mfma_f32_16x16x32_bf16 v[160:163], a[64:67], a[0:3], v[160:163]
    s_waitcnt lgkmcnt(4)
    ds_read_b64_tr_b16 a[80:81], v12 offset:28832
    v_mfma_f32_16x16x32_bf16 v[160:163], a[68:71], a[16:19], v[160:163]
    s_add_u32 m0, s57, 131072
    ds_read_b64_tr_b16 a[82:83], v12 offset:43168
    v_mfma_f32_16x16x32_bf16 v[164:167], a[68:71], a[20:23], v[164:167]
    ds_read_b64_tr_b16 a[84:85], v12 offset:32416
    v_mfma_f32_16x16x32_bf16 v[164:167], a[64:67], a[4:7], v[164:167]
    buffer_load_dwordx4 v6, s[12:15], s72 offen offset:1024 lds
    v_mfma_f32_16x16x32_bf16 v[168:171], a[64:67], a[8:11], v[168:171]
    ds_read_b64_tr_b16 a[86:87], v12 offset:46752
    v_mfma_f32_16x16x32_bf16 v[168:171], a[68:71], a[24:27], v[168:171]
    ds_read_b64_tr_b16 a[248:249], v12 offset:36000
    v_mfma_f32_16x16x32_bf16 v[172:175], a[68:71], a[28:31], v[172:175]
    ds_read_b64_tr_b16 a[250:251], v12 offset:50336
    v_mfma_f32_16x16x32_bf16 v[172:175], a[64:67], a[12:15], v[172:175]
    s_waitcnt lgkmcnt(8)
    ds_read_b64_tr_b16 a[252:253], v12 offset:39584
    v_mfma_f32_16x16x32_bf16 v[188:191], a[72:75], a[12:15], v[188:191]
    s_waitcnt lgkmcnt(7)
    ds_read_b64_tr_b16 a[254:255], v12 offset:53920
    v_mfma_f32_16x16x32_bf16 v[188:191], a[76:79], a[28:31], v[188:191]
    buffer_load_dwordx4 v7, s[12:15], s72 offen offset:2048 lds
    v_mfma_f32_16x16x32_bf16 v[184:187], a[76:79], a[24:27], v[184:187]
    v_mfma_f32_16x16x32_bf16 v[184:187], a[72:75], a[8:11], v[184:187]
    v_mfma_f32_16x16x32_bf16 v[180:183], a[72:75], a[4:7], v[180:183]
    ds_read_b64_tr_b16 a[64:65], v12 offset:28864
    v_mfma_f32_16x16x32_bf16 v[180:183], a[76:79], a[20:23], v[180:183]
    ds_read_b64_tr_b16 a[66:67], v12 offset:43200
    v_mfma_f32_16x16x32_bf16 v[176:179], a[76:79], a[16:19], v[176:179]
    ds_read_b64_tr_b16 a[68:69], v12 offset:32448
    v_mfma_f32_16x16x32_bf16 v[176:179], a[72:75], a[0:3], v[176:179]
    s_waitcnt lgkmcnt(9)
    buffer_load_dwordx4 v8, s[12:15], s72 offen offset:3072 lds
    v_mfma_f32_16x16x32_bf16 v[192:195], a[80:83], a[0:3], v[192:195]
    s_waitcnt lgkmcnt(7)
    ds_read_b64_tr_b16 a[70:71], v12 offset:46784
    v_mfma_f32_16x16x32_bf16 v[192:195], a[84:87], a[16:19], v[192:195]
    v_mfma_f32_16x16x32_bf16 v[196:199], a[84:87], a[20:23], v[196:199]
    s_add_u32 m0, s56, 12288
    v_mfma_f32_16x16x32_bf16 v[196:199], a[80:83], a[4:7], v[196:199]
    s_add_u32 s68, s76, 32768
    v_mfma_f32_16x16x32_bf16 v[200:203], a[80:83], a[8:11], v[200:203]
    ds_read_b64_tr_b16 a[72:73], v12 offset:36032
    v_mfma_f32_16x16x32_bf16 v[200:203], a[84:87], a[24:27], v[200:203]
    buffer_load_dwordx4 v13, s[16:19], s68 offen offset:0 lds
    v_mfma_f32_16x16x32_bf16 v[204:207], a[84:87], a[28:31], v[204:207]
    ds_read_b64_tr_b16 a[74:75], v12 offset:50368
    v_mfma_f32_16x16x32_bf16 v[204:207], a[80:83], a[12:15], v[204:207]
    s_waitcnt lgkmcnt(8)
    ds_read_b64_tr_b16 a[76:77], v12 offset:39616
    v_mfma_f32_16x16x32_bf16 v[220:223], a[248:251], a[12:15], v[220:223]
    s_waitcnt lgkmcnt(7)
    ds_read_b64_tr_b16 a[78:79], v12 offset:53952
    s_add_u32 s68, s76, 48128
    v_mfma_f32_16x16x32_bf16 v[220:223], a[252:255], a[28:31], v[220:223]
    s_waitcnt vmcnt(20)
    v_mfma_f32_16x16x32_bf16 v[216:219], a[252:255], a[24:27], v[216:219]
    buffer_load_dwordx4 v13, s[16:19], s68 offen offset:1024 lds
    v_mfma_f32_16x16x32_bf16 v[216:219], a[248:251], a[8:11], v[216:219]
    ds_read_b128 a[40:43], v3 offset:4096
    v_mfma_f32_16x16x32_bf16 v[212:215], a[248:251], a[4:7], v[212:215]
L_pad4:
    s_cbranch_vccnz L_pad8
    ds_read_b128 a[56:59], v4 offset:4096
    v_mfma_f32_16x16x32_bf16 v[212:215], a[252:255], a[20:23], v[212:215]
    ds_read_b128 a[44:47], v3 offset:6144
    v_mfma_f32_16x16x32_bf16 v[208:211], a[252:255], a[16:19], v[208:211]
    s_add_u32 s68, s76, 63488
    ds_read_b128 a[60:63], v4 offset:6144
    v_mfma_f32_16x16x32_bf16 v[208:211], a[248:251], a[0:3], v[208:211]
    s_waitcnt lgkmcnt(10)
    v_mfma_f32_16x16x32_bf16 v[224:227], a[64:67], a[0:3], v[224:227]
    s_waitcnt lgkmcnt(8)
    buffer_load_dwordx4 v13, s[16:19], s68 offen offset:2048 lds
    v_mfma_f32_16x16x32_bf16 v[224:227], a[68:71], a[16:19], v[224:227]
    v_mfma_f32_16x16x32_bf16 v[228:231], a[68:71], a[20:23], v[228:231]
    s_waitcnt vmcnt(16) lgkmcnt(4)
    v_mfma_f32_16x16x32_bf16 v[228:231], a[64:67], a[4:7], v[228:231]
    s_barrier
    v_mfma_f32_16x16x32_bf16 v[232:235], a[64:67], a[8:11], v[232:235]
    s_add_u32 s68, s76, 78848
    ds_read_b64_tr_b16 a[80:81], v12 offset:0
    v_mfma_f32_16x16x32_bf16 v[232:235], a[68:71], a[24:27], v[232:235]
    ds_read_b64_tr_b16 a[82:83], v12 offset:14336
    v_mfma_f32_16x16x32_bf16 v[236:239], a[68:71], a[28:31], v[236:239]
    buffer_load_dwordx4 v13, s[16:19], s68 offen offset:3072 lds
    v_mfma_f32_16x16x32_bf16 v[236:239], a[64:67], a[12:15], v[236:239]
    ds_read_b64_tr_b16 a[84:85], v12 offset:3584
    v_mfma_f32_16x16x32_bf16 v[252:255], a[72:75], a[12:15], v[252:255]
    ds_read_b64_tr_b16 a[86:87], v12 offset:17920
    v_mfma_f32_16x16x32_bf16 v[252:255], a[76:79], a[28:31], v[252:255]
    ds_read_b64_tr_b16 a[248:249], v12 offset:7168
    v_mfma_f32_16x16x32_bf16 v[248:251], a[76:79], a[24:27], v[248:251]
    s_add_u32 m0, s57, 135168
    ds_read_b64_tr_b16 a[250:251], v12 offset:21504
    v_mfma_f32_16x16x32_bf16 v[248:251], a[72:75], a[8:11], v[248:251]
    ds_read_b64_tr_b16 a[252:253], v12 offset:10752
    v_mfma_f32_16x16x32_bf16 v[244:247], a[72:75], a[4:7], v[244:247]
    buffer_load_dwordx4 v9, s[12:15], s72 offen offset:0 lds
    v_mfma_f32_16x16x32_bf16 v[244:247], a[76:79], a[20:23], v[244:247]
    ds_read_b64_tr_b16 a[254:255], v12 offset:25088
    v_mfma_f32_16x16x32_bf16 v[240:243], a[76:79], a[16:19], v[240:243]
    ds_read_b64_tr_b16 a[64:65], v12 offset:32
    v_mfma_f32_16x16x32_bf16 v[240:243], a[72:75], a[0:3], v[240:243]
    s_waitcnt lgkmcnt(7)
    ds_read_b64_tr_b16 a[66:67], v12 offset:14368
    v_mfma_f32_16x16x32_bf16 v[32:35], a[80:83], a[32:35], v[32:35]
    s_waitcnt lgkmcnt(6)
    ds_read_b64_tr_b16 a[68:69], v12 offset:3616
    v_mfma_f32_16x16x32_bf16 v[32:35], a[84:87], a[48:51], v[32:35]
    ds_read_b64_tr_b16 a[70:71], v12 offset:17952
    v_mfma_f32_16x16x32_bf16 v[36:39], a[84:87], a[52:55], v[36:39]
    buffer_load_dwordx4 v10, s[12:15], s72 offen offset:1024 lds
    v_mfma_f32_16x16x32_bf16 v[36:39], a[80:83], a[36:39], v[36:39]
    v_mfma_f32_16x16x32_bf16 v[40:43], a[80:83], a[40:43], v[40:43]
    ds_read_b64_tr_b16 a[72:73], v12 offset:7200
    v_mfma_f32_16x16x32_bf16 v[40:43], a[84:87], a[56:59], v[40:43]
    ds_read_b64_tr_b16 a[74:75], v12 offset:21536
    v_mfma_f32_16x16x32_bf16 v[44:47], a[84:87], a[60:63], v[44:47]
    ds_read_b64_tr_b16 a[76:77], v12 offset:10784
    v_mfma_f32_16x16x32_bf16 v[44:47], a[80:83], a[44:47], v[44:47]
    s_waitcnt lgkmcnt(9)
    buffer_load_dwordx4 v11, s[12:15], s72 offen offset:2048 lds
    v_mfma_f32_16x16x32_bf16 v[60:63], a[248:251], a[44:47], v[60:63]
    s_waitcnt lgkmcnt(7)
    ds_read_b64_tr_b16 a[78:79], v12 offset:25120
    s_add_u32 m0, s56, 4096
    v_mfma_f32_16x16x32_bf16 v[60:63], a[252:255], a[60:63], v[60:63]
    s_bfe_u32 s73, s71, 0x4000c
    v_mfma_f32_16x16x32_bf16 v[56:59], a[252:255], a[56:59], v[56:59]
    s_lshl_b32 s73, s73, 7
    v_mfma_f32_16x16x32_bf16 v[56:59], a[248:251], a[40:43], v[56:59]
    s_add_u32 s8, s6, s73
    s_addc_u32 s9, s7, 0
    v_mfma_f32_16x16x32_bf16 v[52:55], a[248:251], a[36:39], v[52:55]
    ds_read_b64_tr_b16 a[80:81], v12 offset:64
    v_mfma_f32_16x16x32_bf16 v[52:55], a[252:255], a[52:55], v[52:55]
    buffer_load_dwordx4 v1, s[8:11], s48 offen offset:0 lds
    v_mfma_f32_16x16x32_bf16 v[48:51], a[252:255], a[48:51], v[48:51]
    ds_read_b64_tr_b16 a[82:83], v12 offset:14400
    v_mfma_f32_16x16x32_bf16 v[48:51], a[248:251], a[32:35], v[48:51]
    s_waitcnt lgkmcnt(8)
    ds_read_b64_tr_b16 a[84:85], v12 offset:3648
    v_mfma_f32_16x16x32_bf16 v[64:67], a[64:67], a[32:35], v[64:67]
    s_waitcnt lgkmcnt(7)
    ds_read_b64_tr_b16 a[86:87], v12 offset:17984
    v_mfma_f32_16x16x32_bf16 v[64:67], a[68:71], a[48:51], v[64:67]
    v_mfma_f32_16x16x32_bf16 v[68:71], a[68:71], a[52:55], v[68:71]
    v_mfma_f32_16x16x32_bf16 v[68:71], a[64:67], a[36:39], v[68:71]
    buffer_load_dwordx4 v2, s[8:11], s49 offen offset:1024 lds
    v_mfma_f32_16x16x32_bf16 v[72:75], a[64:67], a[40:43], v[72:75]
    ds_read_b64_tr_b16 a[248:249], v12 offset:7232
    v_mfma_f32_16x16x32_bf16 v[72:75], a[68:71], a[56:59], v[72:75]
    ds_read_b64_tr_b16 a[250:251], v12 offset:21568
    v_mfma_f32_16x16x32_bf16 v[76:79], a[68:71], a[60:63], v[76:79]
    ds_read_b64_tr_b16 a[252:253], v12 offset:10816
    v_mfma_f32_16x16x32_bf16 v[76:79], a[64:67], a[44:47], v[76:79]
    s_waitcnt lgkmcnt(9)
    ds_read_b64_tr_b16 a[254:255], v12 offset:25152
    v_mfma_f32_16x16x32_bf16 v[92:95], a[72:75], a[44:47], v[92:95]
    s_waitcnt lgkmcnt(8)
    v_mfma_f32_16x16x32_bf16 v[92:95], a[76:79], a[60:63], v[92:95]
    buffer_load_dwordx4 v1, s[8:11], s50 offen offset:2048 lds
    v_mfma_f32_16x16x32_bf16 v[88:91], a[76:79], a[56:59], v[88:91]
    v_mfma_f32_16x16x32_bf16 v[88:91], a[72:75], a[40:43], v[88:91]
    v_mfma_f32_16x16x32_bf16 v[84:87], a[72:75], a[36:39], v[84:87]
    ds_read_b64_tr_b16 a[64:65], v12 offset:96
    v_mfma_f32_16x16x32_bf16 v[84:87], a[76:79], a[52:55], v[84:87]
    ds_read_b64_tr_b16 a[66:67], v12 offset:14432
    v_mfma_f32_16x16x32_bf16 v[80:83], a[76:79], a[48:51], v[80:83]
    ds_read_b64_tr_b16 a[68:69], v12 offset:3680
    v_mfma_f32_16x16x32_bf16 v[80:83], a[72:75], a[32:35], v[80:83]
    s_waitcnt lgkmcnt(9)
    buffer_load_dwordx4 v2, s[8:11], s51 offen offset:3072 lds
    v_mfma_f32_16x16x32_bf16 v[96:99], a[80:83], a[32:35], v[96:99]
    s_waitcnt lgkmcnt(7)
    ds_read_b64_tr_b16 a[70:71], v12 offset:18016
    s_add_u32 m0, s57, 94208
    v_mfma_f32_16x16x32_bf16 v[96:99], a[84:87], a[48:51], v[96:99]
    s_waitcnt vmcnt(20)
    s_bfe_u32 s72, s71, 0x4000c
    v_mfma_f32_16x16x32_bf16 v[100:103], a[84:87], a[52:55], v[100:103]
    s_mul_i32 s72, s72, 458752
    ds_read_b128 a[0:3], v3 offset:8192
    v_mfma_f32_16x16x32_bf16 v[100:103], a[80:83], a[36:39], v[100:103]
    ds_read_b128 a[16:19], v4 offset:8192
    v_mfma_f32_16x16x32_bf16 v[104:107], a[80:83], a[40:43], v[104:107]
    buffer_load_dwordx4 v5, s[12:15], s72 offen offset:0 lds
    v_mfma_f32_16x16x32_bf16 v[104:107], a[84:87], a[56:59], v[104:107]
    ds_read_b128 a[4:7], v3 offset:10240
    v_mfma_f32_16x16x32_bf16 v[108:111], a[84:87], a[60:63], v[108:111]
    ds_read_b128 a[20:23], v4 offset:10240
    v_mfma_f32_16x16x32_bf16 v[108:111], a[80:83], a[44:47], v[108:111]
    s_waitcnt lgkmcnt(10)
    ds_read_b64_tr_b16 a[72:73], v12 offset:7264
    v_mfma_f32_16x16x32_bf16 v[124:127], a[248:251], a[44:47], v[124:127]
    s_waitcnt lgkmcnt(9)
    ds_read_b64_tr_b16 a[74:75], v12 offset:21600
    v_mfma_f32_16x16x32_bf16 v[124:127], a[252:255], a[60:63], v[124:127]
    ds_read_b64_tr_b16 a[76:77], v12 offset:10848
    v_mfma_f32_16x16x32_bf16 v[120:123], a[252:255], a[56:59], v[120:123]
    buffer_load_dwordx4 v6, s[12:15], s72 offen offset:1024 lds
    v_mfma_f32_16x16x32_bf16 v[120:123], a[248:251], a[40:43], v[120:123]
    ds_read_b64_tr_b16 a[78:79], v12 offset:25184
    v_mfma_f32_16x16x32_bf16 v[116:119], a[248:251], a[36:39], v[116:119]
    ds_read_b64_tr_b16 a[80:81], v12 offset:128
    v_mfma_f32_16x16x32_bf16 v[116:119], a[252:255], a[52:55], v[116:119]
    ds_read_b64_tr_b16 a[82:83], v12 offset:14464
    v_mfma_f32_16x16x32_bf16 v[112:115], a[252:255], a[48:51], v[112:115]
    s_add_u32 m0, s56, 8192
    ds_read_b64_tr_b16 a[84:85], v12 offset:3712
    v_mfma_f32_16x16x32_bf16 v[112:115], a[248:251], a[32:35], v[112:115]
    s_waitcnt lgkmcnt(13)
    ds_read_b64_tr_b16 a[86:87], v12 offset:18048
    s_waitcnt lgkmcnt(8)
    v_mfma_f32_16x16x32_bf16 v[128:131], a[64:67], a[32:35], v[128:131]
    buffer_load_dwordx4 v1, s[8:11], s52 offen offset:0 lds
    v_mfma_f32_16x16x32_bf16 v[128:131], a[68:71], a[48:51], v[128:131]
    v_mfma_f32_16x16x32_bf16 v[132:135], a[68:71], a[52:55], v[132:135]
    v_mfma_f32_16x16x32_bf16 v[132:135], a[64:67], a[36:39], v[132:135]
    v_mfma_f32_16x16x32_bf16 v[136:139], a[64:67], a[40:43], v[136:139]
    ds_read_b64_tr_b16 a[248:249], v12 offset:7296
    v_mfma_f32_16x16x32_bf16 v[136:139], a[68:71], a[56:59], v[136:139]
    ds_read_b64_tr_b16 a[250:251], v12 offset:21632
    v_mfma_f32_16x16x32_bf16 v[140:143], a[68:71], a[60:63], v[140:143]
    buffer_load_dwordx4 v2, s[8:11], s53 offen offset:1024 lds
    v_mfma_f32_16x16x32_bf16 v[140:143], a[64:67], a[44:47], v[140:143]
    s_waitcnt lgkmcnt(8)
    ds_read_b64_tr_b16 a[252:253], v12 offset:10880
    v_mfma_f32_16x16x32_bf16 v[156:159], a[72:75], a[44:47], v[156:159]
    s_waitcnt lgkmcnt(7)
    ds_read_b64_tr_b16 a[254:255], v12 offset:25216
    v_mfma_f32_16x16x32_bf16 v[156:159], a[76:79], a[60:63], v[156:159]
    v_mfma_f32_16x16x32_bf16 v[152:155], a[76:79], a[56:59], v[152:155]
    v_mfma_f32_16x16x32_bf16 v[152:155], a[72:75], a[40:43], v[152:155]
    v_mfma_f32_16x16x32_bf16 v[148:151], a[72:75], a[36:39], v[148:151]
    buffer_load_dwordx4 v1, s[8:11], s54 offen offset:2048 lds
    v_mfma_f32_16x16x32_bf16 v[148:151], a[76:79], a[52:55], v[148:151]
    ds_read_b64_tr_b16 a[64:65], v12 offset:160
    v_mfma_f32_16x16x32_bf16 v[144:147], a[76:79], a[48:51], v[144:147]
    ds_read_b64_tr_b16 a[66:67], v12 offset:14496
    v_mfma_f32_16x16x32_bf16 v[144:147], a[72:75], a[32:35], v[144:147]
    s_waitcnt lgkmcnt(8)
    ds_read_b64_tr_b16 a[68:69], v12 offset:3744
    v_mfma_f32_16x16x32_bf16 v[160:163], a[80:83], a[32:35], v[160:163]
    s_waitcnt lgkmcnt(7)
    ds_read_b64_tr_b16 a[70:71], v12 offset:18080
    v_mfma_f32_16x16x32_bf16 v[160:163], a[84:87], a[48:51], v[160:163]
    buffer_load_dwordx4 v2, s[8:11], s55 offen offset:3072 lds
    v_mfma_f32_16x16x32_bf16 v[164:167], a[84:87], a[52:55], v[164:167]
    v_mfma_f32_16x16x32_bf16 v[164:167], a[80:83], a[36:39], v[164:167]
    v_mfma_f32_16x16x32_bf16 v[168:171], a[80:83], a[40:43], v[168:171]
    ds_read_b64_tr_b16 a[72:73], v12 offset:7328
    v_mfma_f32_16x16x32_bf16 v[168:171], a[84:87], a[56:59], v[168:171]
    s_add_u32 m0, s57, 94208
    ds_read_b64_tr_b16 a[74:75], v12 offset:21664
    s_waitcnt vmcnt(13)
    v_mfma_f32_16x16x32_bf16 v[172:175], a[84:87], a[60:63], v[172:175]
    ds_read_b64_tr_b16 a[184:185], v14 offset:12288
    v_mfma_f32_16x16x32_bf16 v[172:175], a[80:83], a[44:47], v[172:175]
    s_waitcnt lgkmcnt(9)
    buffer_load_dwordx4 v7, s[12:15], s72 offen offset:2048 lds
    v_mfma_f32_16x16x32_bf16 v[188:191], a[248:251], a[44:47], v[188:191]
    s_waitcnt lgkmcnt(7)
    ds_read_b64_tr_b16 a[188:189], v15 offset:12288
    v_mfma_f32_16x16x32_bf16 v[188:191], a[252:255], a[60:63], v[188:191]
    ds_read_b64_tr_b16 a[192:193], v16 offset:12288
    v_mfma_f32_16x16x32_bf16 v[184:187], a[252:255], a[56:59], v[184:187]
    ds_read_b64_tr_b16 a[196:197], v17 offset:12288
    v_mfma_f32_16x16x32_bf16 v[184:187], a[248:251], a[40:43], v[184:187]
    ds_read_b64_tr_b16 a[186:187], v14 offset:14336
    v_mfma_f32_16x16x32_bf16 v[180:183], a[248:251], a[36:39], v[180:183]
    ds_read_b64_tr_b16 a[76:77], v12 offset:10912
    v_mfma_f32_16x16x32_bf16 v[180:183], a[252:255], a[52:55], v[180:183]
    buffer_load_dwordx4 v8, s[12:15], s72 offen offset:3072 lds
    v_mfma_f32_16x16x32_bf16 v[176:179], a[252:255], a[48:51], v[176:179]
    ds_read_b64_tr_b16 a[78:79], v12 offset:25248
    v_mfma_f32_16x16x32_bf16 v[176:179], a[248:251], a[32:35], v[176:179]
    s_waitcnt lgkmcnt(11)
    ds_read_b64_tr_b16 a[190:191], v15 offset:14336
    v_mfma_f32_16x16x32_bf16 v[192:195], a[64:67], a[32:35], v[192:195]
    s_waitcnt lgkmcnt(10)
    ds_read_b64_tr_b16 a[194:195], v16 offset:14336
    v_mfma_f32_16x16x32_bf16 v[192:195], a[68:71], a[48:51], v[192:195]
    s_add_u32 m0, s57, 98304
    ds_read_b64_tr_b16 a[198:199], v17 offset:14336
    v_mfma_f32_16x16x32_bf16 v[196:199], a[68:71], a[52:55], v[196:199]
    ds_read_b64_tr_b16 a[80:81], v12 offset:192
    v_mfma_f32_16x16x32_bf16 v[196:199], a[64:67], a[36:39], v[196:199]
    buffer_load_dwordx4 v9, s[12:15], s72 offen offset:0 lds
    v_mfma_f32_16x16x32_bf16 v[200:203], a[64:67], a[40:43], v[200:203]
    ds_read_b64_tr_b16 a[82:83], v12 offset:14528
    v_mfma_f32_16x16x32_bf16 v[200:203], a[68:71], a[56:59], v[200:203]
    ds_read_b64_tr_b16 a[84:85], v12 offset:3776
    v_mfma_f32_16x16x32_bf16 v[204:207], a[68:71], a[60:63], v[204:207]
    ds_read_b64_tr_b16 a[86:87], v12 offset:18112
    v_mfma_f32_16x16x32_bf16 v[204:207], a[64:67], a[44:47], v[204:207]
    s_waitcnt lgkmcnt(14)
    ds_read_b64_tr_b16 a[248:249], v12 offset:7360
    v_mfma_f32_16x16x32_bf16 v[220:223], a[72:75], a[44:47], v[220:223]
    s_waitcnt lgkmcnt(8)
    ds_read_b64_tr_b16 a[250:251], v12 offset:21696
    v_mfma_f32_16x16x32_bf16 v[220:223], a[76:79], a[60:63], v[220:223]
    buffer_load_dwordx4 v10, s[12:15], s72 offen offset:1024 lds
    v_mfma_f32_16x16x32_bf16 v[216:219], a[76:79], a[56:59], v[216:219]
    ds_read_b128 a[8:11], v3 offset:0
    v_mfma_f32_16x16x32_bf16 v[216:219], a[72:75], a[40:43], v[216:219]
    ds_read_b128 a[24:27], v4 offset:0
    v_mfma_f32_16x16x32_bf16 v[212:215], a[72:75], a[36:39], v[212:215]
    ds_read_b128 a[12:15], v3 offset:2048
    v_mfma_f32_16x16x32_bf16 v[212:215], a[76:79], a[52:55], v[212:215]
    ds_read_b128 a[28:31], v4 offset:2048
    v_mfma_f32_16x16x32_bf16 v[208:211], a[76:79], a[48:51], v[208:211]
    buffer_load_dwordx4 v11, s[12:15], s72 offen offset:2048 lds
    v_mfma_f32_16x16x32_bf16 v[208:211], a[72:75], a[32:35], v[208:211]
    s_waitcnt lgkmcnt(8)
    ds_read_b64_tr_b16 a[252:253], v12 offset:10944
    s_mov_b32 m0, s56
    v_mfma_f32_16x16x32_bf16 v[224:227], a[80:83], a[32:35], v[224:227]
    s_waitcnt lgkmcnt(7)
    ds_read_b64_tr_b16 a[254:255], v12 offset:25280
    s_bfe_u32 s73, s71, 0x40010
    v_mfma_f32_16x16x32_bf16 v[224:227], a[84:87], a[48:51], v[224:227]
    s_lshl_b32 s73, s73, 7
    v_mfma_f32_16x16x32_bf16 v[228:231], a[84:87], a[52:55], v[228:231]
    s_waitcnt vmcnt(15) lgkmcnt(0)
    s_add_u32 s8, s6, s73
    s_addc_u32 s9, s7, 0
    v_mfma_f32_16x16x32_bf16 v[228:231], a[80:83], a[36:39], v[228:231]
    s_barrier
    v_mfma_f32_16x16x32_bf16 v[232:235], a[80:83], a[40:43], v[232:235]
    buffer_load_dwordx4 v1, s[8:11], s48 offen offset:0 lds
    v_mfma_f32_16x16x32_bf16 v[232:235], a[84:87], a[56:59], v[232:235]
    ds_read_b64_tr_b16 a[64:65], v30 offset:0
    v_mfma_f32_16x16x32_bf16 v[236:239], a[84:87], a[60:63], v[236:239]
    ds_read_b64_tr_b16 a[66:67], v30 offset:14336
    v_mfma_f32_16x16x32_bf16 v[236:239], a[80:83], a[44:47], v[236:239]
    ds_read_b64_tr_b16 a[68:69], v30 offset:3584
    v_mfma_f32_16x16x32_bf16 v[252:255], a[248:251], a[44:47], v[252:255]
    ds_read_b64_tr_b16 a[70:71], v30 offset:17920
    v_mfma_f32_16x16x32_bf16 v[252:255], a[252:255], a[60:63], v[252:255]
    ds_read_b64_tr_b16 a[72:73], v30 offset:7168
    v_mfma_f32_16x16x32_bf16 v[248:251], a[252:255], a[56:59], v[248:251]
    v_cmp_gt_u32 vcc, 1, v21
    s_cbranch_vccnz L_slow_cnt
L_back_cnt:
    v_mfma_f32_16x16x32_bf16 v[248:251], a[248:251], a[40:43], v[248:251]
    buffer_load_dwordx4 v2, s[8:11], s49 offen offset:1024 lds
    v_mfma_f32_16x16x32_bf16 v[244:247], a[248:251], a[36:39], v[244:247]
    ds_read_b64_tr_b16 a[74:75], v30 offset:21504
    v_mfma_f32_16x16x32_bf16 v[244:247], a[252:255], a[52:55], v[244:247]
    s_add_u32 m0, s56, 12288
    ds_read_b64_tr_b16 a[76:77], v30 offset:10752
    v_mfma_f32_16x16x32_bf16 v[240:243], a[252:255], a[48:51], v[240:243]
    s_add_u32 s68, s77, 32768
    ds_read_b64_tr_b16 a[78:79], v30 offset:25088
    v_mfma_f32_16x16x32_bf16 v[240:243], a[248:251], a[32:35], v[240:243]
    s_waitcnt lgkmcnt(6)
    ds_read_b64_tr_b16 a[80:81], v30 offset:32
    v_mfma_f32_16x16x32_bf16 v[32:35], a[64:67], a[0:3], v[32:35]
    s_waitcnt lgkmcnt(5)
    buffer_load_dwordx4 v13, s[16:19], s68 offen offset:0 lds
    v_mfma_f32_16x16x32_bf16 v[32:35], a[68:71], a[16:19], v[32:35]
    ds_read_b64_tr_b16 a[82:83], v30 offset:14368
    v_mfma_f32_16x16x32_bf16 v[36:39], a[68:71], a[20:23], v[36:39]
    ds_read_b64_tr_b16 a[84:85], v30 offset:3616
    v_mfma_f32_16x16x32_bf16 v[36:39], a[64:67], a[4:7], v[36:39]
    ds_read_b64_tr_b16 a[86:87], v30 offset:17952
    v_mfma_f32_16x16x32_bf16 v[40:43], a[64:67], a[8:11], v[40:43]
    s_add_u32 s68, s77, 48128
    ds_read_b64_tr_b16 a[248:249], v30 offset:7200
    v_mfma_f32_16x16x32_bf16 v[40:43], a[68:71], a[24:27], v[40:43]
    ds_read_b64_tr_b16 a[250:251], v30 offset:21536
    v_mfma_f32_16x16x32_bf16 v[44:47], a[68:71], a[28:31], v[44:47]
    buffer_load_dwordx4 v13, s[16:19], s68 offen offset:1024 lds
    v_mfma_f32_16x16x32_bf16 v[44:47], a[64:67], a[12:15], v[44:47]
    s_waitcnt lgkmcnt(8)
    ds_read_b64_tr_b16 a[252:253], v30 offset:10784
    v_mfma_f32_16x16x32_bf16 v[60:63], a[72:75], a[12:15], v[60:63]
    s_waitcnt lgkmcnt(7)
    ds_read_b64_tr_b16 a[254:255], v30 offset:25120
    v_mfma_f32_16x16x32_bf16 v[60:63], a[76:79], a[28:31], v[60:63]
    s_add_u32 s68, s77, 63488
    v_mfma_f32_16x16x32_bf16 v[56:59], a[76:79], a[24:27], v[56:59]
    v_mfma_f32_16x16x32_bf16 v[56:59], a[72:75], a[8:11], v[56:59]
    buffer_load_dwordx4 v13, s[16:19], s68 offen offset:2048 lds
    v_mfma_f32_16x16x32_bf16 v[52:55], a[72:75], a[4:7], v[52:55]
    ds_read_b64_tr_b16 a[64:65], v30 offset:64
    v_mfma_f32_16x16x32_bf16 v[52:55], a[76:79], a[20:23], v[52:55]
    ds_read_b64_tr_b16 a[66:67], v30 offset:14400
    v_mfma_f32_16x16x32_bf16 v[48:51], a[76:79], a[16:19], v[48:51]
    ds_read_b64_tr_b16 a[68:69], v30 offset:3648
    v_mfma_f32_16x16x32_bf16 v[48:51], a[72:75], a[0:3], v[48:51]
    s_waitcnt lgkmcnt(9)
    ds_read_b64_tr_b16 a[70:71], v30 offset:17984
    s_add_u32 s68, s77, 78848
    v_mfma_f32_16x16x32_bf16 v[64:67], a[80:83], a[0:3], v[64:67]
    s_waitcnt lgkmcnt(8)
    v_mfma_f32_16x16x32_bf16 v[64:67], a[84:87], a[16:19], v[64:67]
    buffer_load_dwordx4 v13, s[16:19], s68 offen offset:3072 lds
    v_mfma_f32_16x16x32_bf16 v[68:71], a[84:87], a[20:23], v[68:71]
    v_mfma_f32_16x16x32_bf16 v[68:71], a[80:83], a[4:7], v[68:71]
    v_mfma_f32_16x16x32_bf16 v[72:75], a[80:83], a[8:11], v[72:75]
    ds_read_b64_tr_b16 a[72:73], v30 offset:7232
    v_mfma_f32_16x16x32_bf16 v[72:75], a[84:87], a[24:27], v[72:75]
    s_mov_b32 m0, s56
    ds_read_b64_tr_b16 a[74:75], v30 offset:21568
    v_mfma_f32_16x16x32_bf16 v[76:79], a[84:87], a[28:31], v[76:79]
    ds_read_b64_tr_b16 a[76:77], v30 offset:10816
    v_mfma_f32_16x16x32_bf16 v[76:79], a[80:83], a[12:15], v[76:79]
    s_waitcnt lgkmcnt(9)
    buffer_load_dwordx4 v1, s[8:11], s50 offen offset:2048 lds
    v_mfma_f32_16x16x32_bf16 v[92:95], a[248:251], a[12:15], v[92:95]
    s_waitcnt lgkmcnt(7)
    ds_read_b64_tr_b16 a[78:79], v30 offset:25152
    v_mfma_f32_16x16x32_bf16 v[92:95], a[252:255], a[28:31], v[92:95]
    v_mfma_f32_16x16x32_bf16 v[88:91], a[252:255], a[24:27], v[88:91]
    v_mfma_f32_16x16x32_bf16 v[88:91], a[248:251], a[8:11], v[88:91]
    v_mfma_f32_16x16x32_bf16 v[84:87], a[248:251], a[4:7], v[84:87]
    ds_read_b64_tr_b16 a[80:81], v30 offset:96
    v_mfma_f32_16x16x32_bf16 v[84:87], a[252:255], a[20:23], v[84:87]
    buffer_load_dwordx4 v2, s[8:11], s51 offen offset:3072 lds
    v_mfma_f32_16x16x32_bf16 v[80:83], a[252:255], a[16:19], v[80:83]
    global_load_dword v23, v22, s[4:5]
    v_mfma_f32_16x16x32_bf16 v[80:83], a[248:251], a[0:3], v[80:83]
    s_waitcnt lgkmcnt(7)
    ds_read_b64_tr_b16 a[82:83], v30 offset:14432
    s_add_u32 m0, s57, 65536
    v_mfma_f32_16x16x32_bf16 v[96:99], a[64:67], a[0:3], v[96:99]
    s_waitcnt lgkmcnt(6)
    ds_read_b64_tr_b16 a[84:85], v30 offset:3680
    s_bfe_u32 s72, s71, 0x40010
    v_mfma_f32_16x16x32_bf16 v[96:99], a[68:71], a[16:19], v[96:99]
    s_mul_i32 s72, s72, 458752
    ds_read_b64_tr_b16 a[86:87], v30 offset:18016
    s_waitcnt vmcnt(20)
    v_mfma_f32_16x16x32_bf16 v[100:103], a[68:71], a[20:23], v[100:103]
    ds_read_b128 a[32:35], v3 offset:4096
    v_mfma_f32_16x16x32_bf16 v[100:103], a[64:67], a[4:7], v[100:103]
    buffer_load_dwordx4 v5, s[12:15], s72 offen offset:0 lds
    v_mfma_f32_16x16x32_bf16 v[104:107], a[64:67], a[8:11], v[104:107]
    ds_read_b128 a[48:51], v4 offset:4096
    v_mfma_f32_16x16x32_bf16 v[104:107], a[68:71], a[24:27], v[104:107]
    ds_read_b128 a[36:39], v3 offset:6144
    v_mfma_f32_16x16x32_bf16 v[108:111], a[68:71], a[28:31], v[108:111]
    ds_read_b128 a[52:55], v4 offset:6144
    v_mfma_f32_16x16x32_bf16 v[108:111], a[64:67], a[12:15], v[108:111]
    s_waitcnt lgkmcnt(10)
    ds_read_b64_tr_b16 a[248:249], v30 offset:7264
    v_mfma_f32_16x16x32_bf16 v[124:127], a[72:75], a[12:15], v[124:127]
    s_waitcnt lgkmcnt(9)
    buffer_load_dwordx4 v6, s[12:15], s72 offen offset:1024 lds
    v_mfma_f32_16x16x32_bf16 v[124:127], a[76:79], a[28:31], v[124:127]
    ds_read_b64_tr_b16 a[250:251], v30 offset:21600
    v_mfma_f32_16x16x32_bf16 v[120:123], a[76:79], a[24:27], v[120:123]
    ds_read_b64_tr_b16 a[252:253], v30 offset:10848
    v_mfma_f32_16x16x32_bf16 v[120:123], a[72:75], a[8:11], v[120:123]
    ds_read_b64_tr_b16 a[254:255], v30 offset:25184
    v_mfma_f32_16x16x32_bf16 v[116:119], a[72:75], a[4:7], v[116:119]
    s_add_u32 m0, s56, 4096
    ds_read_b64_tr_b16 a[64:65], v30 offset:128
    v_mfma_f32_16x16x32_bf16 v[116:119], a[76:79], a[20:23], v[116:119]
    s_waitcnt lgkmcnt(5)
    ds_read_b64_tr_b16 a[66:67], v30 offset:14464
    v_mfma_f32_16x16x32_bf16 v[112:115], a[76:79], a[16:19], v[112:115]
    buffer_load_dwordx4 v1, s[8:11], s52 offen offset:0 lds
    v_mfma_f32_16x16x32_bf16 v[112:115], a[72:75], a[0:3], v[112:115]
    ds_read_b64_tr_b16 a[68:69], v30 offset:3712
    v_mfma_f32_16x16x32_bf16 v[128:131], a[80:83], a[0:3], v[128:131]
    ds_read_b64_tr_b16 a[70:71], v30 offset:18048
    v_mfma_f32_16x16x32_bf16 v[128:131], a[84:87], a[16:19], v[128:131]
    v_mfma_f32_16x16x32_bf16 v[132:135], a[84:87], a[20:23], v[132:135]
    v_mfma_f32_16x16x32_bf16 v[132:135], a[80:83], a[4:7], v[132:135]
    v_mfma_f32_16x16x32_bf16 v[136:139], a[80:83], a[8:11], v[136:139]
    buffer_load_dwordx4 v2, s[8:11], s53 offen offset:1024 lds
    v_mfma_f32_16x16x32_bf16 v[136:139], a[84:87], a[24:27], v[136:139]
    ds_read_b64_tr_b16 a[72:73], v30 offset:7296
    v_mfma_f32_16x16x32_bf16 v[140:143], a[84:87], a[28:31], v[140:143]
    ds_read_b64_tr_b16 a[74:75], v30 offset:21632
    v_mfma_f32_16x16x32_bf16 v[140:143], a[80:83], a[12:15], v[140:143]
    s_waitcnt lgkmcnt(8)
    ds_read_b64_tr_b16 a[76:77], v30 offset:10880
    v_mfma_f32_16x16x32_bf16 v[156:159], a[248:251], a[12:15], v[156:159]
    s_waitcnt lgkmcnt(7)
    ds_read_b64_tr_b16 a[78:79], v30 offset:25216
    v_mfma_f32_16x16x32_bf16 v[156:159], a[252:255], a[28:31], v[156:159]
    v_mfma_f32_16x16x32_bf16 v[152:155], a[252:255], a[24:27], v[152:155]
    buffer_load_dwordx4 v1, s[8:11], s54 offen offset:2048 lds
    v_mfma_f32_16x16x32_bf16 v[152:155], a[248:251], a[8:11], v[152:155]
    v_mfma_f32_16x16x32_bf16 v[148:151], a[248:251], a[4:7], v[148:151]
    ds_read_b64_tr_b16 a[80:81], v30 offset:160
    v_mfma_f32_16x16x32_bf16 v[148:151], a[252:255], a[20:23], v[148:151]
    ds_read_b64_tr_b16 a[82:83], v30 offset:14496
    v_mfma_f32_16x16x32_bf16 v[144:147], a[252:255], a[16:19], v[144:147]
    ds_read_b64_tr_b16 a[84:85], v30 offset:3744
    v_mfma_f32_16x16x32_bf16 v[144:147], a[248:251], a[0:3], v[144:147]
    s_waitcnt lgkmcnt(9)
    ds_read_b64_tr_b16 a[86:87], v30 offset:18080
    v_mfma_f32_16x16x32_bf16 v[160:163], a[64:67], a[0:3], v[160:163]
    s_waitcnt lgkmcnt(8)
    buffer_load_dwordx4 v2, s[8:11], s55 offen offset:3072 lds
    v_mfma_f32_16x16x32_bf16 v[160:163], a[68:71], a[16:19], v[160:163]
    v_mfma_f32_16x16x32_bf16 v[164:167], a[68:71], a[20:23], v[164:167]
    v_mfma_f32_16x16x32_bf16 v[164:167], a[64:67], a[4:7], v[164:167]
    s_add_u32 m0, s57, 65536
    v_mfma_f32_16x16x32_bf16 v[168:171], a[64:67], a[8:11], v[168:171]
    ds_read_b64_tr_b16 a[248:249], v30 offset:7328
    v_mfma_f32_16x16x32_bf16 v[168:171], a[68:71], a[24:27], v[168:171]
    buffer_load_dwordx4 v7, s[12:15], s72 offen offset:2048 lds
    v_mfma_f32_16x16x32_bf16 v[172:175], a[68:71], a[28:31], v[172:175]
    ds_read_b64_tr_b16 a[250:251], v30 offset:21664
    v_mfma_f32_16x16x32_bf16 v[172:175], a[64:67], a[12:15], v[172:175]
    s_waitcnt lgkmcnt(8)
    ds_read_b64_tr_b16 a[252:253], v30 offset:10912
    v_mfma_f32_16x16x32_bf16 v[188:191], a[72:75], a[12:15], v[188:191]
    s_waitcnt lgkmcnt(7)
    ds_read_b64_tr_b16 a[254:255], v30 offset:25248
    v_mfma_f32_16x16x32_bf16 v[188:191], a[76:79], a[28:31], v[188:191]
    v_mfma_f32_16x16x32_bf16 v[184:187], a[76:79], a[24:27], v[184:187]
    v_mfma_f32_16x16x32_bf16 v[184:187], a[72:75], a[8:11], v[184:187]
    buffer_load_dwordx4 v8, s[12:15], s72 offen offset:3072 lds
    v_mfma_f32_16x16x32_bf16 v[180:183], a[72:75], a[4:7], v[180:183]
    ds_read_b64_tr_b16 a[64:65], v30 offset:192
    v_mfma_f32_16x16x32_bf16 v[180:183], a[76:79], a[20:23], v[180:183]
    ds_read_b64_tr_b16 a[66:67], v30 offset:14528
    v_mfma_f32_16x16x32_bf16 v[176:179], a[76:79], a[16:19], v[176:179]
    ds_read_b64_tr_b16 a[68:69], v30 offset:3776
    v_mfma_f32_16x16x32_bf16 v[176:179], a[72:75], a[0:3], v[176:179]
    s_waitcnt lgkmcnt(9)
    ds_read_b64_tr_b16 a[70:71], v30 offset:18112
    s_add_u32 m0, s57, 69632
    v_mfma_f32_16x16x32_bf16 v[192:195], a[80:83], a[0:3], v[192:195]
    s_waitcnt lgkmcnt(8)
    v_mfma_f32_16x16x32_bf16 v[192:195], a[84:87], a[16:19], v[192:195]
    buffer_load_dwordx4 v9, s[12:15], s72 offen offset:0 lds
    v_mfma_f32_16x16x32_bf16 v[196:199], a[84:87], a[20:23], v[196:199]
    v_mfma_f32_16x16x32_bf16 v[196:199], a[80:83], a[4:7], v[196:199]
    v_mfma_f32_16x16x32_bf16 v[200:203], a[80:83], a[8:11], v[200:203]
    ds_read_b64_tr_b16 a[72:73], v30 offset:7360
    v_mfma_f32_16x16x32_bf16 v[200:203], a[84:87], a[24:27], v[200:203]
    ds_read_b64_tr_b16 a[74:75], v30 offset:21696
    v_mfma_f32_16x16x32_bf16 v[204:207], a[84:87], a[28:31], v[204:207]
    ds_read_b64_tr_b16 a[76:77], v30 offset:10944
    v_mfma_f32_16x16x32_bf16 v[204:207], a[80:83], a[12:15], v[204:207]
    s_waitcnt lgkmcnt(9)
    buffer_load_dwordx4 v10, s[12:15], s72 offen offset:1024 lds
    v_mfma_f32_16x16x32_bf16 v[220:223], a[248:251], a[12:15], v[220:223]
    s_waitcnt lgkmcnt(7)
    ds_read_b64_tr_b16 a[78:79], v30 offset:25280
    v_mfma_f32_16x16x32_bf16 v[220:223], a[252:255], a[28:31], v[220:223]
    s_waitcnt vmcnt(24)
    v_mfma_f32_16x16x32_bf16 v[216:219], a[252:255], a[24:27], v[216:219]
    ds_read_b128 a[40:43], v3 offset:8192
    v_mfma_f32_16x16x32_bf16 v[216:219], a[248:251], a[8:11], v[216:219]
    ds_read_b128 a[56:59], v4 offset:8192
    v_mfma_f32_16x16x32_bf16 v[212:215], a[248:251], a[4:7], v[212:215]
    ds_read_b128 a[44:47], v3 offset:10240
    v_mfma_f32_16x16x32_bf16 v[212:215], a[252:255], a[20:23], v[212:215]
    buffer_load_dwordx4 v11, s[12:15], s72 offen offset:2048 lds
    v_mfma_f32_16x16x32_bf16 v[208:211], a[252:255], a[16:19], v[208:211]
    ds_read_b128 a[60:63], v4 offset:10240
    v_mfma_f32_16x16x32_bf16 v[208:211], a[248:251], a[0:3], v[208:211]
    s_waitcnt lgkmcnt(10)
    s_add_u32 m0, s56, 8192
    v_mfma_f32_16x16x32_bf16 v[224:227], a[64:67], a[0:3], v[224:227]
    s_waitcnt lgkmcnt(8)
    s_bfe_u32 s73, s71, 0x40014
    s_waitcnt vmcnt(14)
    v_mfma_f32_16x16x32_bf16 v[224:227], a[68:71], a[16:19], v[224:227]
    s_lshl_b32 s73, s73, 7
    ds_read_b64_tr_b16 a[200:201], v14 offset:12288
    v_mfma_f32_16x16x32_bf16 v[228:231], a[68:71], a[20:23], v[228:231]
    s_waitcnt lgkmcnt(5)
    ds_read_b64_tr_b16 a[204:205], v15 offset:12288
    s_add_u32 s8, s6, s73
    s_addc_u32 s9, s7, 0
    v_mfma_f32_16x16x32_bf16 v[228:231], a[64:67], a[4:7], v[228:231]
    s_barrier
    ds_read_b64_tr_b16 a[208:209], v16 offset:12288
    s_waitcnt lgkmcnt(3)
    v_mfma_f32_16x16x32_bf16 v[232:235], a[64:67], a[8:11], v[232:235]
    buffer_load_dwordx4 v1, s[8:11], s48 offen offset:0 lds
    v_mfma_f32_16x16x32_bf16 v[232:235], a[68:71], a[24:27], v[232:235]
    ds_read_b64_tr_b16 a[80:81], v12 offset:28672
    v_mfma_f32_16x16x32_bf16 v[236:239], a[68:71], a[28:31], v[236:239]
    ds_read_b64_tr_b16 a[82:83], v12 offset:43008
    v_mfma_f32_16x16x32_bf16 v[236:239], a[64:67], a[12:15], v[236:239]
    ds_read_b64_tr_b16 a[84:85], v12 offset:32256
    v_mfma_f32_16x16x32_bf16 v[252:255], a[72:75], a[12:15], v[252:255]
    ds_read_b64_tr_b16 a[86:87], v12 offset:46592
    v_mfma_f32_16x16x32_bf16 v[252:255], a[76:79], a[28:31], v[252:255]
    buffer_load_dwordx4 v2, s[8:11], s49 offen offset:1024 lds
    v_mfma_f32_16x16x32_bf16 v[248:251], a[76:79], a[24:27], v[248:251]
    ds_read_b64_tr_b16 a[212:213], v17 offset:12288
    v_mfma_f32_16x16x32_bf16 v[248:251], a[72:75], a[8:11], v[248:251]
    ds_read_b64_tr_b16 a[202:203], v14 offset:14336
    v_mfma_f32_16x16x32_bf16 v[244:247], a[72:75], a[4:7], v[244:247]
    ds_read_b64_tr_b16 a[206:207], v15 offset:14336
    v_mfma_f32_16x16x32_bf16 v[244:247], a[76:79], a[20:23], v[244:247]
    ds_read_b64_tr_b16 a[210:211], v16 offset:14336
    v_mfma_f32_16x16x32_bf16 v[240:243], a[76:79], a[16:19], v[240:243]
    ds_read_b64_tr_b16 a[214:215], v17 offset:14336
    v_mfma_f32_16x16x32_bf16 v[240:243], a[72:75], a[0:3], v[240:243]
    s_waitcnt lgkmcnt(7)
    buffer_load_dwordx4 v1, s[8:11], s50 offen offset:2048 lds
    v_mfma_f32_16x16x32_bf16 v[32:35], a[80:83], a[32:35], v[32:35]
    s_waitcnt lgkmcnt(5)
    ds_read_b64_tr_b16 a[248:249], v12 offset:35840
    v_mfma_f32_16x16x32_bf16 v[32:35], a[84:87], a[48:51], v[32:35]
    ds_read_b64_tr_b16 a[250:251], v12 offset:50176
    v_mfma_f32_16x16x32_bf16 v[36:39], a[84:87], a[52:55], v[36:39]
    ds_read_b64_tr_b16 a[252:253], v12 offset:39424
    v_mfma_f32_16x16x32_bf16 v[36:39], a[80:83], a[36:39], v[36:39]
    ds_read_b64_tr_b16 a[254:255], v12 offset:53760
    v_mfma_f32_16x16x32_bf16 v[40:43], a[80:83], a[40:43], v[40:43]
L_pad5:
    s_cbranch_vccnz L_pad9
    ds_read_b64_tr_b16 a[64:65], v12 offset:28704
    v_mfma_f32_16x16x32_bf16 v[40:43], a[84:87], a[56:59], v[40:43]
    buffer_load_dwordx4 v2, s[8:11], s51 offen offset:3072 lds
    v_mfma_f32_16x16x32_bf16 v[44:47], a[84:87], a[60:63], v[44:47]
    ds_read_b64_tr_b16 a[66:67], v12 offset:43040
    v_mfma_f32_16x16x32_bf16 v[44:47], a[80:83], a[44:47], v[44:47]
    s_waitcnt lgkmcnt(4)
    ds_read_b64_tr_b16 a[68:69], v12 offset:32288
    s_add_u32 m0, s57, 131072
    v_mfma_f32_16x16x32_bf16 v[60:63], a[248:251], a[44:47], v[60:63]
    s_waitcnt lgkmcnt(3)
    ds_read_b64_tr_b16 a[70:71], v12 offset:46624
    s_bfe_u32 s72, s71, 0x40014
    v_mfma_f32_16x16x32_bf16 v[60:63], a[252:255], a[60:63], v[60:63]
    s_mul_i32 s72, s72, 458752
    ds_read_b64_tr_b16 a[72:73], v12 offset:35872
    v_mfma_f32_16x16x32_bf16 v[56:59], a[252:255], a[56:59], v[56:59]
    ds_read_b64_tr_b16 a[74:75], v12 offset:50208
    v_mfma_f32_16x16x32_bf16 v[56:59], a[248:251], a[40:43], v[56:59]
    buffer_load_dwordx4 v5, s[12:15], s72 offen offset:0 lds
    v_mfma_f32_16x16x32_bf16 v[52:55], a[248:251], a[36:39], v[52:55]
    ds_read_b64_tr_b16 a[76:77], v12 offset:39456
    v_mfma_f32_16x16x32_bf16 v[52:55], a[252:255], a[52:55], v[52:55]
    ds_read_b64_tr_b16 a[78:79], v12 offset:53792
    v_mfma_f32_16x16x32_bf16 v[48:51], a[252:255], a[48:51], v[48:51]
    ds_read_b64_tr_b16 a[80:81], v12 offset:28736
    v_mfma_f32_16x16x32_bf16 v[48:51], a[248:251], a[32:35], v[48:51]
    s_waitcnt lgkmcnt(7)
    ds_read_b64_tr_b16 a[82:83], v12 offset:43072
    v_mfma_f32_16x16x32_bf16 v[64:67], a[64:67], a[32:35], v[64:67]
    s_waitcnt lgkmcnt(6)
    buffer_load_dwordx4 v6, s[12:15], s72 offen offset:1024 lds
    v_mfma_f32_16x16x32_bf16 v[64:67], a[68:71], a[48:51], v[64:67]
    ds_read_b64_tr_b16 a[84:85], v12 offset:32320
    v_mfma_f32_16x16x32_bf16 v[68:71], a[68:71], a[52:55], v[68:71]
    ds_read_b64_tr_b16 a[86:87], v12 offset:46656
    v_mfma_f32_16x16x32_bf16 v[68:71], a[64:67], a[36:39], v[68:71]
    s_add_u32 m0, s56, 12288
    v_mfma_f32_16x16x32_bf16 v[72:75], a[64:67], a[40:43], v[72:75]
    s_add_u32 s68, s74, 950272
    ds_read_b64_tr_b16 a[248:249], v12 offset:35904
    v_mfma_f32_16x16x32_bf16 v[72:75], a[68:71], a[56:59], v[72:75]
    ds_read_b64_tr_b16 a[250:251], v12 offset:50240
    v_mfma_f32_16x16x32_bf16 v[76:79], a[68:71], a[60:63], v[76:79]
    buffer_load_dwordx4 v13, s[16:19], s68 offen offset:0 lds
    v_mfma_f32_16x16x32_bf16 v[76:79], a[64:67], a[44:47], v[76:79]
    s_waitcnt lgkmcnt(8)
    ds_read_b64_tr_b16 a[252:253], v12 offset:39488
    v_mfma_f32_16x16x32_bf16 v[92:95], a[72:75], a[44:47], v[92:95]
    s_waitcnt lgkmcnt(7)
    ds_read_b64_tr_b16 a[254:255], v12 offset:53824
    v_mfma_f32_16x16x32_bf16 v[92:95], a[76:79], a[60:63], v[92:95]
    v_mfma_f32_16x16x32_bf16 v[88:91], a[76:79], a[56:59], v[88:91]
    s_add_u32 s68, s74, 965632
    v_mfma_f32_16x16x32_bf16 v[88:91], a[72:75], a[40:43], v[88:91]
    v_mfma_f32_16x16x32_bf16 v[84:87], a[72:75], a[36:39], v[84:87]
    buffer_load_dwordx4 v13, s[16:19], s68 offen offset:1024 lds
    v_mfma_f32_16x16x32_bf16 v[84:87], a[76:79], a[52:55], v[84:87]
    ds_read_b64_tr_b16 a[64:65], v12 offset:28768
    v_mfma_f32_16x16x32_bf16 v[80:83], a[76:79], a[48:51], v[80:83]
    ds_read_b64_tr_b16 a[66:67], v12 offset:43104
    v_mfma_f32_16x16x32_bf16 v[80:83], a[72:75], a[32:35], v[80:83]
    s_waitcnt lgkmcnt(8)
    ds_read_b64_tr_b16 a[68:69], v12 offset:32352
    v_mfma_f32_16x16x32_bf16 v[96:99], a[80:83], a[32:35], v[96:99]
    s_waitcnt lgkmcnt(7)
    ds_read_b64_tr_b16 a[70:71], v12 offset:46688
    s_add_u32 s68, s74, 980992
    v_mfma_f32_16x16x32_bf16 v[96:99], a[84:87], a[48:51], v[96:99]
    s_waitcnt vmcnt(20)
    v_mfma_f32_16x16x32_bf16 v[100:103], a[84:87], a[52:55], v[100:103]
    buffer_load_dwordx4 v13, s[16:19], s68 offen offset:2048 lds
    v_mfma_f32_16x16x32_bf16 v[100:103], a[80:83], a[36:39], v[100:103]
    ds_read_b128 a[0:3], v3 offset:0
    v_mfma_f32_16x16x32_bf16 v[104:107], a[80:83], a[40:43], v[104:107]
    ds_read_b128 a[16:19], v4 offset:0
    v_mfma_f32_16x16x32_bf16 v[104:107], a[84:87], a[56:59], v[104:107]
    ds_read_b128 a[4:7], v3 offset:2048
    v_mfma_f32_16x16x32_bf16 v[108:111], a[84:87], a[60:63], v[108:111]
    s_add_u32 s68, s74, 996352
    ds_read_b128 a[20:23], v4 offset:2048
    v_mfma_f32_16x16x32_bf16 v[108:111], a[80:83], a[44:47], v[108:111]
    s_waitcnt lgkmcnt(10)
    ds_read_b64_tr_b16 a[72:73], v12 offset:35936
    v_mfma_f32_16x16x32_bf16 v[124:127], a[248:251], a[44:47], v[124:127]
    s_waitcnt lgkmcnt(9)
    buffer_load_dwordx4 v13, s[16:19], s68 offen offset:3072 lds
    v_mfma_f32_16x16x32_bf16 v[124:127], a[252:255], a[60:63], v[124:127]
    ds_read_b64_tr_b16 a[74:75], v12 offset:50272
    v_mfma_f32_16x16x32_bf16 v[120:123], a[252:255], a[56:59], v[120:123]
    ds_read_b64_tr_b16 a[76:77], v12 offset:39520
    v_mfma_f32_16x16x32_bf16 v[120:123], a[248:251], a[40:43], v[120:123]
    s_mov_b32 m0, s56
    ds_read_b64_tr_b16 a[78:79], v12 offset:53856
    v_mfma_f32_16x16x32_bf16 v[116:119], a[248:251], a[36:39], v[116:119]
    s_waitcnt lgkmcnt(4)
    ds_read_b64_tr_b16 a[80:81], v12 offset:28800
    v_mfma_f32_16x16x32_bf16 v[116:119], a[252:255], a[52:55], v[116:119]
    buffer_load_dwordx4 v1, s[8:11], s52 offen offset:0 lds
    v_mfma_f32_16x16x32_bf16 v[112:115], a[252:255], a[48:51], v[112:115]
    ds_read_b64_tr_b16 a[82:83], v12 offset:43136
    v_mfma_f32_16x16x32_bf16 v[112:115], a[248:251], a[32:35], v[112:115]
    ds_read_b64_tr_b16 a[84:85], v12 offset:32384
    v_mfma_f32_16x16x32_bf16 v[128:131], a[64:67], a[32:35], v[128:131]
    ds_read_b64_tr_b16 a[86:87], v12 offset:46720
    v_mfma_f32_16x16x32_bf16 v[128:131], a[68:71], a[48:51], v[128:131]
    v_mfma_f32_16x16x32_bf16 v[132:135], a[68:71], a[52:55], v[132:135]
    v_mfma_f32_16x16x32_bf16 v[132:135], a[64:67], a[36:39], v[132:135]
    buffer_load_dwordx4 v2, s[8:11], s53 offen offset:1024 lds
    v_mfma_f32_16x16x32_bf16 v[136:139], a[64:67], a[40:43], v[136:139]
    ds_read_b64_tr_b16 a[248:249], v12 offset:35968
    v_mfma_f32_16x16x32_bf16 v[136:139], a[68:71], a[56:59], v[136:139]
    ds_read_b64_tr_b16 a[250:251], v12 offset:50304
    v_mfma_f32_16x16x32_bf16 v[140:143], a[68:71], a[60:63], v[140:143]
    ds_read_b64_tr_b16 a[252:253], v12 offset:39552
    v_mfma_f32_16x16x32_bf16 v[140:143], a[64:67], a[44:47], v[140:143]
    s_waitcnt lgkmcnt(9)
    ds_read_b64_tr_b16 a[254:255], v12 offset:53888
    v_mfma_f32_16x16x32_bf16 v[156:159], a[72:75], a[44:47], v[156:159]
    s_waitcnt lgkmcnt(8)
    v_mfma_f32_16x16x32_bf16 v[156:159], a[76:79], a[60:63], v[156:159]
    buffer_load_dwordx4 v1, s[8:11], s54 offen offset:2048 lds
    v_mfma_f32_16x16x32_bf16 v[152:155], a[76:79], a[56:59], v[152:155]
    v_mfma_f32_16x16x32_bf16 v[152:155], a[72:75], a[40:43], v[152:155]
    v_mfma_f32_16x16x32_bf16 v[148:151], a[72:75], a[36:39], v[148:151]
    ds_read_b64_tr_b16 a[64:65], v12 offset:28832
    v_mfma_f32_16x16x32_bf16 v[148:151], a[76:79], a[52:55], v[148:151]
    ds_read_b64_tr_b16 a[66:67], v12 offset:43168
    v_mfma_f32_16x16x32_bf16 v[144:147], a[76:79], a[48:51], v[144:147]
    ds_read_b64_tr_b16 a[68:69], v12 offset:32416
    v_mfma_f32_16x16x32_bf16 v[144:147], a[72:75], a[32:35], v[144:147]
    s_waitcnt lgkmcnt(9)
    buffer_load_dwordx4 v2, s[8:11], s55 offen offset:3072 lds
    v_mfma_f32_16x16x32_bf16 v[160:163], a[80:83], a[32:35], v[160:163]
    s_waitcnt lgkmcnt(7)
    ds_read_b64_tr_b16 a[70:71], v12 offset:46752
    v_mfma_f32_16x16x32_bf16 v[160:163], a[84:87], a[48:51], v[160:163]
    v_mfma_f32_16x16x32_bf16 v[164:167], a[84:87], a[52:55], v[164:167]
    v_mfma_f32_16x16x32_bf16 v[164:167], a[80:83], a[36:39], v[164:167]
    s_add_u32 m0, s57, 131072
    v_mfma_f32_16x16x32_bf16 v[168:171], a[80:83], a[40:43], v[168:171]
    ds_read_b64_tr_b16 a[72:73], v12 offset:36000
    v_mfma_f32_16x16x32_bf16 v[168:171], a[84:87], a[56:59], v[168:171]
    buffer_load_dwordx4 v7, s[12:15], s72 offen offset:2048 lds
    v_mfma_f32_16x16x32_bf16 v[172:175], a[84:87], a[60:63], v[172:175]
    ds_read_b64_tr_b16 a[74:75], v12 offset:50336
    v_mfma_f32_16x16x32_bf16 v[172:175], a[80:83], a[44:47], v[172:175]
    s_waitcnt lgkmcnt(8)
    ds_read_b64_tr_b16 a[76:77], v12 offset:39584
    v_mfma_f32_16x16x32_bf16 v[188:191], a[248:251], a[44:47], v[188:191]
    s_waitcnt lgkmcnt(7)
    ds_read_b64_tr_b16 a[78:79], v12 offset:53920
    v_mfma_f32_16x16x32_bf16 v[188:191], a[252:255], a[60:63], v[188:191]
    v_mfma_f32_16x16x32_bf16 v[184:187], a[252:255], a[56:59], v[184:187]
    buffer_load_dwordx4 v8, s[12:15], s72 offen offset:3072 lds
    v_mfma_f32_16x16x32_bf16 v[184:187], a[248:251], a[40:43], v[184:187]
    v_mfma_f32_16x16x32_bf16 v[180:183], a[248:251], a[36:39], v[180:183]
    ds_read_b64_tr_b16 a[80:81], v12 offset:28864
    v_mfma_f32_16x16x32_bf16 v[180:183], a[252:255], a[52:55], v[180:183]
    ds_read_b64_tr_b16 a[82:83], v12 offset:43200
    v_mfma_f32_16x16x32_bf16 v[176:179], a[252:255], a[48:51], v[176:179]
    s_add_u32 m0, s57, 135168
    ds_read_b64_tr_b16 a[84:85], v12 offset:32448
    v_mfma_f32_16x16x32_bf16 v[176:179], a[248:251], a[32:35], v[176:179]
    s_waitcnt lgkmcnt(9)
    ds_read_b64_tr_b16 a[86:87], v12 offset:46784
    v_mfma_f32_16x16x32_bf16 v[192:195], a[64:67], a[32:35], v[192:195]
    s_waitcnt lgkmcnt(8)
    buffer_load_dwordx4 v9, s[12:15], s72 offen offset:0 lds
    v_mfma_f32_16x16x32_bf16 v[192:195], a[68:71], a[48:51], v[192:195]
    v_mfma_f32_16x16x32_bf16 v[196:199], a[68:71], a[52:55], v[196:199]
    v_mfma_f32_16x16x32_bf16 v[196:199], a[64:67], a[36:39], v[196:199]
    v_mfma_f32_16x16x32_bf16 v[200:203], a[64:67], a[40:43], v[200:203]
    ds_read_b64_tr_b16 a[248:249], v12 offset:36032
    v_mfma_f32_16x16x32_bf16 v[200:203], a[68:71], a[56:59], v[200:203]
    ds_read_b64_tr_b16 a[250:251], v12 offset:50368
    v_mfma_f32_16x16x32_bf16 v[204:207], a[68:71], a[60:63], v[204:207]
    buffer_load_dwordx4 v10, s[12:15], s72 offen offset:1024 lds
    v_mfma_f32_16x16x32_bf16 v[204:207], a[64:67], a[44:47], v[204:207]
    s_waitcnt lgkmcnt(8)
    ds_read_b64_tr_b16 a[252:253], v12 offset:39616
    v_mfma_f32_16x16x32_bf16 v[220:223], a[72:75], a[44:47], v[220:223]
    s_waitcnt lgkmcnt(7)
    ds_read_b64_tr_b16 a[254:255], v12 offset:53952
    v_mfma_f32_16x16x32_bf16 v[220:223], a[76:79], a[60:63], v[220:223]
    s_waitcnt vmcnt(23)
    v_mfma_f32_16x16x32_bf16 v[216:219], a[76:79], a[56:59], v[216:219]
    ds_read_b128 a[8:11], v3 offset:4096
    v_mfma_f32_16x16x32_bf16 v[216:219], a[72:75], a[40:43], v[216:219]
    ds_read_b128 a[24:27], v4 offset:4096
    v_mfma_f32_16x16x32_bf16 v[212:215], a[72:75], a[36:39], v[212:215]
    buffer_load_dwordx4 v11, s[12:15], s72 offen offset:2048 lds
    v_mfma_f32_16x16x32_bf16 v[212:215], a[76:79], a[52:55], v[212:215]
    ds_read_b128 a[12:15], v3 offset:6144
    v_mfma_f32_16x16x32_bf16 v[208:211], a[76:79], a[48:51], v[208:211]
    ds_read_b128 a[28:31], v4 offset:6144
    v_mfma_f32_16x16x32_bf16 v[208:211], a[72:75], a[32:35], v[208:211]
    s_waitcnt lgkmcnt(10)
    s_add_u32 m0, s56, 4096
    v_mfma_f32_16x16x32_bf16 v[224:227], a[80:83], a[32:35], v[224:227]
    s_waitcnt lgkmcnt(8)
    s_bfe_u32 s73, s71, 0x40018
    v_mfma_f32_16x16x32_bf16 v[224:227], a[84:87], a[48:51], v[224:227]
    s_lshl_b32 s73, s73, 7
    v_mfma_f32_16x16x32_bf16 v[228:231], a[84:87], a[52:55], v[228:231]
    s_waitcnt vmcnt(19) lgkmcnt(4)
    s_add_u32 s8, s6, s73
    s_addc_u32 s9, s7, 0
    v_mfma_f32_16x16x32_bf16 v[228:231], a[80:83], a[36:39], v[228:231]
    s_barrier
    s_waitcnt lgkmcnt(0)
    v_mfma_f32_16x16x32_bf16 v[232:235], a[80:83], a[40:43], v[232:235]
    buffer_load_dwordx4 v1, s[8:11], s48 offen offset:0 lds
    v_mfma_f32_16x16x32_bf16 v[232:235], a[84:87], a[56:59], v[232:235]
    ds_read_b64_tr_b16 a[64:65], v12 offset:0
    v_mfma_f32_16x16x32_bf16 v[236:239], a[84:87], a[60:63], v[236:239]
    ds_read_b64_tr_b16 a[66:67], v12 offset:14336
    v_mfma_f32_16x16x32_bf16 v[236:239], a[80:83], a[44:47], v[236:239]
    ds_read_b64_tr_b16 a[68:69], v12 offset:3584
    v_mfma_f32_16x16x32_bf16 v[252:255], a[248:251], a[44:47], v[252:255]
    ds_read_b64_tr_b16 a[70:71], v12 offset:17920
    v_mfma_f32_16x16x32_bf16 v[252:255], a[252:255], a[60:63], v[252:255]
    buffer_load_dwordx4 v2, s[8:11], s49 offen offset:1024 lds
    v_mfma_f32_16x16x32_bf16 v[248:251], a[252:255], a[56:59], v[248:251]
    ds_read_b64_tr_b16 a[72:73], v12 offset:7168
    v_mfma_f32_16x16x32_bf16 v[248:251], a[248:251], a[40:43], v[248:251]
    ds_read_b64_tr_b16 a[74:75], v12 offset:21504
    v_mfma_f32_16x16x32_bf16 v[244:247], a[248:251], a[36:39], v[244:247]
    ds_read_b64_tr_b16 a[76:77], v12 offset:10752
    v_mfma_f32_16x16x32_bf16 v[244:247], a[252:255], a[52:55], v[244:247]
    ds_read_b64_tr_b16 a[78:79], v12 offset:25088
    v_mfma_f32_16x16x32_bf16 v[240:243], a[252:255], a[48:51], v[240:243]
    ds_read_b64_tr_b16 a[80:81], v12 offset:32
    v_mfma_f32_16x16x32_bf16 v[240:243], a[248:251], a[32:35], v[240:243]
    s_waitcnt lgkmcnt(7)
    buffer_load_dwordx4 v1, s[8:11], s50 offen offset:2048 lds
    v_mfma_f32_16x16x32_bf16 v[32:35], a[64:67], a[0:3], v[32:35]
    s_waitcnt lgkmcnt(5)
    ds_read_b64_tr_b16 a[82:83], v12 offset:14368
    v_mfma_f32_16x16x32_bf16 v[32:35], a[68:71], a[16:19], v[32:35]
    ds_read_b64_tr_b16 a[84:85], v12 offset:3616
    v_mfma_f32_16x16x32_bf16 v[36:39], a[68:71], a[20:23], v[36:39]
    ds_read_b64_tr_b16 a[86:87], v12 offset:17952
    v_mfma_f32_16x16x32_bf16 v[36:39], a[64:67], a[4:7], v[36:39]
    v_mfma_f32_16x16x32_bf16 v[40:43], a[64:67], a[8:11], v[40:43]
    ds_read_b64_tr_b16 a[248:249], v12 offset:7200
    v_mfma_f32_16x16x32_bf16 v[40:43], a[68:71], a[24:27], v[40:43]
    buffer_load_dwordx4 v2, s[8:11], s51 offen offset:3072 lds
    v_mfma_f32_16x16x32_bf16 v[44:47], a[68:71], a[28:31], v[44:47]
    ds_read_b64_tr_b16 a[250:251], v12 offset:21536
    v_mfma_f32_16x16x32_bf16 v[44:47], a[64:67], a[12:15], v[44:47]
    s_waitcnt lgkmcnt(8)
    ds_read_b64_tr_b16 a[252:253], v12 offset:10784
    s_add_u32 m0, s57, 94208
    v_mfma_f32_16x16x32_bf16 v[60:63], a[72:75], a[12:15], v[60:63]
    s_waitcnt lgkmcnt(7)
    ds_read_b64_tr_b16 a[254:255], v12 offset:25120
    s_bfe_u32 s72, s71, 0x40018
    v_mfma_f32_16x16x32_bf16 v[60:63], a[76:79], a[28:31], v[60:63]
    s_mul_i32 s72, s72, 458752
    s_waitcnt vmcnt(13)
    ds_read_b64_tr_b16 a[216:217], v14 offset:12288
    v_mfma_f32_16x16x32_bf16 v[56:59], a[76:79], a[24:27], v[56:59]
    ds_read_b64_tr_b16 a[220:221], v15 offset:12288
    v_mfma_f32_16x16x32_bf16 v[56:59], a[72:75], a[8:11], v[56:59]
    buffer_load_dwordx4 v5, s[12:15], s72 offen offset:0 lds
    v_mfma_f32_16x16x32_bf16 v[52:55], a[72:75], a[4:7], v[52:55]
    ds_read_b64_tr_b16 a[224:225], v16 offset:12288
    v_mfma_f32_16x16x32_bf16 v[52:55], a[76:79], a[20:23], v[52:55]
    ds_read_b64_tr_b16 a[228:229], v17 offset:12288
    v_mfma_f32_16x16x32_bf16 v[48:51], a[76:79], a[16:19], v[48:51]
    ds_read_b64_tr_b16 a[218:219], v14 offset:14336
    v_mfma_f32_16x16x32_bf16 v[48:51], a[72:75], a[0:3], v[48:51]
    s_waitcnt lgkmcnt(11)
    ds_read_b64_tr_b16 a[222:223], v15 offset:14336
    v_mfma_f32_16x16x32_bf16 v[64:67], a[80:83], a[0:3], v[64:67]
    s_waitcnt lgkmcnt(10)
    buffer_load_dwordx4 v6, s[12:15], s72 offen offset:1024 lds
    v_mfma_f32_16x16x32_bf16 v[64:67], a[84:87], a[16:19], v[64:67]
    ds_read_b64_tr_b16 a[226:227], v16 offset:14336
    v_mfma_f32_16x16x32_bf16 v[68:71], a[84:87], a[20:23], v[68:71]
    ds_read_b64_tr_b16 a[230:231], v17 offset:14336
    v_mfma_f32_16x16x32_bf16 v[68:71], a[80:83], a[4:7], v[68:71]
    ds_read_b64_tr_b16 a[64:65], v12 offset:64
    v_mfma_f32_16x16x32_bf16 v[72:75], a[80:83], a[8:11], v[72:75]
    ds_read_b64_tr_b16 a[66:67], v12 offset:14400
    v_mfma_f32_16x16x32_bf16 v[72:75], a[84:87], a[24:27], v[72:75]
    ds_read_b64_tr_b16 a[68:69], v12 offset:3648
    v_mfma_f32_16x16x32_bf16 v[76:79], a[84:87], a[28:31], v[76:79]
    buffer_load_dwordx4 v7, s[12:15], s72 offen offset:2048 lds
    v_mfma_f32_16x16x32_bf16 v[76:79], a[80:83], a[12:15], v[76:79]
    s_waitcnt lgkmcnt(13)
    ds_read_b64_tr_b16 a[70:71], v12 offset:17984
    v_mfma_f32_16x16x32_bf16 v[92:95], a[248:251], a[12:15], v[92:95]
    s_waitcnt lgkmcnt(12)
    ds_read_b64_tr_b16 a[72:73], v12 offset:7232
    v_mfma_f32_16x16x32_bf16 v[92:95], a[252:255], a[28:31], v[92:95]
    ds_read_b64_tr_b16 a[74:75], v12 offset:21568
    v_mfma_f32_16x16x32_bf16 v[88:91], a[252:255], a[24:27], v[88:91]
    ds_read_b64_tr_b16 a[76:77], v12 offset:10816
    v_mfma_f32_16x16x32_bf16 v[88:91], a[248:251], a[8:11], v[88:91]
    ds_read_b64_tr_b16 a[78:79], v12 offset:25152
    v_mfma_f32_16x16x32_bf16 v[84:87], a[248:251], a[4:7], v[84:87]
    buffer_load_dwordx4 v8, s[12:15], s72 offen offset:3072 lds
    v_mfma_f32_16x16x32_bf16 v[84:87], a[252:255], a[20:23], v[84:87]
    ds_read_b64_tr_b16 a[80:81], v12 offset:96
    v_mfma_f32_16x16x32_bf16 v[80:83], a[252:255], a[16:19], v[80:83]
    ds_read_b64_tr_b16 a[82:83], v12 offset:14432
    v_mfma_f32_16x16x32_bf16 v[80:83], a[248:251], a[0:3], v[80:83]
    s_waitcnt lgkmcnt(8)
    ds_read_b64_tr_b16 a[84:85], v12 offset:3680
    v_mfma_f32_16x16x32_bf16 v[96:99], a[64:67], a[0:3], v[96:99]
    s_waitcnt lgkmcnt(7)
    ds_read_b64_tr_b16 a[86:87], v12 offset:18016
    s_add_u32 m0, s57, 98304
    v_mfma_f32_16x16x32_bf16 v[96:99], a[68:71], a[16:19], v[96:99]
    v_mfma_f32_16x16x32_bf16 v[100:103], a[68:71], a[20:23], v[100:103]
    buffer_load_dwordx4 v9, s[12:15], s72 offen offset:0 lds
    v_mfma_f32_16x16x32_bf16 v[100:103], a[64:67], a[4:7], v[100:103]
    ds_read_b128 a[32:35], v3 offset:8192
    v_mfma_f32_16x16x32_bf16 v[104:107], a[64:67], a[8:11], v[104:107]
    ds_read_b128 a[48:51], v4 offset:8192
    v_mfma_f32_16x16x32_bf16 v[104:107], a[68:71], a[24:27], v[104:107]
    ds_read_b128 a[36:39], v3 offset:10240
    v_mfma_f32_16x16x32_bf16 v[108:111], a[68:71], a[28:31], v[108:111]
    ds_read_b128 a[52:55], v4 offset:10240
    v_mfma_f32_16x16x32_bf16 v[108:111], a[64:67], a[12:15], v[108:111]
    s_waitcnt lgkmcnt(10)
    ds_read_b64_tr_b16 a[248:249], v12 offset:7264
    v_mfma_f32_16x16x32_bf16 v[124:127], a[72:75], a[12:15], v[124:127]
    s_waitcnt lgkmcnt(9)
    buffer_load_dwordx4 v10, s[12:15], s72 offen offset:1024 lds
    v_mfma_f32_16x16x32_bf16 v[124:127], a[76:79], a[28:31], v[124:127]
    ds_read_b64_tr_b16 a[250:251], v12 offset:21600
    v_mfma_f32_16x16x32_bf16 v[120:123], a[76:79], a[24:27], v[120:123]
    ds_read_b64_tr_b16 a[252:253], v12 offset:10848
    v_mfma_f32_16x16x32_bf16 v[120:123], a[72:75], a[8:11], v[120:123]
    s_add_u32 m0, s56, 8192
    ds_read_b64_tr_b16 a[254:255], v12 offset:25184
    v_mfma_f32_16x16x32_bf16 v[116:119], a[72:75], a[4:7], v[116:119]
    s_waitcnt lgkmcnt(4)
    ds_read_b64_tr_b16 a[64:65], v12 offset:128
    v_mfma_f32_16x16x32_bf16 v[116:119], a[76:79], a[20:23], v[116:119]
    buffer_load_dwordx4 v1, s[8:11], s52 offen offset:0 lds
    v_mfma_f32_16x16x32_bf16 v[112:115], a[76:79], a[16:19], v[112:115]
    ds_read_b64_tr_b16 a[66:67], v12 offset:14464
    v_mfma_f32_16x16x32_bf16 v[112:115], a[72:75], a[0:3], v[112:115]
    ds_read_b64_tr_b16 a[68:69], v12 offset:3712
    v_mfma_f32_16x16x32_bf16 v[128:131], a[80:83], a[0:3], v[128:131]
    s_add_u32 m0, s56, 12288
    ds_read_b64_tr_b16 a[70:71], v12 offset:18048
    v_mfma_f32_16x16x32_bf16 v[128:131], a[84:87], a[16:19], v[128:131]
    s_add_u32 s68, s75, 950272
    v_mfma_f32_16x16x32_bf16 v[132:135], a[84:87], a[20:23], v[132:135]
    v_mfma_f32_16x16x32_bf16 v[132:135], a[80:83], a[4:7], v[132:135]
    buffer_load_dwordx4 v13, s[16:19], s68 offen offset:0 lds
    v_mfma_f32_16x16x32_bf16 v[136:139], a[80:83], a[8:11], v[136:139]
    ds_read_b64_tr_b16 a[72:73], v12 offset:7296
    v_mfma_f32_16x16x32_bf16 v[136:139], a[84:87], a[24:27], v[136:139]
    ds_read_b64_tr_b16 a[74:75], v12 offset:21632
    v_mfma_f32_16x16x32_bf16 v[140:143], a[84:87], a[28:31], v[140:143]
    ds_read_b64_tr_b16 a[76:77], v12 offset:10880
    v_mfma_f32_16x16x32_bf16 v[140:143], a[80:83], a[12:15], v[140:143]
    s_waitcnt lgkmcnt(9)
    ds_read_b64_tr_b16 a[78:79], v12 offset:25216
    s_add_u32 s68, s75, 965632
    v_mfma_f32_16x16x32_bf16 v[156:159], a[248:251], a[12:15], v[156:159]
    s_waitcnt lgkmcnt(8)
    v_mfma_f32_16x16x32_bf16 v[156:159], a[252:255], a[28:31], v[156:159]
    buffer_load_dwordx4 v13, s[16:19], s68 offen offset:1024 lds
    v_mfma_f32_16x16x32_bf16 v[152:155], a[252:255], a[24:27], v[152:155]
    v_mfma_f32_16x16x32_bf16 v[152:155], a[248:251], a[8:11], v[152:155]
    v_mfma_f32_16x16x32_bf16 v[148:151], a[248:251], a[4:7], v[148:151]
    ds_read_b64_tr_b16 a[80:81], v12 offset:160
    v_mfma_f32_16x16x32_bf16 v[148:151], a[252:255], a[20:23], v[148:151]
    s_add_u32 s68, s75, 980992
    ds_read_b64_tr_b16 a[82:83], v12 offset:14496
    v_mfma_f32_16x16x32_bf16 v[144:147], a[252:255], a[16:19], v[144:147]
    ds_read_b64_tr_b16 a[84:85], v12 offset:3744
    v_mfma_f32_16x16x32_bf16 v[144:147], a[248:251], a[0:3], v[144:147]
    s_waitcnt lgkmcnt(9)
    buffer_load_dwordx4 v13, s[16:19], s68 offen offset:2048 lds
    v_mfma_f32_16x16x32_bf16 v[160:163], a[64:67], a[0:3], v[160:163]
    s_waitcnt lgkmcnt(7)
    ds_read_b64_tr_b16 a[86:87], v12 offset:18080
    v_mfma_f32_16x16x32_bf16 v[160:163], a[68:71], a[16:19], v[160:163]
    v_mfma_f32_16x16x32_bf16 v[164:167], a[68:71], a[20:23], v[164:167]
    v_mfma_f32_16x16x32_bf16 v[164:167], a[64:67], a[4:7], v[164:167]
    s_add_u32 s68, s75, 996352
    v_mfma_f32_16x16x32_bf16 v[168:171], a[64:67], a[8:11], v[168:171]
    ds_read_b64_tr_b16 a[248:249], v12 offset:7328
    v_mfma_f32_16x16x32_bf16 v[168:171], a[68:71], a[24:27], v[168:171]
    buffer_load_dwordx4 v13, s[16:19], s68 offen offset:3072 lds
    v_mfma_f32_16x16x32_bf16 v[172:175], a[68:71], a[28:31], v[172:175]
    ds_read_b64_tr_b16 a[250:251], v12 offset:21664
    v_mfma_f32_16x16x32_bf16 v[172:175], a[64:67], a[12:15], v[172:175]
    s_waitcnt lgkmcnt(8)
    ds_read_b64_tr_b16 a[252:253], v12 offset:10912
    v_mfma_f32_16x16x32_bf16 v[188:191], a[72:75], a[12:15], v[188:191]
    s_waitcnt lgkmcnt(7)
    ds_read_b64_tr_b16 a[254:255], v12 offset:25248
    s_add_u32 m0, s56, 8192
    v_mfma_f32_16x16x32_bf16 v[188:191], a[76:79], a[28:31], v[188:191]
    v_mfma_f32_16x16x32_bf16 v[184:187], a[76:79], a[24:27], v[184:187]
    buffer_load_dwordx4 v2, s[8:11], s53 offen offset:1024 lds
    v_mfma_f32_16x16x32_bf16 v[184:187], a[72:75], a[8:11], v[184:187]
    v_mfma_f32_16x16x32_bf16 v[180:183], a[72:75], a[4:7], v[180:183]
    ds_read_b64_tr_b16 a[64:65], v12 offset:192
    v_mfma_f32_16x16x32_bf16 v[180:183], a[76:79], a[20:23], v[180:183]
    ds_read_b64_tr_b16 a[66:67], v12 offset:14528
    v_mfma_f32_16x16x32_bf16 v[176:179], a[76:79], a[16:19], v[176:179]
    ds_read_b64_tr_b16 a[68:69], v12 offset:3776
    v_mfma_f32_16x16x32_bf16 v[176:179], a[72:75], a[0:3], v[176:179]
    s_waitcnt lgkmcnt(9)
    ds_read_b64_tr_b16 a[70:71], v12 offset:18112
    v_mfma_f32_16x16x32_bf16 v[192:195], a[80:83], a[0:3], v[192:195]
    s_waitcnt lgkmcnt(8)
    buffer_load_dwordx4 v1, s[8:11], s54 offen offset:2048 lds
    v_mfma_f32_16x16x32_bf16 v[192:195], a[84:87], a[16:19], v[192:195]
    v_mfma_f32_16x16x32_bf16 v[196:199], a[84:87], a[20:23], v[196:199]
    v_mfma_f32_16x16x32_bf16 v[196:199], a[80:83], a[4:7], v[196:199]
    v_mfma_f32_16x16x32_bf16 v[200:203], a[80:83], a[8:11], v[200:203]
    ds_read_b64_tr_b16 a[72:73], v12 offset:7360
    v_mfma_f32_16x16x32_bf16 v[200:203], a[84:87], a[24:27], v[200:203]
    ds_read_b64_tr_b16 a[74:75], v12 offset:21696
    v_mfma_f32_16x16x32_bf16 v[204:207], a[84:87], a[28:31], v[204:207]
    buffer_load_dwordx4 v2, s[8:11], s55 offen offset:3072 lds
    v_mfma_f32_16x16x32_bf16 v[204:207], a[80:83], a[12:15], v[204:207]
    s_waitcnt lgkmcnt(8)
    ds_read_b64_tr_b16 a[76:77], v12 offset:10944
    v_mfma_f32_16x16x32_bf16 v[220:223], a[248:251], a[12:15], v[220:223]
    s_waitcnt lgkmcnt(7)
    ds_read_b64_tr_b16 a[78:79], v12 offset:25280
    v_mfma_f32_16x16x32_bf16 v[220:223], a[252:255], a[28:31], v[220:223]
    s_waitcnt vmcnt(23)
    v_mfma_f32_16x16x32_bf16 v[216:219], a[252:255], a[24:27], v[216:219]
    s_add_u32 m0, s57, 98304
    ds_read_b128 a[40:43], v3 offset:0
    v_mfma_f32_16x16x32_bf16 v[216:219], a[248:251], a[8:11], v[216:219]
    ds_read_b128 a[56:59], v4 offset:0
    v_mfma_f32_16x16x32_bf16 v[212:215], a[248:251], a[4:7], v[212:215]
    buffer_load_dwordx4 v11, s[12:15], s72 offen offset:2048 lds
    v_mfma_f32_16x16x32_bf16 v[212:215], a[252:255], a[20:23], v[212:215]
    ds_read_b128 a[44:47], v3 offset:2048
    v_mfma_f32_16x16x32_bf16 v[208:211], a[252:255], a[16:19], v[208:211]
    ds_read_b128 a[60:63], v4 offset:2048
    v_mfma_f32_16x16x32_bf16 v[208:211], a[248:251], a[0:3], v[208:211]
    s_waitcnt lgkmcnt(10)
    v_mfma_f32_16x16x32_bf16 v[224:227], a[64:67], a[0:3], v[224:227]
    s_waitcnt lgkmcnt(8)
    s_add_u32 m0, s57, 65536
    v_mfma_f32_16x16x32_bf16 v[224:227], a[68:71], a[16:19], v[224:227]
    s_bfe_u32 s72, s71, 0x4001c
    v_mfma_f32_16x16x32_bf16 v[228:231], a[68:71], a[20:23], v[228:231]
    s_waitcnt vmcnt(19) lgkmcnt(4)
    s_mul_i32 s72, s72, 458752
    v_mfma_f32_16x16x32_bf16 v[228:231], a[64:67], a[4:7], v[228:231]
    s_barrier
    v_mfma_f32_16x16x32_bf16 v[232:235], a[64:67], a[8:11], v[232:235]
    buffer_load_dwordx4 v5, s[12:15], s72 offen offset:0 lds
    v_mfma_f32_16x16x32_bf16 v[232:235], a[68:71], a[24:27], v[232:235]
    ds_read_b64_tr_b16 a[80:81], v30 offset:0
    v_mfma_f32_16x16x32_bf16 v[236:239], a[68:71], a[28:31], v[236:239]
    ds_read_b64_tr_b16 a[82:83], v30 offset:14336
    v_mfma_f32_16x16x32_bf16 v[236:239], a[64:67], a[12:15], v[236:239]
    ds_read_b64_tr_b16 a[84:85], v30 offset:3584
    v_mfma_f32_16x16x32_bf16 v[252:255], a[72:75], a[12:15], v[252:255]
    ds_read_b64_tr_b16 a[86:87], v30 offset:17920
    v_mfma_f32_16x16x32_bf16 v[252:255], a[76:79], a[28:31], v[252:255]
    buffer_load_dwordx4 v6, s[12:15], s72 offen offset:1024 lds
    v_mfma_f32_16x16x32_bf16 v[248:251], a[76:79], a[24:27], v[248:251]
    ds_read_b64_tr_b16 a[248:249], v30 offset:7168
    v_mfma_f32_16x16x32_bf16 v[248:251], a[72:75], a[8:11], v[248:251]
    ds_read_b64_tr_b16 a[250:251], v30 offset:21504
    v_mfma_f32_16x16x32_bf16 v[244:247], a[72:75], a[4:7], v[244:247]
    ds_read_b64_tr_b16 a[252:253], v30 offset:10752
    v_mfma_f32_16x16x32_bf16 v[244:247], a[76:79], a[20:23], v[244:247]
    ds_read_b64_tr_b16 a[254:255], v30 offset:25088
    v_mfma_f32_16x16x32_bf16 v[240:243], a[76:79], a[16:19], v[240:243]
    ds_read_b64_tr_b16 a[64:65], v30 offset:32
    v_mfma_f32_16x16x32_bf16 v[240:243], a[72:75], a[0:3], v[240:243]
    s_waitcnt lgkmcnt(7)
    buffer_load_dwordx4 v7, s[12:15], s72 offen offset:2048 lds
    v_mfma_f32_16x16x32_bf16 v[32:35], a[80:83], a[32:35], v[32:35]
    s_waitcnt lgkmcnt(5)
    ds_read_b64_tr_b16 a[66:67], v30 offset:14368
    v_mfma_f32_16x16x32_bf16 v[32:35], a[84:87], a[48:51], v[32:35]
    ds_read_b64_tr_b16 a[68:69], v30 offset:3616
    v_mfma_f32_16x16x32_bf16 v[36:39], a[84:87], a[52:55], v[36:39]
    ds_read_b64_tr_b16 a[70:71], v30 offset:17952
    v_mfma_f32_16x16x32_bf16 v[36:39], a[80:83], a[36:39], v[36:39]
    v_mfma_f32_16x16x32_bf16 v[40:43], a[80:83], a[40:43], v[40:43]
    ds_read_b64_tr_b16 a[72:73], v30 offset:7200
    v_mfma_f32_16x16x32_bf16 v[40:43], a[84:87], a[56:59], v[40:43]
    buffer_load_dwordx4 v8, s[12:15], s72 offen offset:3072 lds
    v_mfma_f32_16x16x32_bf16 v[44:47], a[84:87], a[60:63], v[44:47]
    ds_read_b64_tr_b16 a[74:75], v30 offset:21536
    v_mfma_f32_16x16x32_bf16 v[44:47], a[80:83], a[44:47], v[44:47]
    s_waitcnt lgkmcnt(8)
    ds_read_b64_tr_b16 a[76:77], v30 offset:10784
    v_mfma_f32_16x16x32_bf16 v[60:63], a[248:251], a[44:47], v[60:63]
    s_waitcnt lgkmcnt(7)
    ds_read_b64_tr_b16 a[78:79], v30 offset:25120
    v_mfma_f32_16x16x32_bf16 v[60:63], a[252:255], a[60:63], v[60:63]
    s_add_u32 m0, s57, 69632
    v_mfma_f32_16x16x32_bf16 v[56:59], a[252:255], a[56:59], v[56:59]
    v_mfma_f32_16x16x32_bf16 v[56:59], a[248:251], a[40:43], v[56:59]
    buffer_load_dwordx4 v9, s[12:15], s72 offen offset:0 lds
    v_mfma_f32_16x16x32_bf16 v[52:55], a[248:251], a[36:39], v[52:55]
    ds_read_b64_tr_b16 a[80:81], v30 offset:64
    v_mfma_f32_16x16x32_bf16 v[52:55], a[252:255], a[52:55], v[52:55]
    ds_read_b64_tr_b16 a[82:83], v30 offset:14400
    v_mfma_f32_16x16x32_bf16 v[48:51], a[252:255], a[48:51], v[48:51]
    ds_read_b64_tr_b16 a[84:85], v30 offset:3648
    v_mfma_f32_16x16x32_bf16 v[48:51], a[248:251], a[32:35], v[48:51]
    s_waitcnt lgkmcnt(9)
    ds_read_b64_tr_b16 a[86:87], v30 offset:17984
    v_mfma_f32_16x16x32_bf16 v[64:67], a[64:67], a[32:35], v[64:67]
    s_waitcnt lgkmcnt(8)
    buffer_load_dwordx4 v10, s[12:15], s72 offen offset:1024 lds
    v_mfma_f32_16x16x32_bf16 v[64:67], a[68:71], a[48:51], v[64:67]
    v_mfma_f32_16x16x32_bf16 v[68:71], a[68:71], a[52:55], v[68:71]
    v_mfma_f32_16x16x32_bf16 v[68:71], a[64:67], a[36:39], v[68:71]
    v_mfma_f32_16x16x32_bf16 v[72:75], a[64:67], a[40:43], v[72:75]
    ds_read_b64_tr_b16 a[248:249], v30 offset:7232
    v_mfma_f32_16x16x32_bf16 v[72:75], a[68:71], a[56:59], v[72:75]
    ds_read_b64_tr_b16 a[250:251], v30 offset:21568
    v_mfma_f32_16x16x32_bf16 v[76:79], a[68:71], a[60:63], v[76:79]
    buffer_load_dwordx4 v11, s[12:15], s72 offen offset:2048 lds
    v_mfma_f32_16x16x32_bf16 v[76:79], a[64:67], a[44:47], v[76:79]
    s_waitcnt lgkmcnt(8)
    ds_read_b64_tr_b16 a[252:253], v30 offset:10816
    s_mov_b32 m0, s56
    v_mfma_f32_16x16x32_bf16 v[92:95], a[72:75], a[44:47], v[92:95]
    s_waitcnt lgkmcnt(7)
    ds_read_b64_tr_b16 a[254:255], v30 offset:25152
    s_bfe_u32 s73, s71, 0x4001c
    v_mfma_f32_16x16x32_bf16 v[92:95], a[76:79], a[60:63], v[92:95]
    s_lshl_b32 s73, s73, 7
    v_mfma_f32_16x16x32_bf16 v[88:91], a[76:79], a[56:59], v[88:91]
    s_add_u32 s8, s6, s73
    s_addc_u32 s9, s7, 0
    v_mfma_f32_16x16x32_bf16 v[88:91], a[72:75], a[40:43], v[88:91]
    v_mfma_f32_16x16x32_bf16 v[84:87], a[72:75], a[36:39], v[84:87]
    buffer_load_dwordx4 v1, s[8:11], s48 offen offset:0 lds
    v_mfma_f32_16x16x32_bf16 v[84:87], a[76:79], a[52:55], v[84:87]
    ds_read_b64_tr_b16 a[64:65], v30 offset:96
    v_mfma_f32_16x16x32_bf16 v[80:83], a[76:79], a[48:51], v[80:83]
L_pad6:
    s_cbranch_vccnz L_pad10
    ds_read_b64_tr_b16 a[66:67], v30 offset:14432
    v_mfma_f32_16x16x32_bf16 v[80:83], a[72:75], a[32:35], v[80:83]
    s_waitcnt lgkmcnt(8)
    ds_read_b64_tr_b16 a[68:69], v30 offset:3680
    v_mfma_f32_16x16x32_bf16 v[96:99], a[80:83], a[32:35], v[96:99]
    s_waitcnt lgkmcnt(7)
    ds_read_b64_tr_b16 a[70:71], v30 offset:18016
    v_mfma_f32_16x16x32_bf16 v[96:99], a[84:87], a[48:51], v[96:99]
    s_waitcnt vmcnt(23)
    v_mfma_f32_16x16x32_bf16 v[100:103], a[84:87], a[52:55], v[100:103]
    buffer_load_dwordx4 v2, s[8:11], s49 offen offset:1024 lds
    v_mfma_f32_16x16x32_bf16 v[100:103], a[80:83], a[36:39], v[100:103]
    ds_read_b128 a[0:3], v3 offset:4096
    v_mfma_f32_16x16x32_bf16 v[104:107], a[80:83], a[40:43], v[104:107]
    s_waitcnt vmcnt(13)
    ds_read_b128 a[16:19], v4 offset:4096
    v_mfma_f32_16x16x32_bf16 v[104:107], a[84:87], a[56:59], v[104:107]
    ds_read_b128 a[4:7], v3 offset:6144
    v_mfma_f32_16x16x32_bf16 v[108:111], a[84:87], a[60:63], v[108:111]
    ds_read_b128 a[20:23], v4 offset:6144
    v_mfma_f32_16x16x32_bf16 v[108:111], a[80:83], a[44:47], v[108:111]
    s_waitcnt lgkmcnt(10)
    ds_read_b64_tr_b16 a[232:233], v14 offset:12288
    v_mfma_f32_16x16x32_bf16 v[124:127], a[248:251], a[44:47], v[124:127]
    s_waitcnt lgkmcnt(9)
    buffer_load_dwordx4 v1, s[8:11], s50 offen offset:2048 lds
    v_mfma_f32_16x16x32_bf16 v[124:127], a[252:255], a[60:63], v[124:127]
    ds_read_b64_tr_b16 a[236:237], v15 offset:12288
    v_mfma_f32_16x16x32_bf16 v[120:123], a[252:255], a[56:59], v[120:123]
    ds_read_b64_tr_b16 a[240:241], v16 offset:12288
    v_mfma_f32_16x16x32_bf16 v[120:123], a[248:251], a[40:43], v[120:123]
    ds_read_b64_tr_b16 a[244:245], v17 offset:12288
    v_mfma_f32_16x16x32_bf16 v[116:119], a[248:251], a[36:39], v[116:119]
    ds_read_b64_tr_b16 a[234:235], v14 offset:14336
    v_mfma_f32_16x16x32_bf16 v[116:119], a[252:255], a[52:55], v[116:119]
    buffer_load_dwordx4 v2, s[8:11], s51 offen offset:3072 lds
    v_mfma_f32_16x16x32_bf16 v[112:115], a[252:255], a[48:51], v[112:115]
    ds_read_b64_tr_b16 a[72:73], v30 offset:7264
    v_mfma_f32_16x16x32_bf16 v[112:115], a[248:251], a[32:35], v[112:115]
    s_waitcnt lgkmcnt(12)
    ds_read_b64_tr_b16 a[74:75], v30 offset:21600
    v_mfma_f32_16x16x32_bf16 v[128:131], a[64:67], a[32:35], v[128:131]
    s_waitcnt lgkmcnt(11)
    ds_read_b64_tr_b16 a[238:239], v15 offset:14336
    v_mfma_f32_16x16x32_bf16 v[128:131], a[68:71], a[48:51], v[128:131]
    s_add_u32 m0, s56, 4096
    ds_read_b64_tr_b16 a[76:77], v30 offset:10848
    v_mfma_f32_16x16x32_bf16 v[132:135], a[68:71], a[52:55], v[132:135]
    s_waitcnt lgkmcnt(9)
    ds_read_b64_tr_b16 a[78:79], v30 offset:25184
    v_mfma_f32_16x16x32_bf16 v[132:135], a[64:67], a[36:39], v[132:135]
    ds_read_b64_tr_b16 a[242:243], v16 offset:14336
    v_mfma_f32_16x16x32_bf16 v[136:139], a[64:67], a[40:43], v[136:139]
    ds_read_b64_tr_b16 a[246:247], v17 offset:14336
    v_mfma_f32_16x16x32_bf16 v[136:139], a[68:71], a[56:59], v[136:139]
    buffer_load_dwordx4 v1, s[8:11], s52 offen offset:0 lds
    v_mfma_f32_16x16x32_bf16 v[140:143], a[68:71], a[60:63], v[140:143]
    ds_read_b64_tr_b16 a[80:81], v30 offset:128
    v_mfma_f32_16x16x32_bf16 v[140:143], a[64:67], a[44:47], v[140:143]
    s_waitcnt lgkmcnt(6)
    ds_read_b64_tr_b16 a[82:83], v30 offset:14464
    v_mfma_f32_16x16x32_bf16 v[156:159], a[72:75], a[44:47], v[156:159]
    s_waitcnt lgkmcnt(4)
    ds_read_b64_tr_b16 a[84:85], v30 offset:3712
    v_mfma_f32_16x16x32_bf16 v[156:159], a[76:79], a[60:63], v[156:159]
    buffer_load_dwordx4 v2, s[8:11], s53 offen offset:1024 lds
    v_mfma_f32_16x16x32_bf16 v[152:155], a[76:79], a[56:59], v[152:155]
    ds_read_b64_tr_b16 a[86:87], v30 offset:18048
    v_mfma_f32_16x16x32_bf16 v[152:155], a[72:75], a[40:43], v[152:155]
    ds_read_b64_tr_b16 a[248:249], v30 offset:7296
    v_mfma_f32_16x16x32_bf16 v[148:151], a[72:75], a[36:39], v[148:151]
    ds_read_b64_tr_b16 a[250:251], v30 offset:21632
    v_mfma_f32_16x16x32_bf16 v[148:151], a[76:79], a[52:55], v[148:151]
    ds_read_b64_tr_b16 a[252:253], v30 offset:10880
    v_mfma_f32_16x16x32_bf16 v[144:147], a[76:79], a[48:51], v[144:147]
    ds_read_b64_tr_b16 a[254:255], v30 offset:25216
    v_mfma_f32_16x16x32_bf16 v[144:147], a[72:75], a[32:35], v[144:147]
    s_waitcnt lgkmcnt(6)
    buffer_load_dwordx4 v1, s[8:11], s54 offen offset:2048 lds
    v_mfma_f32_16x16x32_bf16 v[160:163], a[80:83], a[32:35], v[160:163]
    s_waitcnt lgkmcnt(4)
    ds_read_b64_tr_b16 a[64:65], v30 offset:160
    v_mfma_f32_16x16x32_bf16 v[160:163], a[84:87], a[48:51], v[160:163]
    ds_read_b64_tr_b16 a[66:67], v30 offset:14496
    v_mfma_f32_16x16x32_bf16 v[164:167], a[84:87], a[52:55], v[164:167]
    ds_read_b64_tr_b16 a[68:69], v30 offset:3744
    v_mfma_f32_16x16x32_bf16 v[164:167], a[80:83], a[36:39], v[164:167]
    ds_read_b64_tr_b16 a[70:71], v30 offset:18080
    v_mfma_f32_16x16x32_bf16 v[168:171], a[80:83], a[40:43], v[168:171]
    ds_read_b64_tr_b16 a[72:73], v30 offset:7328
    v_mfma_f32_16x16x32_bf16 v[168:171], a[84:87], a[56:59], v[168:171]
    buffer_load_dwordx4 v2, s[8:11], s55 offen offset:3072 lds
    v_mfma_f32_16x16x32_bf16 v[172:175], a[84:87], a[60:63], v[172:175]
    ds_read_b64_tr_b16 a[74:75], v30 offset:21664
    v_mfma_f32_16x16x32_bf16 v[172:175], a[80:83], a[44:47], v[172:175]
    s_waitcnt lgkmcnt(8)
    ds_read_b64_tr_b16 a[76:77], v30 offset:10912
    v_mfma_f32_16x16x32_bf16 v[188:191], a[248:251], a[44:47], v[188:191]
    s_waitcnt lgkmcnt(7)
    ds_read_b64_tr_b16 a[78:79], v30 offset:25248
    v_mfma_f32_16x16x32_bf16 v[188:191], a[252:255], a[60:63], v[188:191]
    v_mfma_f32_16x16x32_bf16 v[184:187], a[252:255], a[56:59], v[184:187]
    v_mfma_f32_16x16x32_bf16 v[184:187], a[248:251], a[40:43], v[184:187]
    v_mfma_f32_16x16x32_bf16 v[180:183], a[248:251], a[36:39], v[180:183]
    ds_read_b64_tr_b16 a[80:81], v30 offset:192
    v_mfma_f32_16x16x32_bf16 v[180:183], a[252:255], a[52:55], v[180:183]
    ds_read_b64_tr_b16 a[82:83], v30 offset:14528
    v_mfma_f32_16x16x32_bf16 v[176:179], a[252:255], a[48:51], v[176:179]
    ds_read_b64_tr_b16 a[84:85], v30 offset:3776
    v_mfma_f32_16x16x32_bf16 v[176:179], a[248:251], a[32:35], v[176:179]
    s_waitcnt lgkmcnt(9)
    ds_read_b64_tr_b16 a[86:87], v30 offset:18112
    v_mfma_f32_16x16x32_bf16 v[192:195], a[64:67], a[32:35], v[192:195]
    s_waitcnt lgkmcnt(8)
    v_mfma_f32_16x16x32_bf16 v[192:195], a[68:71], a[48:51], v[192:195]
    v_mfma_f32_16x16x32_bf16 v[196:199], a[68:71], a[52:55], v[196:199]
    v_mfma_f32_16x16x32_bf16 v[196:199], a[64:67], a[36:39], v[196:199]
    v_mfma_f32_16x16x32_bf16 v[200:203], a[64:67], a[40:43], v[200:203]
    ds_read_b64_tr_b16 a[248:249], v30 offset:7360
    v_mfma_f32_16x16x32_bf16 v[200:203], a[68:71], a[56:59], v[200:203]
    ds_read_b64_tr_b16 a[250:251], v30 offset:21696
    v_mfma_f32_16x16x32_bf16 v[204:207], a[68:71], a[60:63], v[204:207]
    ds_read_b64_tr_b16 a[252:253], v30 offset:10944
    v_mfma_f32_16x16x32_bf16 v[204:207], a[64:67], a[44:47], v[204:207]
    s_waitcnt lgkmcnt(9)
    ds_read_b64_tr_b16 a[254:255], v30 offset:25280
    v_mfma_f32_16x16x32_bf16 v[220:223], a[72:75], a[44:47], v[220:223]
    s_waitcnt lgkmcnt(8)
    v_mov_b32 v5, v29
    v_mfma_f32_16x16x32_bf16 v[220:223], a[76:79], a[60:63], v[220:223]
    s_waitcnt vmcnt(16)
    v_add_u32 v6, 65536, v28
    v_mfma_f32_16x16x32_bf16 v[216:219], a[76:79], a[56:59], v[216:219]
    ds_read_b128 a[8:11], v3 offset:8192
    v_add_u32 v7, 131072, v28
    v_mfma_f32_16x16x32_bf16 v[216:219], a[72:75], a[40:43], v[216:219]
    ds_read_b128 a[24:27], v4 offset:8192
    v_lshl_add_u32 v8, v0, 2, s56
    v_mfma_f32_16x16x32_bf16 v[212:215], a[72:75], a[36:39], v[212:215]
    ds_read_b128 a[12:15], v3 offset:10240
    v_xor_b32 v9, 32768, v8
    v_mfma_f32_16x16x32_bf16 v[212:215], a[76:79], a[52:55], v[212:215]
    s_add_u32 m0, s56, 12288
    ds_read_b128 a[28:31], v4 offset:10240
    v_sub_u32 v10, v29, v18
    v_mfma_f32_16x16x32_bf16 v[208:211], a[76:79], a[48:51], v[208:211]
    s_add_u32 s68, s76, 950272
    v_lshl_add_u32 v10, v10, 3, v18
    v_mfma_f32_16x16x32_bf16 v[208:211], a[72:75], a[32:35], v[208:211]
    s_waitcnt lgkmcnt(10)
    v_mfma_f32_16x16x32_bf16 v[224:227], a[80:83], a[32:35], v[224:227]
    s_waitcnt lgkmcnt(8)
    buffer_load_dwordx4 v13, s[16:19], s68 offen offset:0 lds
    v_mfma_f32_16x16x32_bf16 v[224:227], a[84:87], a[48:51], v[224:227]
    v_mfma_f32_16x16x32_bf16 v[228:231], a[84:87], a[52:55], v[228:231]
    s_waitcnt vmcnt(9) lgkmcnt(4)
    v_mfma_f32_16x16x32_bf16 v[228:231], a[80:83], a[36:39], v[228:231]
    s_barrier
    s_add_u32 s68, s76, 965632
    v_mfma_f32_16x16x32_bf16 v[232:235], a[80:83], a[40:43], v[232:235]
    ds_read_b64_tr_b16 a[64:65], v12 offset:28672
    v_mfma_f32_16x16x32_bf16 v[232:235], a[84:87], a[56:59], v[232:235]
    buffer_load_dwordx4 v13, s[16:19], s68 offen offset:1024 lds
    v_mfma_f32_16x16x32_bf16 v[236:239], a[84:87], a[60:63], v[236:239]
    ds_read_b64_tr_b16 a[66:67], v12 offset:43008
    v_mfma_f32_16x16x32_bf16 v[236:239], a[80:83], a[44:47], v[236:239]
    ds_read_b64_tr_b16 a[68:69], v12 offset:32256
    v_mfma_f32_16x16x32_bf16 v[252:255], a[248:251], a[44:47], v[252:255]
    s_add_u32 s68, s76, 980992
    ds_read_b64_tr_b16 a[70:71], v12 offset:46592
    v_mfma_f32_16x16x32_bf16 v[252:255], a[252:255], a[60:63], v[252:255]
    ds_read_b64_tr_b16 a[72:73], v12 offset:35840
    v_mfma_f32_16x16x32_bf16 v[248:251], a[252:255], a[56:59], v[248:251]
    buffer_load_dwordx4 v13, s[16:19], s68 offen offset:2048 lds
    v_mfma_f32_16x16x32_bf16 v[248:251], a[248:251], a[40:43], v[248:251]
    ds_read_b64_tr_b16 a[74:75], v12 offset:50176
    v_mfma_f32_16x16x32_bf16 v[244:247], a[248:251], a[36:39], v[244:247]
    ds_read_b64_tr_b16 a[76:77], v12 offset:39424
    v_mfma_f32_16x16x32_bf16 v[244:247], a[252:255], a[52:55], v[244:247]
    s_add_u32 s68, s76, 996352
    ds_read_b64_tr_b16 a[78:79], v12 offset:53760
    v_mfma_f32_16x16x32_bf16 v[240:243], a[252:255], a[48:51], v[240:243]
    ds_read_b64_tr_b16 a[80:81], v12 offset:0
    v_mfma_f32_16x16x32_bf16 v[240:243], a[248:251], a[32:35], v[240:243]
    s_waitcnt lgkmcnt(7)
    buffer_load_dwordx4 v13, s[16:19], s68 offen offset:3072 lds
    s_waitcnt vmcnt(8)
    v_mfma_f32_16x16x32_bf16 v[32:35], a[64:67], a[0:3], v[32:35]
    s_waitcnt lgkmcnt(5)
    ds_read_b128 a[32:35], v3 offset:0
    v_mfma_f32_16x16x32_bf16 v[32:35], a[68:71], a[16:19], v[32:35]
    s_add_u32 m0, s56, 8192
    ds_read_b128 a[48:51], v4 offset:0
    v_mfma_f32_16x16x32_bf16 v[36:39], a[68:71], a[20:23], v[36:39]
    s_add_u32 s68, s77, 950272
    ds_read_b128 a[36:39], v3 offset:2048
    v_mfma_f32_16x16x32_bf16 v[36:39], a[64:67], a[4:7], v[36:39]
    s_waitcnt vmcnt(4)
    ds_read_b128 a[52:55], v4 offset:2048
    v_mfma_f32_16x16x32_bf16 v[40:43], a[64:67], a[8:11], v[40:43]
    buffer_load_dwordx4 v13, s[16:19], s68 offen offset:0 lds
    v_mfma_f32_16x16x32_bf16 v[40:43], a[68:71], a[24:27], v[40:43]
    ds_read_b128 a[40:43], v3 offset:4096
    v_mfma_f32_16x16x32_bf16 v[44:47], a[68:71], a[28:31], v[44:47]
    ds_read_b128 a[56:59], v4 offset:4096
    v_mfma_f32_16x16x32_bf16 v[44:47], a[64:67], a[12:15], v[44:47]
    s_waitcnt lgkmcnt(9)
    ds_read_b128 a[44:47], v3 offset:6144
    s_add_u32 s68, s77, 965632
    v_mfma_f32_16x16x32_bf16 v[60:63], a[72:75], a[12:15], v[60:63]
    s_waitcnt lgkmcnt(8)
    ds_read_b64_tr_b16 a[82:83], v12 offset:14336
    v_mfma_f32_16x16x32_bf16 v[60:63], a[76:79], a[28:31], v[60:63]
    ds_read_b128 a[60:63], v4 offset:6144
    v_mfma_f32_16x16x32_bf16 v[56:59], a[76:79], a[24:27], v[56:59]
    buffer_load_dwordx4 v13, s[16:19], s68 offen offset:1024 lds
    v_mfma_f32_16x16x32_bf16 v[56:59], a[72:75], a[8:11], v[56:59]
    s_add_u32 s68, s77, 980992
    ds_read_b64_tr_b16 a[84:85], v12 offset:3584
    v_mfma_f32_16x16x32_bf16 v[52:55], a[72:75], a[4:7], v[52:55]
    ds_read_b64_tr_b16 a[86:87], v12 offset:17920
    v_mfma_f32_16x16x32_bf16 v[52:55], a[76:79], a[20:23], v[52:55]
    buffer_load_dwordx4 v13, s[16:19], s68 offen offset:2048 lds
    v_mfma_f32_16x16x32_bf16 v[48:51], a[76:79], a[16:19], v[48:51]
    ds_read_b64_tr_b16 a[248:249], v12 offset:7168
    v_mfma_f32_16x16x32_bf16 v[48:51], a[72:75], a[0:3], v[48:51]
    s_waitcnt lgkmcnt(4)
    ds_read_b64_tr_b16 a[250:251], v12 offset:21504
    s_add_u32 s68, s77, 996352
    v_mfma_f32_16x16x32_bf16 v[32:35], a[80:83], a[32:35], v[32:35]
    s_waitcnt lgkmcnt(2)
    ds_read_b64_tr_b16 a[252:253], v12 offset:10752
    v_mfma_f32_16x16x32_bf16 v[32:35], a[84:87], a[48:51], v[32:35]
    buffer_load_dwordx4 v13, s[16:19], s68 offen offset:3072 lds
    v_mfma_f32_16x16x32_bf16 v[36:39], a[84:87], a[52:55], v[36:39]
    ds_read_b64_tr_b16 a[254:255], v12 offset:25088
    v_mfma_f32_16x16x32_bf16 v[36:39], a[80:83], a[36:39], v[36:39]
    s_mov_b32 m0, s56
    ds_read_b64_tr_b16 a[64:65], v12 offset:28704
    v_mfma_f32_16x16x32_bf16 v[40:43], a[80:83], a[40:43], v[40:43]
    s_add_u32 s68, s74, 98304
    ds_read_b64_tr_b16 a[66:67], v12 offset:43040
    v_mfma_f32_16x16x32_bf16 v[40:43], a[84:87], a[56:59], v[40:43]
    ds_read_b64_tr_b16 a[68:69], v12 offset:32288
    v_mfma_f32_16x16x32_bf16 v[44:47], a[84:87], a[60:63], v[44:47]
    buffer_load_dwordx4 v13, s[16:19], s68 offen offset:0 lds
    v_mfma_f32_16x16x32_bf16 v[44:47], a[80:83], a[44:47], v[44:47]
    s_waitcnt lgkmcnt(5)
    ds_read_b64_tr_b16 a[70:71], v12 offset:46624
    v_mfma_f32_16x16x32_bf16 v[60:63], a[248:251], a[44:47], v[60:63]
    s_waitcnt lgkmcnt(4)
    ds_read_b64_tr_b16 a[72:73], v12 offset:32
    ds_read_b64_tr_b16 a[74:75], v12 offset:14368
    v_mfma_f32_16x16x32_bf16 v[60:63], a[252:255], a[60:63], v[60:63]
    s_add_u32 s68, s74, 113664
    ds_read_b64_tr_b16 a[76:77], v12 offset:3616
    ds_read_b64_tr_b16 a[78:79], v12 offset:17952
    v_mfma_f32_16x16x32_bf16 v[56:59], a[252:255], a[56:59], v[56:59]
    buffer_load_dwordx4 v13, s[16:19], s68 offen offset:1024 lds
    v_mfma_f32_16x16x32_bf16 v[56:59], a[248:251], a[40:43], v[56:59]
    s_add_u32 s68, s74, 129024
    v_pk_mul_f32 v[22:23], v[32:33], s[66:67] op_sel_hi:[1,0]
    v_pk_mul_f32 v[24:25], v[34:35], s[66:67] op_sel_hi:[1,0]
    v_pk_mul_f32 v[26:27], v[36:37], s[66:67] op_sel_hi:[1,0]
    v_pk_mul_f32 v[28:29], v[38:39], s[66:67] op_sel_hi:[1,0]
    v_mfma_f32_16x16x32_bf16 v[52:55], a[248:251], a[36:39], v[52:55]
    ds_read_b64_tr_b16 a[80:81], v12 offset:35872
    v_mfma_f32_16x16x32_bf16 v[52:55], a[252:255], a[52:55], v[52:55]
    buffer_load_dwordx4 v13, s[16:19], s68 offen offset:2048 lds
    ds_read_b64_tr_b16 a[82:83], v12 offset:50208
    v_exp_f32 v22, v22
    v_exp_f32 v23, v23
    v_mfma_f32_16x16x32_bf16 v[48:51], a[252:255], a[48:51], v[48:51]
    s_add_u32 s68, s74, 144384
    ds_read_b64_tr_b16 a[84:85], v12 offset:39456
    v_exp_f32 v24, v24
    v_exp_f32 v25, v25
    v_mfma_f32_16x16x32_bf16 v[48:51], a[248:251], a[32:35], v[48:51]
    s_waitcnt lgkmcnt(9)
    ds_read_b64_tr_b16 a[86:87], v12 offset:53792
    v_exp_f32 v26, v26
    v_exp_f32 v27, v27
    v_mfma_f32_16x16x32_bf16 v[64:67], a[64:67], a[0:3], v[64:67]
    s_waitcnt lgkmcnt(8)
    buffer_load_dwordx4 v13, s[16:19], s68 offen offset:3072 lds
    ds_read_b64_tr_b16 a[248:249], v12 offset:7200
    v_exp_f32 v28, v28
    v_exp_f32 v29, v29
    v_pk_add_f32 v[22:23], v[22:23], 1.0 op_sel_hi:[1,0]
    v_pk_add_f32 v[24:25], v[24:25], 1.0 op_sel_hi:[1,0]
    v_pk_add_f32 v[26:27], v[26:27], 1.0 op_sel_hi:[1,0]
    v_pk_add_f32 v[28:29], v[28:29], 1.0 op_sel_hi:[1,0]
    v_mfma_f32_16x16x32_bf16 v[64:67], a[68:71], a[16:19], v[64:67]
    s_waitcnt lgkmcnt(7)
    ds_read_b64_tr_b16 a[250:251], v12 offset:21536
    s_add_u32 m0, s56, 4096
    v_mfma_f32_16x16x32_bf16 v[64:67], a[72:75], a[32:35], v[64:67]
    s_waitcnt lgkmcnt(6)
    ds_read_b64_tr_b16 a[252:253], v12 offset:10784
    v_rcp_f32 v22, v22
    v_rcp_f32 v23, v23
    v_mfma_f32_16x16x32_bf16 v[64:67], a[76:79], a[48:51], v[64:67]
    s_add_u32 s68, s75, 98304
    ds_read_b64_tr_b16 a[254:255], v12 offset:25120
    v_rcp_f32 v24, v24
    v_rcp_f32 v25, v25
    v_mfma_f32_16x16x32_bf16 v[68:71], a[76:79], a[52:55], v[68:71]
    buffer_load_dwordx4 v13, s[16:19], s68 offen offset:0 lds
    v_rcp_f32 v26, v26
    v_rcp_f32 v27, v27
    v_mfma_f32_16x16x32_bf16 v[68:71], a[72:75], a[36:39], v[68:71]
    s_add_u32 s68, s75, 113664
    v_rcp_f32 v28, v28
    v_rcp_f32 v29, v29
    v_pk_mul_f32 v[32:33], v[32:33], v[22:23]
    v_pk_mul_f32 v[34:35], v[34:35], v[24:25]
    v_pk_mul_f32 v[36:37], v[36:37], v[26:27]
    v_pk_mul_f32 v[38:39], v[38:39], v[28:29]
    v_pk_mul_f32 v[22:23], v[40:41], s[66:67] op_sel_hi:[1,0]
    v_pk_mul_f32 v[24:25], v[42:43], s[66:67] op_sel_hi:[1,0]
    v_pk_mul_f32 v[26:27], v[44:45], s[66:67] op_sel_hi:[1,0]
    v_pk_mul_f32 v[28:29], v[46:47], s[66:67] op_sel_hi:[1,0]
    v_mfma_f32_16x16x32_bf16 v[68:71], a[68:71], a[20:23], v[68:71]
    buffer_load_dwordx4 v13, s[16:19], s68 offen offset:1024 lds
    s_add_u32 s68, s75, 129024
    v_mfma_f32_16x16x32_bf16 v[68:71], a[64:67], a[4:7], v[68:71]
    v_exp_f32 v22, v22
    v_exp_f32 v23, v23
    v_mfma_f32_16x16x32_bf16 v[72:75], a[64:67], a[8:11], v[72:75]
    buffer_load_dwordx4 v13, s[16:19], s68 offen offset:2048 lds
    v_exp_f32 v24, v24
    v_exp_f32 v25, v25
    v_mfma_f32_16x16x32_bf16 v[72:75], a[68:71], a[24:27], v[72:75]
    s_add_u32 s68, s75, 144384
    v_exp_f32 v26, v26
    v_exp_f32 v27, v27
    v_mfma_f32_16x16x32_bf16 v[72:75], a[72:75], a[40:43], v[72:75]
    buffer_load_dwordx4 v13, s[16:19], s68 offen offset:3072 lds
    v_exp_f32 v28, v28
    v_exp_f32 v29, v29
    v_pk_mul_f32 v[48:49], v[32:33], v[48:49]
    v_pk_mul_f32 v[50:51], v[34:35], v[50:51]
    v_pk_mul_f32 v[52:53], v[36:37], v[52:53]
    v_pk_mul_f32 v[54:55], v[38:39], v[54:55]
    v_pk_add_f32 v[22:23], v[22:23], 1.0 op_sel_hi:[1,0]
    v_pk_add_f32 v[24:25], v[24:25], 1.0 op_sel_hi:[1,0]
    v_pk_add_f32 v[26:27], v[26:27], 1.0 op_sel_hi:[1,0]
    v_pk_add_f32 v[28:29], v[28:29], 1.0 op_sel_hi:[1,0]
    v_mfma_f32_16x16x32_bf16 v[72:75], a[76:79], a[56:59], v[72:75]
    v_cvt_pk_bf16_f32 v32, v48, v49
    v_cvt_pk_bf16_f32 v33, v50, v51
    v_mfma_f32_16x16x32_bf16 v[76:79], a[76:79], a[60:63], v[76:79]
    v_cvt_pk_bf16_f32 v34, v52, v53
    v_cvt_pk_bf16_f32 v35, v54, v55
    v_rcp_f32 v22, v22
    v_rcp_f32 v23, v23
    v_mfma_f32_16x16x32_bf16 v[76:79], a[72:75], a[44:47], v[76:79]
    s_nop 1
    v_permlane32_swap_b32 v32, v34
    v_permlane32_swap_b32 v33, v35
    v_rcp_f32 v24, v24
    v_rcp_f32 v25, v25
    v_mfma_f32_16x16x32_bf16 v[76:79], a[68:71], a[28:31], v[76:79]
    buffer_store_dwordx4 v[32:35], v19, s[20:23], s61 offen sc1
    v_rcp_f32 v26, v26
    v_rcp_f32 v27, v27
    v_mfma_f32_16x16x32_bf16 v[76:79], a[64:67], a[12:15], v[76:79]
    s_waitcnt lgkmcnt(6)
    v_rcp_f32 v28, v28
    v_rcp_f32 v29, v29
    v_pk_mul_f32 v[40:41], v[40:41], v[22:23]
    v_pk_mul_f32 v[42:43], v[42:43], v[24:25]
    v_pk_mul_f32 v[44:45], v[44:45], v[26:27]
    v_pk_mul_f32 v[46:47], v[46:47], v[28:29]
    v_pk_mul_f32 v[56:57], v[40:41], v[56:57]
    v_pk_mul_f32 v[58:59], v[42:43], v[58:59]
    v_pk_mul_f32 v[60:61], v[44:45], v[60:61]
    v_pk_mul_f32 v[62:63], v[46:47], v[62:63]
    v_pk_mul_f32 v[22:23], v[64:65], s[66:67] op_sel_hi:[1,0]
    v_pk_mul_f32 v[24:25], v[66:67], s[66:67] op_sel_hi:[1,0]
    v_pk_mul_f32 v[26:27], v[68:69], s[66:67] op_sel_hi:[1,0]
    v_pk_mul_f32 v[28:29], v[70:71], s[66:67] op_sel_hi:[1,0]
    v_mfma_f32_16x16x32_bf16 v[92:95], a[80:83], a[12:15], v[92:95]
    s_waitcnt lgkmcnt(4)
    ds_read_b64_tr_b16 a[64:65], v12 offset:28736
    v_cvt_pk_bf16_f32 v40, v56, v57
    v_cvt_pk_bf16_f32 v41, v58, v59
    v_mfma_f32_16x16x32_bf16 v[92:95], a[84:87], a[28:31], v[92:95]
    s_waitcnt lgkmcnt(3)
    ds_read_b64_tr_b16 a[66:67], v12 offset:43072
    v_cvt_pk_bf16_f32 v42, v60, v61
    v_cvt_pk_bf16_f32 v43, v62, v63
    v_exp_f32 v22, v22
    v_mfma_f32_16x16x32_bf16 v[92:95], a[248:251], a[44:47], v[92:95]
    s_waitcnt lgkmcnt(2)
    ds_read_b64_tr_b16 a[68:69], v12 offset:32320
    s_nop 1
    v_permlane32_swap_b32 v40, v42
    v_permlane32_swap_b32 v41, v43
    v_exp_f32 v23, v23
    v_mfma_f32_16x16x32_bf16 v[92:95], a[252:255], a[60:63], v[92:95]
    s_waitcnt vmcnt(15)
    buffer_store_dwordx4 v[40:43], v19, s[20:23], s62 offen sc1
    ds_read_b64_tr_b16 v[48:49], v14 offset:12288
    v_exp_f32 v24, v24
    v_mfma_f32_16x16x32_bf16 v[88:91], a[252:255], a[56:59], v[88:91]
    ds_read_b64_tr_b16 v[52:53], v15 offset:12288
    ds_read_b64_tr_b16 a[70:71], v12 offset:46656
    v_exp_f32 v25, v25
    v_mfma_f32_16x16x32_bf16 v[88:91], a[248:251], a[40:43], v[88:91]
    ds_read_b64_tr_b16 v[56:57], v16 offset:12288
    ds_read_b64_tr_b16 a[72:73], v12 offset:64
    v_exp_f32 v26, v26
    v_mfma_f32_16x16x32_bf16 v[88:91], a[84:87], a[24:27], v[88:91]
    s_waitcnt vmcnt(14)
    ds_read_b64_tr_b16 v[60:61], v17 offset:12288
    ds_read_b64_tr_b16 a[74:75], v12 offset:14400
    v_exp_f32 v27, v27
    v_mfma_f32_16x16x32_bf16 v[88:91], a[80:83], a[8:11], v[88:91]
    ds_read_b64_tr_b16 v[50:51], v14 offset:14336
    ds_read_b64_tr_b16 a[76:77], v12 offset:3648
    v_exp_f32 v28, v28
    v_exp_f32 v29, v29
    v_pk_add_f32 v[22:23], v[22:23], 1.0 op_sel_hi:[1,0]
    v_pk_add_f32 v[24:25], v[24:25], 1.0 op_sel_hi:[1,0]
    v_pk_add_f32 v[26:27], v[26:27], 1.0 op_sel_hi:[1,0]
    v_pk_add_f32 v[28:29], v[28:29], 1.0 op_sel_hi:[1,0]
    v_mfma_f32_16x16x32_bf16 v[84:87], a[80:83], a[4:7], v[84:87]
    ds_read_b64_tr_b16 v[54:55], v15 offset:14336
    ds_read_b64_tr_b16 a[78:79], v12 offset:17984
    v_mfma_f32_16x16x32_bf16 v[84:87], a[84:87], a[20:23], v[84:87]
    ds_read_b64_tr_b16 v[58:59], v16 offset:14336
    v_rcp_f32 v22, v22
    v_mfma_f32_16x16x32_bf16 v[84:87], a[248:251], a[36:39], v[84:87]
    s_waitcnt vmcnt(12)
    ds_read_b64_tr_b16 v[62:63], v17 offset:14336
    v_rcp_f32 v23, v23
    v_mfma_f32_16x16x32_bf16 v[84:87], a[252:255], a[52:55], v[84:87]
    ds_read_b64_tr_b16 v[32:33], v14 offset:8192
    v_rcp_f32 v24, v24
    v_mfma_f32_16x16x32_bf16 v[80:83], a[252:255], a[48:51], v[80:83]
    ds_read_b64_tr_b16 v[36:37], v15 offset:8192
    v_rcp_f32 v25, v25
    v_mfma_f32_16x16x32_bf16 v[80:83], a[248:251], a[32:35], v[80:83]
    s_add_u32 m0, s56, 12288
    ds_read_b64_tr_b16 v[40:41], v16 offset:8192
    v_rcp_f32 v26, v26
    v_mfma_f32_16x16x32_bf16 v[80:83], a[84:87], a[16:19], v[80:83]
    s_waitcnt vmcnt(10)
    ds_read_b64_tr_b16 v[44:45], v17 offset:8192
    v_rcp_f32 v27, v27
    v_mfma_f32_16x16x32_bf16 v[80:83], a[80:83], a[0:3], v[80:83]
    s_waitcnt lgkmcnt(15)
    ds_read_b64_tr_b16 v[34:35], v14 offset:10240
    v_rcp_f32 v28, v28
    v_rcp_f32 v29, v29
    v_pk_mul_f32 v[64:65], v[64:65], v[22:23]
    v_pk_mul_f32 v[66:67], v[66:67], v[24:25]
    v_pk_mul_f32 v[68:69], v[68:69], v[26:27]
    v_pk_mul_f32 v[70:71], v[70:71], v[28:29]
    v_pk_mul_f32 v[22:23], v[72:73], s[66:67] op_sel_hi:[1,0]
    v_pk_mul_f32 v[24:25], v[74:75], s[66:67] op_sel_hi:[1,0]
    v_pk_mul_f32 v[26:27], v[76:77], s[66:67] op_sel_hi:[1,0]
    v_pk_mul_f32 v[28:29], v[78:79], s[66:67] op_sel_hi:[1,0]
    v_mfma_f32_16x16x32_bf16 v[96:99], a[64:67], a[0:3], v[96:99]
    s_waitcnt lgkmcnt(15)
    ds_read_b64_tr_b16 v[38:39], v15 offset:10240
    ds_read_b64_tr_b16 a[80:81], v12 offset:35904
    v_mfma_f32_16x16x32_bf16 v[96:99], a[68:71], a[16:19], v[96:99]
    s_waitcnt lgkmcnt(13)
    s_add_u32 s68, s76, 98304
    ds_read_b64_tr_b16 v[42:43], v16 offset:10240
    v_exp_f32 v22, v22
    v_mfma_f32_16x16x32_bf16 v[96:99], a[72:75], a[32:35], v[96:99]
    s_waitcnt lgkmcnt(10)
    s_waitcnt lgkmcnt(8)
    buffer_load_dwordx4 v13, s[16:19], s68 offen offset:0 lds
    v_exp_f32 v23, v23
    v_mfma_f32_16x16x32_bf16 v[96:99], a[76:79], a[48:51], v[96:99]
    s_add_u32 s68, s76, 113664
    ds_read_b64_tr_b16 v[46:47], v17 offset:10240
    ds_read_b64_tr_b16 a[82:83], v12 offset:50240
    v_exp_f32 v24, v24
    v_mfma_f32_16x16x32_bf16 v[100:103], a[76:79], a[52:55], v[100:103]
    buffer_load_dwordx4 v13, s[16:19], s68 offen offset:1024 lds
    ds_read_b64_tr_b16 a[84:85], v12 offset:39488
    v_exp_f32 v25, v25
    v_mfma_f32_16x16x32_bf16 v[100:103], a[72:75], a[36:39], v[100:103]
    s_add_u32 s68, s76, 129024
    ds_read_b64_tr_b16 a[86:87], v12 offset:53824
    ds_read_b64_tr_b16 a[248:249], v12 offset:7232
    v_exp_f32 v26, v26
    v_mfma_f32_16x16x32_bf16 v[100:103], a[68:71], a[20:23], v[100:103]
    buffer_load_dwordx4 v13, s[16:19], s68 offen offset:2048 lds
    ds_read_b64_tr_b16 a[250:251], v12 offset:21568
    v_exp_f32 v27, v27
    v_mfma_f32_16x16x32_bf16 v[100:103], a[64:67], a[4:7], v[100:103]
    s_add_u32 s68, s76, 144384
    ds_read_b64_tr_b16 a[252:253], v12 offset:10816
    ds_read_b64_tr_b16 a[254:255], v12 offset:25152
    v_exp_f32 v28, v28
    v_exp_f32 v29, v29
    v_pk_mul_f32 v[80:81], v[64:65], v[80:81]
    v_pk_mul_f32 v[82:83], v[66:67], v[82:83]
    v_pk_mul_f32 v[84:85], v[68:69], v[84:85]
    v_pk_mul_f32 v[86:87], v[70:71], v[86:87]
    v_pk_add_f32 v[22:23], v[22:23], 1.0 op_sel_hi:[1,0]
    v_pk_add_f32 v[24:25], v[24:25], 1.0 op_sel_hi:[1,0]
    v_pk_add_f32 v[26:27], v[26:27], 1.0 op_sel_hi:[1,0]
    v_pk_add_f32 v[28:29], v[28:29], 1.0 op_sel_hi:[1,0]
    v_mfma_f32_16x16x32_bf16 v[104:107], a[64:67], a[8:11], v[104:107]
    buffer_load_dwordx4 v13, s[16:19], s68 offen offset:3072 lds
    v_cvt_pk_bf16_f32 v64, v80, v81
    v_cvt_pk_bf16_f32 v65, v82, v83
    v_mfma_f32_16x16x32_bf16 v[104:107], a[68:71], a[24:27], v[104:107]
    s_add_u32 m0, s56, 8192
    v_cvt_pk_bf16_f32 v68, v84, v85
    v_cvt_pk_bf16_f32 v69, v86, v87
    v_rcp_f32 v22, v22
    v_mfma_f32_16x16x32_bf16 v[104:107], a[72:75], a[40:43], v[104:107]
    s_add_u32 s68, s77, 98304
    v_rcp_f32 v23, v23
    v_mfma_f32_16x16x32_bf16 v[104:107], a[76:79], a[56:59], v[104:107]
    s_waitcnt lgkmcnt(7)
    buffer_load_dwordx4 v13, s[16:19], s68 offen offset:0 lds
    v_rcp_f32 v24, v24
    v_mfma_f32_16x16x32_bf16 v[108:111], a[76:79], a[60:63], v[108:111]
    s_add_u32 s68, s77, 113664
    v_rcp_f32 v25, v25
    v_mov_b32 v2, 1
    v_mfma_f32_16x16x32_bf16 v[108:111], a[72:75], a[44:47], v[108:111]
    s_waitcnt vmcnt(5)
    v_rcp_f32 v26, v26
    v_mfma_f32_16x16x32_bf16 v[108:111], a[68:71], a[28:31], v[108:111]
    buffer_load_dwordx4 v13, s[16:19], s68 offen offset:1024 lds
    v_rcp_f32 v27, v27
    v_mfma_f32_16x16x32_bf16 v[108:111], a[64:67], a[12:15], v[108:111]
    s_waitcnt lgkmcnt(6)
    s_mov_b64 exec, 1
    buffer_store_dword v2, off, s[32:35], s63 sc1
    s_mov_b64 exec, -1
    v_rcp_f32 v28, v28
    v_rcp_f32 v29, v29
    v_pk_mul_f32 v[72:73], v[72:73], v[22:23]
    v_pk_mul_f32 v[74:75], v[74:75], v[24:25]
    v_pk_mul_f32 v[76:77], v[76:77], v[26:27]
    v_pk_mul_f32 v[78:79], v[78:79], v[28:29]
    v_pk_mul_f32 v[88:89], v[72:73], v[88:89]
    v_pk_mul_f32 v[90:91], v[74:75], v[90:91]
    v_pk_mul_f32 v[92:93], v[76:77], v[92:93]
    v_pk_mul_f32 v[94:95], v[78:79], v[94:95]
    v_pk_mul_f32 v[22:23], v[96:97], s[66:67] op_sel_hi:[1,0]
    v_pk_mul_f32 v[24:25], v[98:99], s[66:67] op_sel_hi:[1,0]
    v_pk_mul_f32 v[26:27], v[100:101], s[66:67] op_sel_hi:[1,0]
    v_pk_mul_f32 v[28:29], v[102:103], s[66:67] op_sel_hi:[1,0]
    v_mfma_f32_16x16x32_bf16 v[124:127], a[80:83], a[12:15], v[124:127]
    s_waitcnt lgkmcnt(4)
    ds_read_b64_tr_b16 a[64:65], v12 offset:28768
    v_cvt_pk_bf16_f32 v72, v88, v89
    v_cvt_pk_bf16_f32 v73, v90, v91
    v_mfma_f32_16x16x32_bf16 v[124:127], a[84:87], a[28:31], v[124:127]
    s_waitcnt lgkmcnt(3)
    s_add_u32 s68, s77, 129024
    ds_read_b64_tr_b16 a[66:67], v12 offset:43104
    v_cvt_pk_bf16_f32 v76, v92, v93
    v_cvt_pk_bf16_f32 v77, v94, v95
    v_exp_f32 v22, v22
    v_mfma_f32_16x16x32_bf16 v[124:127], a[248:251], a[44:47], v[124:127]
    s_waitcnt lgkmcnt(2)
    buffer_load_dwordx4 v13, s[16:19], s68 offen offset:2048 lds
    ds_read_b64_tr_b16 a[68:69], v12 offset:32352
    v_exp_f32 v23, v23
    v_mfma_f32_16x16x32_bf16 v[124:127], a[252:255], a[60:63], v[124:127]
    s_add_u32 s68, s77, 144384
    ds_read_b64_tr_b16 a[70:71], v12 offset:46688
    v_exp_f32 v24, v24
    v_mfma_f32_16x16x32_bf16 v[120:123], a[252:255], a[56:59], v[120:123]
    buffer_load_dwordx4 v13, s[16:19], s68 offen offset:3072 lds
    ds_read_b64_tr_b16 v[80:81], v14 offset:0
    v_exp_f32 v25, v25
    v_mfma_f32_16x16x32_bf16 v[120:123], a[248:251], a[40:43], v[120:123]
L_pad7:
    s_cbranch_vccnz L_pad11
    ds_read_b64_tr_b16 v[84:85], v15 offset:0
    ds_read_b64_tr_b16 v[88:89], v16 offset:0
    v_exp_f32 v26, v26
    v_mfma_f32_16x16x32_bf16 v[120:123], a[84:87], a[24:27], v[120:123]
    ds_read_b64_tr_b16 v[92:93], v17 offset:0
    ds_read_b64_tr_b16 a[72:73], v12 offset:96
    v_exp_f32 v27, v27
    v_mfma_f32_16x16x32_bf16 v[120:123], a[80:83], a[8:11], v[120:123]
    ds_read_b64_tr_b16 v[82:83], v14 offset:2048
    ds_read_b64_tr_b16 a[74:75], v12 offset:14432
    v_exp_f32 v28, v28
    v_exp_f32 v29, v29
    v_pk_add_f32 v[22:23], v[22:23], 1.0 op_sel_hi:[1,0]
    v_pk_add_f32 v[24:25], v[24:25], 1.0 op_sel_hi:[1,0]
    v_pk_add_f32 v[26:27], v[26:27], 1.0 op_sel_hi:[1,0]
    v_pk_add_f32 v[28:29], v[28:29], 1.0 op_sel_hi:[1,0]
    v_mfma_f32_16x16x32_bf16 v[116:119], a[80:83], a[4:7], v[116:119]
    ds_read_b64_tr_b16 v[86:87], v15 offset:2048
    ds_read_b64_tr_b16 a[76:77], v12 offset:3680
    v_mfma_f32_16x16x32_bf16 v[116:119], a[84:87], a[20:23], v[116:119]
    ds_read_b64_tr_b16 a[78:79], v12 offset:18016
    ds_read_b64_tr_b16 v[90:91], v16 offset:2048
    v_rcp_f32 v22, v22
    v_mfma_f32_16x16x32_bf16 v[116:119], a[248:251], a[36:39], v[116:119]
    ds_read_b64_tr_b16 v[94:95], v17 offset:2048
    v_rcp_f32 v23, v23
    v_mfma_f32_16x16x32_bf16 v[116:119], a[252:255], a[52:55], v[116:119]
    v_rcp_f32 v24, v24
    v_mfma_f32_16x16x32_bf16 v[112:115], a[252:255], a[48:51], v[112:115]
    v_rcp_f32 v25, v25
    v_mfma_f32_16x16x32_bf16 v[112:115], a[248:251], a[32:35], v[112:115]
    s_mov_b32 m0, s56
    v_rcp_f32 v26, v26
    v_mfma_f32_16x16x32_bf16 v[112:115], a[84:87], a[16:19], v[112:115]
    s_add_u32 s68, s74, 1015808
    v_rcp_f32 v27, v27
    v_mfma_f32_16x16x32_bf16 v[112:115], a[80:83], a[0:3], v[112:115]
    s_waitcnt lgkmcnt(14)
    v_rcp_f32 v28, v28
    v_rcp_f32 v29, v29
    v_pk_mul_f32 v[96:97], v[96:97], v[22:23]
    v_pk_mul_f32 v[98:99], v[98:99], v[24:25]
    v_pk_mul_f32 v[100:101], v[100:101], v[26:27]
    v_pk_mul_f32 v[102:103], v[102:103], v[28:29]
    v_pk_mul_f32 v[22:23], v[104:105], s[66:67] op_sel_hi:[1,0]
    v_pk_mul_f32 v[24:25], v[106:107], s[66:67] op_sel_hi:[1,0]
    v_pk_mul_f32 v[26:27], v[108:109], s[66:67] op_sel_hi:[1,0]
    v_pk_mul_f32 v[28:29], v[110:111], s[66:67] op_sel_hi:[1,0]
    v_mfma_f32_16x16x32_bf16 v[128:131], a[64:67], a[0:3], v[128:131]
    s_waitcnt lgkmcnt(12)
    ds_read_b64_tr_b16 a[80:81], v12 offset:35936
    s_waitcnt lgkmcnt(1)
    v_mfma_f32_16x16x32_bf16 v[128:131], a[68:71], a[16:19], v[128:131]
    buffer_load_dwordx4 v13, s[16:19], s68 offen offset:0 lds
    ds_read_b64_tr_b16 a[82:83], v12 offset:50272
    v_exp_f32 v22, v22
    v_mfma_f32_16x16x32_bf16 v[128:131], a[72:75], a[32:35], v[128:131]
    s_add_u32 s68, s74, 1031168
    ds_read_b64_tr_b16 a[84:85], v12 offset:39520
    v_exp_f32 v23, v23
    v_mfma_f32_16x16x32_bf16 v[128:131], a[76:79], a[48:51], v[128:131]
    buffer_load_dwordx4 v13, s[16:19], s68 offen offset:1024 lds
    ds_read_b64_tr_b16 a[86:87], v12 offset:53856
    v_exp_f32 v24, v24
    v_mfma_f32_16x16x32_bf16 v[132:135], a[76:79], a[52:55], v[132:135]
    s_add_u32 s68, s74, 1046528
    ds_read_b64_tr_b16 a[248:249], v12 offset:7264
    v_exp_f32 v25, v25
    v_mfma_f32_16x16x32_bf16 v[132:135], a[72:75], a[36:39], v[132:135]
    ds_read_b64_tr_b16 a[250:251], v12 offset:21600
    v_exp_f32 v26, v26
    v_mfma_f32_16x16x32_bf16 v[132:135], a[68:71], a[20:23], v[132:135]
    buffer_load_dwordx4 v13, s[16:19], s68 offen offset:2048 lds
    ds_read_b64_tr_b16 a[252:253], v12 offset:10848
    v_exp_f32 v27, v27
    v_mfma_f32_16x16x32_bf16 v[132:135], a[64:67], a[4:7], v[132:135]
    s_add_u32 s68, s74, 1061888
    ds_read_b64_tr_b16 a[254:255], v12 offset:25184
    v_exp_f32 v28, v28
    v_exp_f32 v29, v29
    v_pk_mul_f32 v[112:113], v[96:97], v[112:113]
    v_pk_mul_f32 v[114:115], v[98:99], v[114:115]
    v_pk_mul_f32 v[116:117], v[100:101], v[116:117]
    v_pk_mul_f32 v[118:119], v[102:103], v[118:119]
    v_pk_add_f32 v[22:23], v[22:23], 1.0 op_sel_hi:[1,0]
    v_pk_add_f32 v[24:25], v[24:25], 1.0 op_sel_hi:[1,0]
    v_pk_add_f32 v[26:27], v[26:27], 1.0 op_sel_hi:[1,0]
    v_pk_add_f32 v[28:29], v[28:29], 1.0 op_sel_hi:[1,0]
    v_mfma_f32_16x16x32_bf16 v[136:139], a[64:67], a[8:11], v[136:139]
    buffer_load_dwordx4 v13, s[16:19], s68 offen offset:3072 lds
    v_cvt_pk_bf16_f32 v66, v112, v113
    v_cvt_pk_bf16_f32 v67, v114, v115
    v_mfma_f32_16x16x32_bf16 v[136:139], a[68:71], a[24:27], v[136:139]
    v_cvt_pk_bf16_f32 v70, v116, v117
    v_cvt_pk_bf16_f32 v71, v118, v119
    v_rcp_f32 v22, v22
    v_mfma_f32_16x16x32_bf16 v[136:139], a[72:75], a[40:43], v[136:139]
    v_rcp_f32 v23, v23
    v_mfma_f32_16x16x32_bf16 v[136:139], a[76:79], a[56:59], v[136:139]
    buffer_store_dwordx4 v[64:67], v18, s[20:23], s59 offen offset:0 sc1
    v_rcp_f32 v24, v24
    v_mfma_f32_16x16x32_bf16 v[140:143], a[76:79], a[60:63], v[140:143]
    v_rcp_f32 v25, v25
    v_mfma_f32_16x16x32_bf16 v[140:143], a[72:75], a[44:47], v[140:143]
    v_rcp_f32 v26, v26
    v_mfma_f32_16x16x32_bf16 v[140:143], a[68:71], a[28:31], v[140:143]
    v_rcp_f32 v27, v27
    v_mfma_f32_16x16x32_bf16 v[140:143], a[64:67], a[12:15], v[140:143]
    s_waitcnt lgkmcnt(6)
    v_rcp_f32 v28, v28
    v_rcp_f32 v29, v29
    v_pk_mul_f32 v[104:105], v[104:105], v[22:23]
    v_pk_mul_f32 v[106:107], v[106:107], v[24:25]
    v_pk_mul_f32 v[108:109], v[108:109], v[26:27]
    v_pk_mul_f32 v[110:111], v[110:111], v[28:29]
    v_pk_mul_f32 v[120:121], v[104:105], v[120:121]
    v_pk_mul_f32 v[122:123], v[106:107], v[122:123]
    v_pk_mul_f32 v[124:125], v[108:109], v[124:125]
    v_pk_mul_f32 v[126:127], v[110:111], v[126:127]
    v_pk_mul_f32 v[22:23], v[128:129], s[66:67] op_sel_hi:[1,0]
    v_pk_mul_f32 v[24:25], v[130:131], s[66:67] op_sel_hi:[1,0]
    v_pk_mul_f32 v[26:27], v[132:133], s[66:67] op_sel_hi:[1,0]
    v_pk_mul_f32 v[28:29], v[134:135], s[66:67] op_sel_hi:[1,0]
    v_mfma_f32_16x16x32_bf16 v[156:159], a[80:83], a[12:15], v[156:159]
    s_waitcnt lgkmcnt(4)
    buffer_store_dwordx4 v[68:71], v18, s[20:23], s59 offen offset:1024 sc1
    ds_read_b64_tr_b16 a[64:65], v12 offset:28800
    v_cvt_pk_bf16_f32 v74, v120, v121
    v_cvt_pk_bf16_f32 v75, v122, v123
    v_mfma_f32_16x16x32_bf16 v[156:159], a[84:87], a[28:31], v[156:159]
    s_waitcnt lgkmcnt(3)
    ds_read_b64_tr_b16 a[66:67], v12 offset:43136
    v_cvt_pk_bf16_f32 v78, v124, v125
    v_cvt_pk_bf16_f32 v79, v126, v127
    v_exp_f32 v22, v22
    v_mfma_f32_16x16x32_bf16 v[156:159], a[248:251], a[44:47], v[156:159]
    s_waitcnt lgkmcnt(2)
    ds_read_b64_tr_b16 a[68:69], v12 offset:32384
    v_exp_f32 v23, v23
    v_mfma_f32_16x16x32_bf16 v[156:159], a[252:255], a[60:63], v[156:159]
    s_add_u32 s59, s59, 65536
    ds_read_b64_tr_b16 v[96:97], v14 offset:4096
    ds_read_b64_tr_b16 a[70:71], v12 offset:46720
    v_exp_f32 v24, v24
    v_mfma_f32_16x16x32_bf16 v[152:155], a[252:255], a[56:59], v[152:155]
    ds_read_b64_tr_b16 v[100:101], v15 offset:4096
    ds_read_b64_tr_b16 a[72:73], v12 offset:128
    v_exp_f32 v25, v25
    v_mfma_f32_16x16x32_bf16 v[152:155], a[248:251], a[40:43], v[152:155]
    buffer_store_dwordx4 v[72:75], v18, s[20:23], s60 offen offset:0 sc1
    ds_read_b64_tr_b16 v[104:105], v16 offset:4096
    v_exp_f32 v26, v26
    v_mfma_f32_16x16x32_bf16 v[152:155], a[84:87], a[24:27], v[152:155]
    ds_read_b64_tr_b16 v[108:109], v17 offset:4096
    ds_read_b64_tr_b16 a[74:75], v12 offset:14464
    v_exp_f32 v27, v27
    v_mfma_f32_16x16x32_bf16 v[152:155], a[80:83], a[8:11], v[152:155]
    ds_read_b64_tr_b16 v[98:99], v14 offset:6144
    ds_read_b64_tr_b16 a[76:77], v12 offset:3712
    v_exp_f32 v28, v28
    v_exp_f32 v29, v29
    v_pk_add_f32 v[22:23], v[22:23], 1.0 op_sel_hi:[1,0]
    v_pk_add_f32 v[24:25], v[24:25], 1.0 op_sel_hi:[1,0]
    v_pk_add_f32 v[26:27], v[26:27], 1.0 op_sel_hi:[1,0]
    v_pk_add_f32 v[28:29], v[28:29], 1.0 op_sel_hi:[1,0]
    v_mfma_f32_16x16x32_bf16 v[148:151], a[80:83], a[4:7], v[148:151]
    ds_read_b64_tr_b16 v[102:103], v15 offset:6144
    ds_read_b64_tr_b16 a[78:79], v12 offset:18048
    v_mfma_f32_16x16x32_bf16 v[148:151], a[84:87], a[20:23], v[148:151]
    ds_read_b64_tr_b16 v[106:107], v16 offset:6144
    v_rcp_f32 v22, v22
    v_mfma_f32_16x16x32_bf16 v[148:151], a[248:251], a[36:39], v[148:151]
    buffer_store_dwordx4 v[76:79], v18, s[20:23], s60 offen offset:1024 sc1
    ds_read_b64_tr_b16 v[110:111], v17 offset:6144
    v_rcp_f32 v23, v23
    v_mfma_f32_16x16x32_bf16 v[148:151], a[252:255], a[52:55], v[148:151]
    s_add_u32 s60, s60, 65536
    v_rcp_f32 v24, v24
    v_mfma_f32_16x16x32_bf16 v[144:147], a[252:255], a[48:51], v[144:147]
    v_rcp_f32 v25, v25
    v_mfma_f32_16x16x32_bf16 v[144:147], a[248:251], a[32:35], v[144:147]
    s_waitcnt vmcnt(15)
    v_rcp_f32 v26, v26
    v_mfma_f32_16x16x32_bf16 v[144:147], a[84:87], a[16:19], v[144:147]
    s_add_u32 m0, s56, 4096
    ds_read_b64_tr_b16 v[64:65], v14 offset:12288
    v_rcp_f32 v27, v27
    v_mfma_f32_16x16x32_bf16 v[144:147], a[80:83], a[0:3], v[144:147]
    s_waitcnt lgkmcnt(15)
    ds_read_b64_tr_b16 v[68:69], v15 offset:12288
    v_rcp_f32 v28, v28
    v_rcp_f32 v29, v29
    v_pk_mul_f32 v[128:129], v[128:129], v[22:23]
    v_pk_mul_f32 v[130:131], v[130:131], v[24:25]
    v_pk_mul_f32 v[132:133], v[132:133], v[26:27]
    v_pk_mul_f32 v[134:135], v[134:135], v[28:29]
    v_pk_mul_f32 v[22:23], v[136:137], s[66:67] op_sel_hi:[1,0]
    v_pk_mul_f32 v[24:25], v[138:139], s[66:67] op_sel_hi:[1,0]
    v_pk_mul_f32 v[26:27], v[140:141], s[66:67] op_sel_hi:[1,0]
    v_pk_mul_f32 v[28:29], v[142:143], s[66:67] op_sel_hi:[1,0]
    v_mfma_f32_16x16x32_bf16 v[160:163], a[64:67], a[0:3], v[160:163]
    s_waitcnt lgkmcnt(13)
    ds_read_b64_tr_b16 v[72:73], v16 offset:12288
    ds_read_b64_tr_b16 a[80:81], v12 offset:35968
    v_mfma_f32_16x16x32_bf16 v[160:163], a[68:71], a[16:19], v[160:163]
    s_waitcnt lgkmcnt(10)
    s_add_u32 s68, s75, 1015808
    ds_read_b64_tr_b16 v[76:77], v17 offset:12288
    v_exp_f32 v22, v22
    v_mfma_f32_16x16x32_bf16 v[160:163], a[72:75], a[32:35], v[160:163]
    s_waitcnt lgkmcnt(7)
    s_waitcnt lgkmcnt(5)
    buffer_load_dwordx4 v13, s[16:19], s68 offen offset:0 lds
    v_exp_f32 v23, v23
    v_mfma_f32_16x16x32_bf16 v[160:163], a[76:79], a[48:51], v[160:163]
    s_waitcnt vmcnt(14)
    ds_read_b64_tr_b16 v[66:67], v14 offset:14336
    ds_read_b64_tr_b16 v[70:71], v15 offset:14336
    v_exp_f32 v24, v24
    v_mfma_f32_16x16x32_bf16 v[164:167], a[76:79], a[52:55], v[164:167]
    s_add_u32 s68, s75, 1031168
    buffer_load_dword v21, v20, s[32:35], s64 offen sc1
    ds_read_b64_tr_b16 v[74:75], v16 offset:14336
    v_exp_f32 v25, v25
    v_mfma_f32_16x16x32_bf16 v[164:167], a[72:75], a[36:39], v[164:167]
    buffer_load_dwordx4 v13, s[16:19], s68 offen offset:1024 lds
    ds_read_b64_tr_b16 v[78:79], v17 offset:14336
    v_exp_f32 v26, v26
    v_mfma_f32_16x16x32_bf16 v[164:167], a[68:71], a[20:23], v[164:167]
    s_add_u32 s68, s75, 1046528
    ds_read_b64_tr_b16 a[82:83], v12 offset:50304
    ds_read_b64_tr_b16 a[84:85], v12 offset:39552
    v_exp_f32 v27, v27
    v_mfma_f32_16x16x32_bf16 v[164:167], a[64:67], a[4:7], v[164:167]
    buffer_load_dwordx4 v13, s[16:19], s68 offen offset:2048 lds
    ds_read_b64_tr_b16 a[86:87], v12 offset:53888
    v_exp_f32 v28, v28
    v_exp_f32 v29, v29
    v_pk_mul_f32 v[144:145], v[128:129], v[144:145]
    v_pk_mul_f32 v[146:147], v[130:131], v[146:147]
    v_pk_mul_f32 v[148:149], v[132:133], v[148:149]
    v_pk_mul_f32 v[150:151], v[134:135], v[150:151]
    v_pk_add_f32 v[22:23], v[22:23], 1.0 op_sel_hi:[1,0]
    v_pk_add_f32 v[24:25], v[24:25], 1.0 op_sel_hi:[1,0]
    v_pk_add_f32 v[26:27], v[26:27], 1.0 op_sel_hi:[1,0]
    v_pk_add_f32 v[28:29], v[28:29], 1.0 op_sel_hi:[1,0]
    v_mfma_f32_16x16x32_bf16 v[168:171], a[64:67], a[8:11], v[168:171]
    s_add_u32 s68, s75, 1061888
    ds_read_b64_tr_b16 a[248:249], v12 offset:7296
    ds_read_b64_tr_b16 a[250:251], v12 offset:21632
    v_cvt_pk_bf16_f32 v128, v144, v145
    v_cvt_pk_bf16_f32 v129, v146, v147
    v_mfma_f32_16x16x32_bf16 v[168:171], a[68:71], a[24:27], v[168:171]
    buffer_load_dwordx4 v13, s[16:19], s68 offen offset:3072 lds
    ds_read_b64_tr_b16 a[252:253], v12 offset:10880
    v_cvt_pk_bf16_f32 v132, v148, v149
    v_cvt_pk_bf16_f32 v133, v150, v151
    v_rcp_f32 v22, v22
    v_mfma_f32_16x16x32_bf16 v[168:171], a[72:75], a[40:43], v[168:171]
    s_add_u32 m0, s56, 12288
    ds_read_b64_tr_b16 a[254:255], v12 offset:25216
    v_rcp_f32 v23, v23
    v_mfma_f32_16x16x32_bf16 v[168:171], a[76:79], a[56:59], v[168:171]
    s_add_u32 s68, s76, 1015808
    v_rcp_f32 v24, v24
    v_mfma_f32_16x16x32_bf16 v[172:175], a[76:79], a[60:63], v[172:175]
    s_waitcnt lgkmcnt(7)
    buffer_load_dwordx4 v13, s[16:19], s68 offen offset:0 lds
    v_rcp_f32 v25, v25
    v_mfma_f32_16x16x32_bf16 v[172:175], a[72:75], a[44:47], v[172:175]
    s_add_u32 s68, s76, 1031168
    v_rcp_f32 v26, v26
    v_mfma_f32_16x16x32_bf16 v[172:175], a[68:71], a[28:31], v[172:175]
    buffer_load_dwordx4 v13, s[16:19], s68 offen offset:1024 lds
    v_rcp_f32 v27, v27
    v_mfma_f32_16x16x32_bf16 v[172:175], a[64:67], a[12:15], v[172:175]
    s_waitcnt lgkmcnt(6)
    v_rcp_f32 v28, v28
    v_rcp_f32 v29, v29
    v_pk_mul_f32 v[136:137], v[136:137], v[22:23]
    v_pk_mul_f32 v[138:139], v[138:139], v[24:25]
    v_pk_mul_f32 v[140:141], v[140:141], v[26:27]
    v_pk_mul_f32 v[142:143], v[142:143], v[28:29]
    v_pk_mul_f32 v[152:153], v[136:137], v[152:153]
    v_pk_mul_f32 v[154:155], v[138:139], v[154:155]
    v_pk_mul_f32 v[156:157], v[140:141], v[156:157]
    v_pk_mul_f32 v[158:159], v[142:143], v[158:159]
    v_pk_mul_f32 v[22:23], v[160:161], s[66:67] op_sel_hi:[1,0]
    v_pk_mul_f32 v[24:25], v[162:163], s[66:67] op_sel_hi:[1,0]
    v_pk_mul_f32 v[26:27], v[164:165], s[66:67] op_sel_hi:[1,0]
    v_pk_mul_f32 v[28:29], v[166:167], s[66:67] op_sel_hi:[1,0]
    v_mfma_f32_16x16x32_bf16 v[188:191], a[80:83], a[12:15], v[188:191]
    s_waitcnt lgkmcnt(4)
    ds_read_b64_tr_b16 a[64:65], v12 offset:28832
    v_cvt_pk_bf16_f32 v136, v152, v153
    v_cvt_pk_bf16_f32 v137, v154, v155
    v_mfma_f32_16x16x32_bf16 v[188:191], a[84:87], a[28:31], v[188:191]
    s_waitcnt lgkmcnt(3)
    ds_read_b64_tr_b16 a[66:67], v12 offset:43168
    v_cvt_pk_bf16_f32 v140, v156, v157
    v_cvt_pk_bf16_f32 v141, v158, v159
    v_exp_f32 v22, v22
    v_mfma_f32_16x16x32_bf16 v[188:191], a[248:251], a[44:47], v[188:191]
    s_waitcnt lgkmcnt(2)
    s_add_u32 s68, s76, 1046528
    ds_read_b64_tr_b16 a[68:69], v12 offset:32416
    v_exp_f32 v23, v23
    v_mfma_f32_16x16x32_bf16 v[188:191], a[252:255], a[60:63], v[188:191]
    s_waitcnt vmcnt(18)
    buffer_load_dwordx4 v13, s[16:19], s68 offen offset:2048 lds
    ds_read_b64_tr_b16 v[144:145], v14 offset:8192
    v_exp_f32 v24, v24
    v_mov_b32 v2, 2
    v_mfma_f32_16x16x32_bf16 v[184:187], a[252:255], a[56:59], v[184:187]
    s_add_u32 s68, s76, 1061888
    ds_read_b64_tr_b16 v[148:149], v15 offset:8192
    ds_read_b64_tr_b16 a[70:71], v12 offset:46752
    v_exp_f32 v25, v25
    v_mfma_f32_16x16x32_bf16 v[184:187], a[248:251], a[40:43], v[184:187]
    s_waitcnt vmcnt(8)
    buffer_load_dwordx4 v13, s[16:19], s68 offen offset:3072 lds
    ds_read_b64_tr_b16 v[152:153], v16 offset:8192
    v_exp_f32 v26, v26
    v_mfma_f32_16x16x32_bf16 v[184:187], a[84:87], a[24:27], v[184:187]
    s_mov_b64 exec, 1
    buffer_store_dword v2, off, s[32:35], s63 sc1
    s_mov_b64 exec, -1
    v_exp_f32 v27, v27
    v_mfma_f32_16x16x32_bf16 v[184:187], a[80:83], a[8:11], v[184:187]
    ds_read_b64_tr_b16 v[156:157], v17 offset:8192
    ds_read_b64_tr_b16 v[146:147], v14 offset:10240
    v_exp_f32 v28, v28
    v_exp_f32 v29, v29
    v_pk_add_f32 v[22:23], v[22:23], 1.0 op_sel_hi:[1,0]
    v_pk_add_f32 v[24:25], v[24:25], 1.0 op_sel_hi:[1,0]
    v_pk_add_f32 v[26:27], v[26:27], 1.0 op_sel_hi:[1,0]
    v_pk_add_f32 v[28:29], v[28:29], 1.0 op_sel_hi:[1,0]
    v_mfma_f32_16x16x32_bf16 v[180:183], a[80:83], a[4:7], v[180:183]
    ds_read_b64_tr_b16 a[72:73], v12 offset:160
    ds_read_b64_tr_b16 a[74:75], v12 offset:14496
    v_mfma_f32_16x16x32_bf16 v[180:183], a[84:87], a[20:23], v[180:183]
    ds_read_b64_tr_b16 v[150:151], v15 offset:10240
    ds_read_b64_tr_b16 a[76:77], v12 offset:3744
    v_rcp_f32 v22, v22
    v_mfma_f32_16x16x32_bf16 v[180:183], a[248:251], a[36:39], v[180:183]
    ds_read_b64_tr_b16 a[78:79], v12 offset:18080
    ds_read_b64_tr_b16 v[154:155], v16 offset:10240
    v_rcp_f32 v23, v23
    v_mfma_f32_16x16x32_bf16 v[180:183], a[252:255], a[52:55], v[180:183]
    ds_read_b64_tr_b16 v[158:159], v17 offset:10240
    v_rcp_f32 v24, v24
    v_mfma_f32_16x16x32_bf16 v[176:179], a[252:255], a[48:51], v[176:179]
    v_rcp_f32 v25, v25
    v_mfma_f32_16x16x32_bf16 v[176:179], a[248:251], a[32:35], v[176:179]
    s_add_u32 m0, s0, 131072
    v_rcp_f32 v26, v26
    v_mfma_f32_16x16x32_bf16 v[176:179], a[84:87], a[16:19], v[176:179]
    s_waitcnt vmcnt(8)
    v_rcp_f32 v27, v27
    v_mfma_f32_16x16x32_bf16 v[176:179], a[80:83], a[0:3], v[176:179]
    s_waitcnt lgkmcnt(14)
    v_cmp_gt_u32 vcc, 1, v21
    s_cbranch_vccnz L_slow_f1
L_back_f1:
    v_rcp_f32 v28, v28
    v_rcp_f32 v29, v29
    v_pk_mul_f32 v[160:161], v[160:161], v[22:23]
    v_pk_mul_f32 v[162:163], v[162:163], v[24:25]
    v_pk_mul_f32 v[164:165], v[164:165], v[26:27]
    v_pk_mul_f32 v[166:167], v[166:167], v[28:29]
    v_pk_mul_f32 v[22:23], v[168:169], s[66:67] op_sel_hi:[1,0]
    v_pk_mul_f32 v[24:25], v[170:171], s[66:67] op_sel_hi:[1,0]
    v_pk_mul_f32 v[26:27], v[172:173], s[66:67] op_sel_hi:[1,0]
    v_pk_mul_f32 v[28:29], v[174:175], s[66:67] op_sel_hi:[1,0]
    v_mfma_f32_16x16x32_bf16 v[192:195], a[64:67], a[0:3], v[192:195]
    s_waitcnt lgkmcnt(10)
    ds_read_b64_tr_b16 a[80:81], v12 offset:36000
    s_add_u32 s68, s92, 2048
    v_mfma_f32_16x16x32_bf16 v[192:195], a[68:71], a[16:19], v[192:195]
    s_waitcnt lgkmcnt(6)
    buffer_load_dwordx4 v10, s[24:27], s68 offen offset:0 sc1 lds
    ds_read_b64_tr_b16 a[82:83], v12 offset:50336
    v_exp_f32 v22, v22
    v_mfma_f32_16x16x32_bf16 v[192:195], a[72:75], a[32:35], v[192:195]
    s_waitcnt lgkmcnt(4)
    ds_read_b64_tr_b16 a[84:85], v12 offset:39584
    v_exp_f32 v23, v23
    v_mfma_f32_16x16x32_bf16 v[192:195], a[76:79], a[48:51], v[192:195]
    s_add_u32 s68, s93, 0
    ds_read_b64_tr_b16 a[86:87], v12 offset:53920
    v_exp_f32 v24, v24
    v_mfma_f32_16x16x32_bf16 v[196:199], a[76:79], a[52:55], v[196:199]
    buffer_load_dwordx4 v10, s[24:27], s68 offen offset:2048 sc1 lds
    ds_read_b64_tr_b16 a[248:249], v12 offset:7328
    v_exp_f32 v25, v25
    v_mfma_f32_16x16x32_bf16 v[196:199], a[72:75], a[36:39], v[196:199]
    s_add_u32 m0, s0, 135168
    ds_read_b64_tr_b16 a[250:251], v12 offset:21664
    v_exp_f32 v26, v26
    v_mfma_f32_16x16x32_bf16 v[196:199], a[68:71], a[20:23], v[196:199]
    s_add_u32 s68, s92, 3072
    ds_read_b64_tr_b16 a[252:253], v12 offset:10912
    v_exp_f32 v27, v27
    v_mfma_f32_16x16x32_bf16 v[196:199], a[64:67], a[4:7], v[196:199]
    buffer_load_dwordx4 v10, s[24:27], s68 offen offset:0 sc1 lds
    ds_read_b64_tr_b16 a[254:255], v12 offset:25248
    v_exp_f32 v28, v28
    v_exp_f32 v29, v29
    v_pk_mul_f32 v[176:177], v[160:161], v[176:177]
    v_pk_mul_f32 v[178:179], v[162:163], v[178:179]
    v_pk_mul_f32 v[180:181], v[164:165], v[180:181]
    v_pk_mul_f32 v[182:183], v[166:167], v[182:183]
    v_pk_add_f32 v[22:23], v[22:23], 1.0 op_sel_hi:[1,0]
    v_pk_add_f32 v[24:25], v[24:25], 1.0 op_sel_hi:[1,0]
    v_pk_add_f32 v[26:27], v[26:27], 1.0 op_sel_hi:[1,0]
    v_pk_add_f32 v[28:29], v[28:29], 1.0 op_sel_hi:[1,0]
    v_mfma_f32_16x16x32_bf16 v[200:203], a[64:67], a[8:11], v[200:203]
    s_add_u32 s68, s93, 1024
    v_cvt_pk_bf16_f32 v130, v176, v177
    v_cvt_pk_bf16_f32 v131, v178, v179
    v_mfma_f32_16x16x32_bf16 v[200:203], a[68:71], a[24:27], v[200:203]
    buffer_load_dwordx4 v10, s[24:27], s68 offen offset:2048 sc1 lds
    v_cvt_pk_bf16_f32 v134, v180, v181
    v_cvt_pk_bf16_f32 v135, v182, v183
    v_rcp_f32 v22, v22
    v_mfma_f32_16x16x32_bf16 v[200:203], a[72:75], a[40:43], v[200:203]
    s_add_u32 m0, s0, 139264
    v_rcp_f32 v23, v23
    v_mfma_f32_16x16x32_bf16 v[200:203], a[76:79], a[56:59], v[200:203]
    s_add_u32 s68, s92, 4096
    buffer_store_dwordx4 v[128:131], v18, s[20:23], s59 offen offset:0 sc1
    v_rcp_f32 v24, v24
    v_mfma_f32_16x16x32_bf16 v[204:207], a[76:79], a[60:63], v[204:207]
    buffer_load_dwordx4 v10, s[24:27], s68 offen offset:0 sc1 lds
    v_rcp_f32 v25, v25
    v_mfma_f32_16x16x32_bf16 v[204:207], a[72:75], a[44:47], v[204:207]
    s_add_u32 s68, s93, 2048
    v_rcp_f32 v26, v26
    v_mfma_f32_16x16x32_bf16 v[204:207], a[68:71], a[28:31], v[204:207]
    buffer_load_dwordx4 v10, s[24:27], s68 offen offset:2048 sc1 lds
    v_rcp_f32 v27, v27
    v_mfma_f32_16x16x32_bf16 v[204:207], a[64:67], a[12:15], v[204:207]
    s_waitcnt lgkmcnt(6)
    v_rcp_f32 v28, v28
    v_rcp_f32 v29, v29
    v_pk_mul_f32 v[168:169], v[168:169], v[22:23]
    v_pk_mul_f32 v[170:171], v[170:171], v[24:25]
    v_pk_mul_f32 v[172:173], v[172:173], v[26:27]
    v_pk_mul_f32 v[174:175], v[174:175], v[28:29]
    v_pk_mul_f32 v[184:185], v[168:169], v[184:185]
    v_pk_mul_f32 v[186:187], v[170:171], v[186:187]
    v_pk_mul_f32 v[188:189], v[172:173], v[188:189]
    v_pk_mul_f32 v[190:191], v[174:175], v[190:191]
    v_pk_mul_f32 v[22:23], v[192:193], s[66:67] op_sel_hi:[1,0]
    v_pk_mul_f32 v[24:25], v[194:195], s[66:67] op_sel_hi:[1,0]
    v_pk_mul_f32 v[26:27], v[196:197], s[66:67] op_sel_hi:[1,0]
    v_pk_mul_f32 v[28:29], v[198:199], s[66:67] op_sel_hi:[1,0]
    v_mfma_f32_16x16x32_bf16 v[220:223], a[80:83], a[12:15], v[220:223]
    s_waitcnt lgkmcnt(4)
    ds_read_b64_tr_b16 a[64:65], v12 offset:28864
    v_cvt_pk_bf16_f32 v138, v184, v185
    v_cvt_pk_bf16_f32 v139, v186, v187
    v_mfma_f32_16x16x32_bf16 v[220:223], a[84:87], a[28:31], v[220:223]
    s_waitcnt lgkmcnt(3)
    s_add_u32 m0, s0, 143360
    s_add_u32 s68, s92, 5120
    v_cvt_pk_bf16_f32 v142, v188, v189
    v_cvt_pk_bf16_f32 v143, v190, v191
    v_exp_f32 v22, v22
    v_mfma_f32_16x16x32_bf16 v[220:223], a[248:251], a[44:47], v[220:223]
    s_waitcnt lgkmcnt(1)
    buffer_load_dwordx4 v10, s[24:27], s68 offen offset:0 sc1 lds
    ds_read_b64_tr_b16 a[66:67], v12 offset:43200
    v_exp_f32 v23, v23
    v_mfma_f32_16x16x32_bf16 v[220:223], a[252:255], a[60:63], v[220:223]
    s_add_u32 s68, s93, 3072
    buffer_store_dwordx4 v[132:135], v18, s[20:23], s59 offen offset:1024 sc1
    ds_read_b64_tr_b16 a[68:69], v12 offset:32448
    v_exp_f32 v24, v24
    v_mfma_f32_16x16x32_bf16 v[216:219], a[252:255], a[56:59], v[216:219]
    s_add_u32 s59, s59, 65536
    buffer_load_dwordx4 v10, s[24:27], s68 offen offset:2048 sc1 lds
    ds_read_b64_tr_b16 v[160:161], v14 offset:0
    v_exp_f32 v25, v25
    v_mfma_f32_16x16x32_bf16 v[216:219], a[248:251], a[40:43], v[216:219]
    s_add_u32 m0, s56, 8192
    ds_read_b64_tr_b16 v[164:165], v15 offset:0
    ds_read_b64_tr_b16 v[168:169], v16 offset:0
    v_exp_f32 v26, v26
    v_mfma_f32_16x16x32_bf16 v[216:219], a[84:87], a[24:27], v[216:219]
    s_add_u32 s68, s77, 1015808
    ds_read_b64_tr_b16 v[172:173], v17 offset:0
    ds_read_b64_tr_b16 a[70:71], v12 offset:46784
    v_exp_f32 v27, v27
    v_mfma_f32_16x16x32_bf16 v[216:219], a[80:83], a[8:11], v[216:219]
    ds_read_b64_tr_b16 v[162:163], v14 offset:2048
    ds_read_b64_tr_b16 a[72:73], v12 offset:192
    v_exp_f32 v28, v28
    v_exp_f32 v29, v29
    v_pk_add_f32 v[22:23], v[22:23], 1.0 op_sel_hi:[1,0]
    v_pk_add_f32 v[24:25], v[24:25], 1.0 op_sel_hi:[1,0]
    v_pk_add_f32 v[26:27], v[26:27], 1.0 op_sel_hi:[1,0]
    v_pk_add_f32 v[28:29], v[28:29], 1.0 op_sel_hi:[1,0]
    v_mfma_f32_16x16x32_bf16 v[212:215], a[80:83], a[4:7], v[212:215]
    buffer_load_dwordx4 v13, s[16:19], s68 offen offset:0 lds
    ds_read_b64_tr_b16 a[74:75], v12 offset:14528
    v_mfma_f32_16x16x32_bf16 v[212:215], a[84:87], a[20:23], v[212:215]
    ds_read_b64_tr_b16 v[166:167], v15 offset:2048
    ds_read_b64_tr_b16 a[76:77], v12 offset:3776
    v_rcp_f32 v22, v22
    v_mfma_f32_16x16x32_bf16 v[212:215], a[248:251], a[36:39], v[212:215]
    s_waitcnt vmcnt(18)
    ds_read_b64_tr_b16 a[78:79], v12 offset:18112
    ds_read_b64_tr_b16 v[170:171], v16 offset:2048
    v_rcp_f32 v23, v23
    v_mfma_f32_16x16x32_bf16 v[212:215], a[252:255], a[52:55], v[212:215]
    buffer_store_dwordx4 v[136:139], v18, s[20:23], s60 offen offset:0 sc1
    ds_read_b64_tr_b16 v[174:175], v17 offset:2048
    v_rcp_f32 v24, v24
    v_mfma_f32_16x16x32_bf16 v[208:211], a[252:255], a[48:51], v[208:211]
    ds_read_b64_tr_b16 v[176:177], v14 offset:4096
    ds_read_b64_tr_b16 v[180:181], v15 offset:4096
    v_rcp_f32 v25, v25
    v_mfma_f32_16x16x32_bf16 v[208:211], a[248:251], a[32:35], v[208:211]
    ds_read_b64_tr_b16 v[184:185], v16 offset:4096
    v_rcp_f32 v26, v26
    v_mfma_f32_16x16x32_bf16 v[208:211], a[84:87], a[16:19], v[208:211]
    s_waitcnt vmcnt(17)
    ds_read_b64_tr_b16 v[188:189], v17 offset:4096
    v_rcp_f32 v27, v27
    v_mfma_f32_16x16x32_bf16 v[208:211], a[80:83], a[0:3], v[208:211]
    s_waitcnt lgkmcnt(15)
    ds_read_b64_tr_b16 v[178:179], v14 offset:6144
    v_rcp_f32 v28, v28
    v_rcp_f32 v29, v29
    v_pk_mul_f32 v[192:193], v[192:193], v[22:23]
    v_pk_mul_f32 v[194:195], v[194:195], v[24:25]
    v_pk_mul_f32 v[196:197], v[196:197], v[26:27]
    v_pk_mul_f32 v[198:199], v[198:199], v[28:29]
    v_pk_mul_f32 v[22:23], v[200:201], s[66:67] op_sel_hi:[1,0]
    v_pk_mul_f32 v[24:25], v[202:203], s[66:67] op_sel_hi:[1,0]
    v_pk_mul_f32 v[26:27], v[204:205], s[66:67] op_sel_hi:[1,0]
    v_pk_mul_f32 v[28:29], v[206:207], s[66:67] op_sel_hi:[1,0]
    v_mfma_f32_16x16x32_bf16 v[224:227], a[64:67], a[0:3], v[224:227]
    s_waitcnt lgkmcnt(13)
    ds_read_b64_tr_b16 v[182:183], v15 offset:6144
    ds_read_b64_tr_b16 a[80:81], v12 offset:36032
    v_mfma_f32_16x16x32_bf16 v[224:227], a[68:71], a[16:19], v[224:227]
    s_waitcnt lgkmcnt(12)
    s_add_u32 s68, s77, 1031168
    ds_read_b64_tr_b16 v[186:187], v16 offset:6144
    v_exp_f32 v22, v22
    v_mfma_f32_16x16x32_bf16 v[224:227], a[72:75], a[32:35], v[224:227]
    s_waitcnt lgkmcnt(10)
    buffer_load_dwordx4 v13, s[16:19], s68 offen offset:1024 lds
    ds_read_b64_tr_b16 v[190:191], v17 offset:6144
    v_exp_f32 v23, v23
    v_mfma_f32_16x16x32_bf16 v[224:227], a[76:79], a[48:51], v[224:227]
    buffer_store_dwordx4 v[140:143], v18, s[20:23], s60 offen offset:1024 sc1
    ds_read_b64_tr_b16 a[82:83], v12 offset:50368
    v_exp_f32 v24, v24
    v_mfma_f32_16x16x32_bf16 v[228:231], a[76:79], a[52:55], v[228:231]
    s_add_u32 s60, s60, 65536
    ds_read_b64_tr_b16 a[84:85], v12 offset:39616
    ds_read_b64_tr_b16 a[86:87], v12 offset:53952
    v_exp_f32 v25, v25
    v_mfma_f32_16x16x32_bf16 v[228:231], a[72:75], a[36:39], v[228:231]
    ds_read_b64_tr_b16 a[248:249], v12 offset:7360
    ds_read_b64_tr_b16 a[250:251], v12 offset:21696
    v_exp_f32 v26, v26
    v_mfma_f32_16x16x32_bf16 v[228:231], a[68:71], a[20:23], v[228:231]
    s_waitcnt vmcnt(17)
    ds_read_b64_tr_b16 a[252:253], v12 offset:10944
    v_exp_f32 v27, v27
    v_mfma_f32_16x16x32_bf16 v[228:231], a[64:67], a[4:7], v[228:231]
    s_add_u32 s68, s77, 1046528
    ds_read_b64_tr_b16 v[128:129], v14 offset:12288
    ds_read_b64_tr_b16 a[254:255], v12 offset:25280
    v_exp_f32 v28, v28
    v_exp_f32 v29, v29
    v_pk_mul_f32 v[208:209], v[192:193], v[208:209]
    v_pk_mul_f32 v[210:211], v[194:195], v[210:211]
    v_pk_mul_f32 v[212:213], v[196:197], v[212:213]
    v_pk_mul_f32 v[214:215], v[198:199], v[214:215]
    v_pk_add_f32 v[22:23], v[22:23], 1.0 op_sel_hi:[1,0]
    v_pk_add_f32 v[24:25], v[24:25], 1.0 op_sel_hi:[1,0]
    v_pk_add_f32 v[26:27], v[26:27], 1.0 op_sel_hi:[1,0]
    v_pk_add_f32 v[28:29], v[28:29], 1.0 op_sel_hi:[1,0]
    v_mfma_f32_16x16x32_bf16 v[232:235], a[64:67], a[8:11], v[232:235]
    buffer_load_dwordx4 v13, s[16:19], s68 offen offset:2048 lds
    ds_read_b64_tr_b16 v[132:133], v15 offset:12288
    v_cvt_pk_bf16_f32 v112, v208, v209
    v_cvt_pk_bf16_f32 v113, v210, v211
    v_mfma_f32_16x16x32_bf16 v[232:235], a[68:71], a[24:27], v[232:235]
    s_add_u32 s68, s77, 1061888
    ds_read_b64_tr_b16 v[136:137], v16 offset:12288
L_pad8:
    s_cbranch_vccnz L_warm
    v_cvt_pk_bf16_f32 v116, v212, v213
    v_cvt_pk_bf16_f32 v117, v214, v215
    v_rcp_f32 v22, v22
    v_mfma_f32_16x16x32_bf16 v[232:235], a[72:75], a[40:43], v[232:235]
    s_waitcnt vmcnt(16)
    ds_read_b64_tr_b16 v[140:141], v17 offset:12288
    v_rcp_f32 v23, v23
    v_mfma_f32_16x16x32_bf16 v[232:235], a[76:79], a[56:59], v[232:235]
    buffer_load_dwordx4 v13, s[16:19], s68 offen offset:3072 lds
    ds_read_b64_tr_b16 v[130:131], v14 offset:14336
    v_rcp_f32 v24, v24
    v_mfma_f32_16x16x32_bf16 v[236:239], a[76:79], a[60:63], v[236:239]
    s_mov_b32 m0, s56
    ds_read_b64_tr_b16 v[134:135], v15 offset:14336
    v_rcp_f32 v25, v25
    v_mfma_f32_16x16x32_bf16 v[236:239], a[72:75], a[44:47], v[236:239]
    s_add_u32 s68, s74, 163840
    ds_read_b64_tr_b16 v[138:139], v16 offset:14336
    v_rcp_f32 v26, v26
    v_mfma_f32_16x16x32_bf16 v[236:239], a[68:71], a[28:31], v[236:239]
    s_waitcnt lgkmcnt(15)
    buffer_load_dwordx4 v13, s[16:19], s68 offen offset:0 lds
    ds_read_b64_tr_b16 v[142:143], v17 offset:14336
    v_rcp_f32 v27, v27
    v_mfma_f32_16x16x32_bf16 v[236:239], a[64:67], a[12:15], v[236:239]
    s_waitcnt lgkmcnt(14)
    v_rcp_f32 v28, v28
    v_rcp_f32 v29, v29
    v_pk_mul_f32 v[200:201], v[200:201], v[22:23]
    v_pk_mul_f32 v[202:203], v[202:203], v[24:25]
    v_pk_mul_f32 v[204:205], v[204:205], v[26:27]
    v_pk_mul_f32 v[206:207], v[206:207], v[28:29]
    v_pk_mul_f32 v[216:217], v[200:201], v[216:217]
    v_pk_mul_f32 v[218:219], v[202:203], v[218:219]
    v_pk_mul_f32 v[220:221], v[204:205], v[220:221]
    v_pk_mul_f32 v[222:223], v[206:207], v[222:223]
    v_pk_mul_f32 v[22:23], v[224:225], s[66:67] op_sel_hi:[1,0]
    v_pk_mul_f32 v[24:25], v[226:227], s[66:67] op_sel_hi:[1,0]
    v_pk_mul_f32 v[26:27], v[228:229], s[66:67] op_sel_hi:[1,0]
    v_pk_mul_f32 v[28:29], v[230:231], s[66:67] op_sel_hi:[1,0]
    v_mfma_f32_16x16x32_bf16 v[252:255], a[80:83], a[12:15], v[252:255]
    s_waitcnt lgkmcnt(12)
    v_cvt_pk_bf16_f32 v120, v216, v217
    v_cvt_pk_bf16_f32 v121, v218, v219
    v_mfma_f32_16x16x32_bf16 v[252:255], a[84:87], a[28:31], v[252:255]
    s_waitcnt lgkmcnt(10)
    s_add_u32 s68, s74, 179200
    v_cvt_pk_bf16_f32 v124, v220, v221
    v_cvt_pk_bf16_f32 v125, v222, v223
    v_exp_f32 v22, v22
    v_mfma_f32_16x16x32_bf16 v[252:255], a[248:251], a[44:47], v[252:255]
    s_waitcnt lgkmcnt(7)
    buffer_load_dwordx4 v13, s[16:19], s68 offen offset:1024 lds
    v_exp_f32 v23, v23
    v_mfma_f32_16x16x32_bf16 v[252:255], a[252:255], a[60:63], v[252:255]
    s_add_u32 s68, s74, 194560
    v_exp_f32 v24, v24
    v_mfma_f32_16x16x32_bf16 v[248:251], a[252:255], a[56:59], v[248:251]
    buffer_load_dwordx4 v13, s[16:19], s68 offen offset:2048 lds
    v_exp_f32 v25, v25
    v_mfma_f32_16x16x32_bf16 v[248:251], a[248:251], a[40:43], v[248:251]
    s_waitcnt vmcnt(9)
    v_exp_f32 v26, v26
    v_mfma_f32_16x16x32_bf16 v[248:251], a[84:87], a[24:27], v[248:251]
    s_barrier
    v_exp_f32 v27, v27
    v_mfma_f32_16x16x32_bf16 v[248:251], a[80:83], a[8:11], v[248:251]
    s_add_u32 m0, s0, 65536
    ds_read_b128 a[64:67], v7 offset:0
    v_exp_f32 v28, v28
    v_exp_f32 v29, v29
    v_pk_add_f32 v[22:23], v[22:23], 1.0 op_sel_hi:[1,0]
    v_pk_add_f32 v[24:25], v[24:25], 1.0 op_sel_hi:[1,0]
    v_pk_add_f32 v[26:27], v[26:27], 1.0 op_sel_hi:[1,0]
    v_pk_add_f32 v[28:29], v[28:29], 1.0 op_sel_hi:[1,0]
    v_mfma_f32_16x16x32_bf16 v[244:247], a[80:83], a[4:7], v[244:247]
    s_add_u32 s68, s92, 6144
    ds_read_b128 a[68:71], v7 offset:1024
    v_mfma_f32_16x16x32_bf16 v[244:247], a[84:87], a[20:23], v[244:247]
    buffer_load_dwordx4 v10, s[24:27], s68 offen offset:0 sc1 lds
    ds_read_b128 a[72:75], v7 offset:2048
    v_rcp_f32 v22, v22
    v_mfma_f32_16x16x32_bf16 v[244:247], a[248:251], a[36:39], v[244:247]
    s_add_u32 s68, s93, 4096
    ds_read_b128 a[76:79], v7 offset:3072
    buffer_load_dword v21, v20, s[32:35], s64 offen sc1
    v_rcp_f32 v23, v23
    v_mfma_f32_16x16x32_bf16 v[244:247], a[252:255], a[52:55], v[244:247]
    buffer_load_dwordx4 v10, s[24:27], s68 offen offset:2048 sc1 lds
    v_rcp_f32 v24, v24
    v_mfma_f32_16x16x32_bf16 v[240:243], a[252:255], a[48:51], v[240:243]
    s_add_u32 m0, s0, 69632
    v_rcp_f32 v25, v25
    v_mfma_f32_16x16x32_bf16 v[240:243], a[248:251], a[32:35], v[240:243]
    s_add_u32 s68, s92, 7168
    v_rcp_f32 v26, v26
    v_mfma_f32_16x16x32_bf16 v[240:243], a[84:87], a[16:19], v[240:243]
    buffer_load_dwordx4 v10, s[24:27], s68 offen offset:0 sc1 lds
    v_rcp_f32 v27, v27
    v_mfma_f32_16x16x32_bf16 v[240:243], a[80:83], a[0:3], v[240:243]
    s_waitcnt lgkmcnt(3)
    v_rcp_f32 v28, v28
    v_rcp_f32 v29, v29
    v_pk_mul_f32 v[224:225], v[224:225], v[22:23]
    v_pk_mul_f32 v[226:227], v[226:227], v[24:25]
    v_pk_mul_f32 v[228:229], v[228:229], v[26:27]
    v_pk_mul_f32 v[230:231], v[230:231], v[28:29]
    v_pk_mul_f32 v[22:23], v[232:233], s[66:67] op_sel_hi:[1,0]
    v_pk_mul_f32 v[24:25], v[234:235], s[66:67] op_sel_hi:[1,0]
    v_pk_mul_f32 v[26:27], v[236:237], s[66:67] op_sel_hi:[1,0]
    v_pk_mul_f32 v[28:29], v[238:239], s[66:67] op_sel_hi:[1,0]
    v_mfma_f32_16x16x32_bf16 a[12:15], a[100:103], a[64:67], 0
    s_waitcnt lgkmcnt(2)
    ds_read_b128 a[80:83], v7 offset:4096
    s_add_u32 s68, s93, 5120
    v_mfma_f32_16x16x32_bf16 a[12:15], a[116:119], a[68:71], a[12:15]
    s_waitcnt lgkmcnt(2)
    buffer_load_dwordx4 v10, s[24:27], s68 offen offset:2048 sc1 lds
    v_exp_f32 v22, v22
    v_mfma_f32_16x16x32_bf16 a[12:15], a[132:135], a[72:75], a[12:15]
    s_waitcnt lgkmcnt(1)
    ds_read_b128 a[84:87], v7 offset:5120
    v_exp_f32 v23, v23
    v_mfma_f32_16x16x32_bf16 a[12:15], a[148:151], a[76:79], a[12:15]
    s_add_u32 m0, s0, 73728
    v_exp_f32 v24, v24
    v_mfma_f32_16x16x32_bf16 a[8:11], a[144:147], a[76:79], 0
    s_add_u32 s68, s92, 8192
    ds_read_b128 a[248:251], v7 offset:6144
    v_exp_f32 v25, v25
    v_mfma_f32_16x16x32_bf16 a[8:11], a[128:131], a[72:75], a[8:11]
    buffer_load_dwordx4 v10, s[24:27], s68 offen offset:0 sc1 lds
    v_exp_f32 v26, v26
    v_mfma_f32_16x16x32_bf16 a[8:11], a[112:115], a[68:71], a[8:11]
    s_add_u32 s68, s93, 6144
    ds_read_b128 a[252:255], v7 offset:7168
    v_exp_f32 v27, v27
    v_mfma_f32_16x16x32_bf16 a[8:11], a[96:99], a[64:67], a[8:11]
    buffer_load_dwordx4 v10, s[24:27], s68 offen offset:2048 sc1 lds
    v_exp_f32 v28, v28
    v_exp_f32 v29, v29
    v_pk_mul_f32 v[240:241], v[224:225], v[240:241]
    v_pk_mul_f32 v[242:243], v[226:227], v[242:243]
    v_pk_mul_f32 v[244:245], v[228:229], v[244:245]
    v_pk_mul_f32 v[246:247], v[230:231], v[246:247]
    v_pk_add_f32 v[22:23], v[22:23], 1.0 op_sel_hi:[1,0]
    v_pk_add_f32 v[24:25], v[24:25], 1.0 op_sel_hi:[1,0]
    v_pk_add_f32 v[26:27], v[26:27], 1.0 op_sel_hi:[1,0]
    v_pk_add_f32 v[28:29], v[28:29], 1.0 op_sel_hi:[1,0]
    v_mfma_f32_16x16x32_bf16 a[4:7], a[92:95], a[64:67], 0
    s_add_u32 m0, s0, 77824
    v_cvt_pk_bf16_f32 v114, v240, v241
    v_cvt_pk_bf16_f32 v115, v242, v243
    v_mfma_f32_16x16x32_bf16 a[4:7], a[108:111], a[68:71], a[4:7]
    s_add_u32 s68, s92, 9216
    v_cvt_pk_bf16_f32 v118, v244, v245
    v_cvt_pk_bf16_f32 v119, v246, v247
    v_rcp_f32 v22, v22
    v_mfma_f32_16x16x32_bf16 a[4:7], a[124:127], a[72:75], a[4:7]
    v_rcp_f32 v23, v23
    v_mfma_f32_16x16x32_bf16 a[4:7], a[140:143], a[76:79], a[4:7]
    buffer_store_dwordx4 v[112:115], v18, s[20:23], s59 offen offset:0 sc1
    buffer_load_dwordx4 v10, s[24:27], s68 offen offset:0 sc1 lds
    v_rcp_f32 v24, v24
    v_mfma_f32_16x16x32_bf16 a[0:3], a[136:139], a[76:79], 0
    v_rcp_f32 v25, v25
    v_mfma_f32_16x16x32_bf16 a[0:3], a[120:123], a[72:75], a[0:3]
    s_add_u32 s68, s93, 7168
    v_rcp_f32 v26, v26
    v_mfma_f32_16x16x32_bf16 a[0:3], a[104:107], a[68:71], a[0:3]
    v_rcp_f32 v27, v27
    v_mfma_f32_16x16x32_bf16 a[0:3], a[88:91], a[64:67], a[0:3]
    s_waitcnt lgkmcnt(3)
    buffer_load_dwordx4 v10, s[24:27], s68 offen offset:2048 sc1 lds
    v_rcp_f32 v28, v28
    v_rcp_f32 v29, v29
    v_pk_mul_f32 v[232:233], v[232:233], v[22:23]
    v_pk_mul_f32 v[234:235], v[234:235], v[24:25]
    v_pk_mul_f32 v[236:237], v[236:237], v[26:27]
    v_pk_mul_f32 v[238:239], v[238:239], v[28:29]
    v_pk_mul_f32 v[248:249], v[232:233], v[248:249]
    v_pk_mul_f32 v[250:251], v[234:235], v[250:251]
    v_pk_mul_f32 v[252:253], v[236:237], v[252:253]
    v_pk_mul_f32 v[254:255], v[238:239], v[254:255]
    v_mfma_f32_16x16x32_bf16 a[16:19], a[88:91], a[80:83], 0
    s_waitcnt lgkmcnt(2)
    ds_read_b128 a[64:67], v7 offset:8192
    v_cvt_pk_bf16_f32 v122, v248, v249
    v_cvt_pk_bf16_f32 v123, v250, v251
    v_mfma_f32_16x16x32_bf16 a[16:19], a[104:107], a[84:87], a[16:19]
    s_waitcnt lgkmcnt(2)
    v_cvt_pk_bf16_f32 v126, v252, v253
    v_cvt_pk_bf16_f32 v127, v254, v255
    v_mfma_f32_16x16x32_bf16 a[16:19], a[120:123], a[248:251], a[16:19]
    s_waitcnt lgkmcnt(1)
    ds_read_b128 a[68:71], v7 offset:9216
    s_mov_b32 m0, s56
    v_mfma_f32_16x16x32_bf16 a[16:19], a[136:139], a[252:255], a[16:19]
    s_add_u32 s68, s74, 209920
    v_mfma_f32_16x16x32_bf16 a[20:23], a[140:143], a[252:255], 0
    buffer_load_dwordx4 v13, s[16:19], s68 offen offset:3072 lds
    v_mfma_f32_16x16x32_bf16 a[20:23], a[124:127], a[248:251], a[20:23]
    ds_read_b128 a[72:75], v7 offset:10240
    v_mfma_f32_16x16x32_bf16 a[20:23], a[108:111], a[84:87], a[20:23]
    buffer_store_dwordx4 v[116:119], v18, s[20:23], s59 offen offset:1024 sc1
    v_mfma_f32_16x16x32_bf16 a[20:23], a[92:95], a[80:83], a[20:23]
    ds_read_b128 a[76:79], v7 offset:11264
    v_mfma_f32_16x16x32_bf16 a[24:27], a[96:99], a[80:83], 0
    s_add_u32 m0, s0, 98304
    v_mfma_f32_16x16x32_bf16 a[24:27], a[112:115], a[84:87], a[24:27]
    s_waitcnt vmcnt(10)
    s_add_u32 s68, s92, 34816
    v_mfma_f32_16x16x32_bf16 a[24:27], a[128:131], a[248:251], a[24:27]
    v_cmp_gt_u32 vcc, 2, v21
    s_cbranch_vccnz L_slow_f2
L_back_f2:
    v_mfma_f32_16x16x32_bf16 a[24:27], a[144:147], a[252:255], a[24:27]
    buffer_load_dwordx4 v10, s[24:27], s68 offen offset:0 sc1 lds
    v_mfma_f32_16x16x32_bf16 a[28:31], a[148:151], a[252:255], 0
    v_mfma_f32_16x16x32_bf16 a[28:31], a[132:135], a[248:251], a[28:31]
    s_add_u32 s68, s93, 32768
    v_mfma_f32_16x16x32_bf16 a[28:31], a[116:119], a[84:87], a[28:31]
    v_mfma_f32_16x16x32_bf16 a[28:31], a[100:103], a[80:83], a[28:31]
    s_waitcnt lgkmcnt(3)
    buffer_load_dwordx4 v10, s[24:27], s68 offen offset:2048 sc1 lds
    v_mfma_f32_16x16x32_bf16 v[204:207], a[100:103], a[64:67], 0
    s_waitcnt lgkmcnt(2)
    ds_read_b128 a[80:83], v7 offset:12288
    v_mfma_f32_16x16x32_bf16 v[204:207], a[116:119], a[68:71], v[204:207]
    s_waitcnt lgkmcnt(2)
    buffer_store_dwordx4 v[120:123], v18, s[20:23], s60 offen offset:0 sc1
    s_add_u32 m0, s0, 102400
    v_mfma_f32_16x16x32_bf16 v[204:207], a[132:135], a[72:75], v[204:207]
    s_waitcnt lgkmcnt(1)
    ds_read_b128 a[84:87], v7 offset:13312
    s_add_u32 s68, s92, 35840
    v_mfma_f32_16x16x32_bf16 v[204:207], a[148:151], a[76:79], v[204:207]
    v_mfma_f32_16x16x32_bf16 v[200:203], a[144:147], a[76:79], 0
    buffer_load_dwordx4 v10, s[24:27], s68 offen offset:0 sc1 lds
    v_mfma_f32_16x16x32_bf16 v[200:203], a[128:131], a[72:75], v[200:203]
    ds_read_b128 a[248:251], v7 offset:14336
    v_mfma_f32_16x16x32_bf16 v[200:203], a[112:115], a[68:71], v[200:203]
    ds_read_b128 a[252:255], v7 offset:15360
    v_mfma_f32_16x16x32_bf16 v[200:203], a[96:99], a[64:67], v[200:203]
    s_add_u32 s68, s93, 33792
    v_mfma_f32_16x16x32_bf16 v[196:199], a[92:95], a[64:67], 0
    v_mfma_f32_16x16x32_bf16 v[196:199], a[108:111], a[68:71], v[196:199]
    buffer_load_dwordx4 v10, s[24:27], s68 offen offset:2048 sc1 lds
    v_mfma_f32_16x16x32_bf16 v[196:199], a[124:127], a[72:75], v[196:199]
    s_add_u32 m0, s0, 106496
    v_mfma_f32_16x16x32_bf16 v[196:199], a[140:143], a[76:79], v[196:199]
    s_add_u32 s68, s92, 36864
    v_mfma_f32_16x16x32_bf16 v[192:195], a[136:139], a[76:79], 0
    buffer_store_dwordx4 v[124:127], v18, s[20:23], s60 offen offset:1024 sc1
    v_mfma_f32_16x16x32_bf16 v[192:195], a[120:123], a[72:75], v[192:195]
    buffer_load_dwordx4 v10, s[24:27], s68 offen offset:0 sc1 lds
    v_mfma_f32_16x16x32_bf16 v[192:195], a[104:107], a[68:71], v[192:195]
    s_waitcnt vmcnt(9) lgkmcnt(0)
    v_mfma_f32_16x16x32_bf16 v[192:195], a[88:91], a[64:67], v[192:195]
    s_barrier
    v_mfma_f32_16x16x32_bf16 v[208:211], a[88:91], a[80:83], 0
    ds_read_b128 a[64:67], v6 offset:0
    v_mfma_f32_16x16x32_bf16 v[208:211], a[104:107], a[84:87], v[208:211]
    s_add_u32 s68, s93, 34816
    ds_read_b64_tr_b16 v[112:113], v14 offset:8192
    v_mfma_f32_16x16x32_bf16 v[208:211], a[120:123], a[248:251], v[208:211]
    ds_read_b128 a[68:71], v6 offset:1024
    v_mfma_f32_16x16x32_bf16 v[208:211], a[136:139], a[252:255], v[208:211]
    buffer_load_dwordx4 v10, s[24:27], s68 offen offset:2048 sc1 lds
    s_add_u32 m0, s56, 4096
    v_mfma_f32_16x16x32_bf16 v[212:215], a[140:143], a[252:255], 0
    s_add_u32 s68, s75, 163840
    ds_read_b64_tr_b16 v[116:117], v15 offset:8192
    v_mfma_f32_16x16x32_bf16 v[212:215], a[124:127], a[248:251], v[212:215]
    ds_read_b128 a[72:75], v6 offset:2048
    v_mfma_f32_16x16x32_bf16 v[212:215], a[108:111], a[84:87], v[212:215]
    buffer_load_dwordx4 v13, s[16:19], s68 offen offset:0 lds
    v_mfma_f32_16x16x32_bf16 v[212:215], a[92:95], a[80:83], v[212:215]
    s_add_u32 m0, s0, 110592
    ds_read_b64_tr_b16 v[120:121], v16 offset:8192
    v_mfma_f32_16x16x32_bf16 v[216:219], a[96:99], a[80:83], 0
    s_add_u32 s68, s92, 37888
    ds_read_b128 a[76:79], v6 offset:3072
    v_mfma_f32_16x16x32_bf16 v[216:219], a[112:115], a[84:87], v[216:219]
    ds_read_b64_tr_b16 v[124:125], v17 offset:8192
    v_mfma_f32_16x16x32_bf16 v[216:219], a[128:131], a[248:251], v[216:219]
    buffer_load_dwordx4 v10, s[24:27], s68 offen offset:0 sc1 lds
    v_mfma_f32_16x16x32_bf16 v[216:219], a[144:147], a[252:255], v[216:219]
    ds_read_b64_tr_b16 v[114:115], v14 offset:10240
    v_mfma_f32_16x16x32_bf16 v[220:223], a[148:151], a[252:255], 0
    ds_read_b64_tr_b16 v[118:119], v15 offset:10240
    v_mfma_f32_16x16x32_bf16 v[220:223], a[132:135], a[248:251], v[220:223]
    ds_read_b64_tr_b16 v[122:123], v16 offset:10240
    v_mfma_f32_16x16x32_bf16 v[220:223], a[116:119], a[84:87], v[220:223]
    s_add_u32 s68, s93, 35840
    ds_read_b64_tr_b16 v[126:127], v17 offset:10240
    v_mfma_f32_16x16x32_bf16 v[220:223], a[100:103], a[80:83], v[220:223]
    s_waitcnt lgkmcnt(11)
    v_mfma_f32_16x16x32_bf16 a[44:47], a[100:103], a[64:67], 0
    s_waitcnt lgkmcnt(9)
    buffer_load_dwordx4 v10, s[24:27], s68 offen offset:2048 sc1 lds
    v_mfma_f32_16x16x32_bf16 a[44:47], a[116:119], a[68:71], a[44:47]
    s_waitcnt lgkmcnt(7)
    ds_read_b128 a[80:83], v6 offset:4096
    s_add_u32 m0, s0, 131072
    v_mfma_f32_16x16x32_bf16 a[44:47], a[132:135], a[72:75], a[44:47]
    s_waitcnt lgkmcnt(6)
    ds_read_b128 a[84:87], v6 offset:5120
    s_add_u32 s68, s92, 38912
    v_mfma_f32_16x16x32_bf16 a[44:47], a[148:151], a[76:79], a[44:47]
    v_mfma_f32_16x16x32_bf16 a[40:43], a[144:147], a[76:79], 0
    buffer_load_dwordx4 v10, s[24:27], s68 offen offset:0 sc1 lds
    v_mfma_f32_16x16x32_bf16 a[40:43], a[128:131], a[72:75], a[40:43]
    ds_read_b128 a[248:251], v6 offset:6144
    v_mfma_f32_16x16x32_bf16 a[40:43], a[112:115], a[68:71], a[40:43]
    s_add_u32 s68, s93, 36864
    ds_read_b128 a[252:255], v6 offset:7168
    v_mfma_f32_16x16x32_bf16 a[40:43], a[96:99], a[64:67], a[40:43]
    v_mfma_f32_16x16x32_bf16 a[36:39], a[92:95], a[64:67], 0
    buffer_load_dwordx4 v10, s[24:27], s68 offen offset:2048 sc1 lds
    v_mfma_f32_16x16x32_bf16 a[36:39], a[108:111], a[68:71], a[36:39]
    s_add_u32 m0, s0, 135168
    v_mfma_f32_16x16x32_bf16 a[36:39], a[124:127], a[72:75], a[36:39]
    s_add_u32 s68, s92, 39936
    v_mfma_f32_16x16x32_bf16 a[36:39], a[140:143], a[76:79], a[36:39]
    v_mfma_f32_16x16x32_bf16 a[32:35], a[136:139], a[76:79], 0
    buffer_load_dwordx4 v10, s[24:27], s68 offen offset:0 sc1 lds
    v_mfma_f32_16x16x32_bf16 a[32:35], a[120:123], a[72:75], a[32:35]
    v_mfma_f32_16x16x32_bf16 a[32:35], a[104:107], a[68:71], a[32:35]
    s_add_u32 s68, s93, 37888
    v_mfma_f32_16x16x32_bf16 a[32:35], a[88:91], a[64:67], a[32:35]
    s_waitcnt lgkmcnt(3)
    v_mfma_f32_16x16x32_bf16 a[48:51], a[88:91], a[80:83], 0
    s_waitcnt lgkmcnt(2)
    buffer_load_dwordx4 v10, s[24:27], s68 offen offset:2048 sc1 lds
    v_mfma_f32_16x16x32_bf16 a[48:51], a[104:107], a[84:87], a[48:51]
    s_waitcnt lgkmcnt(1)
    ds_read_b128 a[64:67], v6 offset:8192
    s_add_u32 m0, s0, 139264
    v_mfma_f32_16x16x32_bf16 a[48:51], a[120:123], a[248:251], a[48:51]
    s_waitcnt lgkmcnt(1)
    ds_read_b128 a[68:71], v6 offset:9216
    s_add_u32 s68, s92, 40960
    v_mfma_f32_16x16x32_bf16 a[48:51], a[136:139], a[252:255], a[48:51]
    v_mfma_f32_16x16x32_bf16 a[52:55], a[140:143], a[252:255], 0
    buffer_load_dwordx4 v10, s[24:27], s68 offen offset:0 sc1 lds
    v_mfma_f32_16x16x32_bf16 a[52:55], a[124:127], a[248:251], a[52:55]
    ds_read_b128 a[72:75], v6 offset:10240
    v_mfma_f32_16x16x32_bf16 a[52:55], a[108:111], a[84:87], a[52:55]
    ds_read_b128 a[76:79], v6 offset:11264
    v_mfma_f32_16x16x32_bf16 a[52:55], a[92:95], a[80:83], a[52:55]
    s_add_u32 s68, s93, 38912
    v_mfma_f32_16x16x32_bf16 a[56:59], a[96:99], a[80:83], 0
    v_mfma_f32_16x16x32_bf16 a[56:59], a[112:115], a[84:87], a[56:59]
    buffer_load_dwordx4 v10, s[24:27], s68 offen offset:2048 sc1 lds
    s_add_u32 m0, s56, 4096
    v_mfma_f32_16x16x32_bf16 a[56:59], a[128:131], a[248:251], a[56:59]
    s_add_u32 s68, s75, 179200
    v_mfma_f32_16x16x32_bf16 a[56:59], a[144:147], a[252:255], a[56:59]
    v_mfma_f32_16x16x32_bf16 a[60:63], a[148:151], a[252:255], 0
    buffer_load_dwordx4 v13, s[16:19], s68 offen offset:1024 lds
    v_mfma_f32_16x16x32_bf16 a[60:63], a[132:135], a[248:251], a[60:63]
    v_mfma_f32_16x16x32_bf16 a[60:63], a[116:119], a[84:87], a[60:63]
    s_add_u32 m0, s0, 143360
    v_mfma_f32_16x16x32_bf16 a[60:63], a[100:103], a[80:83], a[60:63]
    s_waitcnt lgkmcnt(3)
    s_add_u32 s68, s92, 41984
    v_mfma_f32_16x16x32_bf16 v[236:239], a[100:103], a[64:67], 0
    s_waitcnt lgkmcnt(2)
    ds_read_b128 a[80:83], v6 offset:12288
    v_mfma_f32_16x16x32_bf16 v[236:239], a[116:119], a[68:71], v[236:239]
    s_waitcnt lgkmcnt(2)
    buffer_load_dwordx4 v10, s[24:27], s68 offen offset:0 sc1 lds
    v_mfma_f32_16x16x32_bf16 v[236:239], a[132:135], a[72:75], v[236:239]
    s_waitcnt lgkmcnt(1)
    ds_read_b128 a[84:87], v6 offset:13312
    s_add_u32 m0, s56, 4096
    v_mfma_f32_16x16x32_bf16 v[236:239], a[148:151], a[76:79], v[236:239]
    s_add_u32 s68, s75, 194560
    v_mfma_f32_16x16x32_bf16 v[232:235], a[144:147], a[76:79], 0
    ds_read_b128 a[248:251], v6 offset:14336
    v_mfma_f32_16x16x32_bf16 v[232:235], a[128:131], a[72:75], v[232:235]
    buffer_load_dwordx4 v13, s[16:19], s68 offen offset:2048 lds
    v_mfma_f32_16x16x32_bf16 v[232:235], a[112:115], a[68:71], v[232:235]
    s_add_u32 m0, s0, 143360
    ds_read_b128 a[252:255], v6 offset:15360
    v_mfma_f32_16x16x32_bf16 v[232:235], a[96:99], a[64:67], v[232:235]
    s_add_u32 s68, s93, 39936
    v_mfma_f32_16x16x32_bf16 v[228:231], a[92:95], a[64:67], 0
    v_mfma_f32_16x16x32_bf16 v[228:231], a[108:111], a[68:71], v[228:231]
    buffer_load_dwordx4 v10, s[24:27], s68 offen offset:2048 sc1 lds
    v_mfma_f32_16x16x32_bf16 v[228:231], a[124:127], a[72:75], v[228:231]
    v_mfma_f32_16x16x32_bf16 v[228:231], a[140:143], a[76:79], v[228:231]
    s_add_u32 m0, s56, 4096
    v_mfma_f32_16x16x32_bf16 v[224:227], a[136:139], a[76:79], 0
    s_add_u32 s68, s75, 209920
    v_mfma_f32_16x16x32_bf16 v[224:227], a[120:123], a[72:75], v[224:227]
    v_mfma_f32_16x16x32_bf16 v[224:227], a[104:107], a[68:71], v[224:227]
    s_waitcnt vmcnt(10) lgkmcnt(0)
    buffer_load_dwordx4 v13, s[16:19], s68 offen offset:3072 lds
    s_add_u32 m0, s0, 65536
    v_mfma_f32_16x16x32_bf16 v[224:227], a[88:91], a[64:67], v[224:227]
    s_barrier
    s_add_u32 s68, s92, 67584
    v_mfma_f32_16x16x32_bf16 v[240:243], a[88:91], a[80:83], 0
    ds_read_b128 a[64:67], v6 offset:32768
    v_mfma_f32_16x16x32_bf16 v[240:243], a[104:107], a[84:87], v[240:243]
    buffer_load_dwordx4 v10, s[24:27], s68 offen offset:0 sc1 lds
    v_mfma_f32_16x16x32_bf16 v[240:243], a[120:123], a[248:251], v[240:243]
    ds_read_b128 a[68:71], v6 offset:33792
    v_mfma_f32_16x16x32_bf16 v[240:243], a[136:139], a[252:255], v[240:243]
    v_mfma_f32_16x16x32_bf16 v[244:247], a[140:143], a[252:255], 0
    ds_read_b128 a[72:75], v6 offset:34816
    v_mfma_f32_16x16x32_bf16 v[244:247], a[124:127], a[248:251], v[244:247]
    v_mfma_f32_16x16x32_bf16 v[244:247], a[108:111], a[84:87], v[244:247]
    ds_read_b128 a[76:79], v6 offset:35840
    v_mfma_f32_16x16x32_bf16 v[244:247], a[92:95], a[80:83], v[244:247]
    s_add_u32 s68, s93, 65536
    v_mfma_f32_16x16x32_bf16 v[248:251], a[96:99], a[80:83], 0
    v_mfma_f32_16x16x32_bf16 v[248:251], a[112:115], a[84:87], v[248:251]
    buffer_load_dwordx4 v10, s[24:27], s68 offen offset:2048 sc1 lds
    s_add_u32 m0, s56, 12288
    v_mfma_f32_16x16x32_bf16 v[248:251], a[128:131], a[248:251], v[248:251]
    s_add_u32 s68, s76, 163840
    v_mfma_f32_16x16x32_bf16 v[248:251], a[144:147], a[252:255], v[248:251]
    v_mfma_f32_16x16x32_bf16 v[252:255], a[148:151], a[252:255], 0
    buffer_load_dwordx4 v13, s[16:19], s68 offen offset:0 lds
    v_mov_b32 v2, 4
    v_mfma_f32_16x16x32_bf16 v[252:255], a[132:135], a[248:251], v[252:255]
    v_mfma_f32_16x16x32_bf16 v[252:255], a[116:119], a[84:87], v[252:255]
    s_add_u32 m0, s0, 69632
    s_mov_b64 exec, 1
    buffer_store_dword v2, off, s[32:35], s63 sc1
    s_mov_b64 exec, -1
    v_mfma_f32_16x16x32_bf16 v[252:255], a[100:103], a[80:83], v[252:255]
    s_waitcnt lgkmcnt(3)
    s_add_u32 s68, s92, 68608
    v_mfma_f32_16x16x32_bf16 a[12:15], a[164:167], a[64:67], a[12:15]
    s_waitcnt lgkmcnt(2)
    ds_read_b128 a[80:83], v6 offset:36864
    v_mfma_f32_16x16x32_bf16 a[12:15], a[180:183], a[68:71], a[12:15]
    s_waitcnt lgkmcnt(2)
    buffer_load_dwordx4 v10, s[24:27], s68 offen offset:0 sc1 lds
    v_mfma_f32_16x16x32_bf16 a[12:15], a[196:199], a[72:75], a[12:15]
    s_waitcnt lgkmcnt(1)
    ds_read_b64_tr_b16 a[88:89], v14 offset:0
    s_add_u32 m0, s56, 12288
    v_mfma_f32_16x16x32_bf16 a[12:15], a[212:215], a[76:79], a[12:15]
    s_add_u32 s68, s76, 179200
    ds_read_b128 a[84:87], v6 offset:37888
    v_mfma_f32_16x16x32_bf16 a[8:11], a[208:211], a[76:79], a[8:11]
    ds_read_b64_tr_b16 a[92:93], v15 offset:0
    v_mfma_f32_16x16x32_bf16 a[8:11], a[192:195], a[72:75], a[8:11]
    buffer_load_dwordx4 v13, s[16:19], s68 offen offset:1024 lds
    v_mfma_f32_16x16x32_bf16 a[8:11], a[176:179], a[68:71], a[8:11]
    s_add_u32 m0, s0, 69632
    ds_read_b128 a[248:251], v6 offset:38912
    v_mfma_f32_16x16x32_bf16 a[8:11], a[160:163], a[64:67], a[8:11]
    s_add_u32 s68, s93, 66560
    ds_read_b64_tr_b16 a[96:97], v16 offset:0
    v_mfma_f32_16x16x32_bf16 a[4:7], a[156:159], a[64:67], a[4:7]
    ds_read_b128 a[252:255], v6 offset:39936
    v_mfma_f32_16x16x32_bf16 a[4:7], a[172:175], a[68:71], a[4:7]
    ds_read_b64_tr_b16 a[100:101], v17 offset:0
    v_mfma_f32_16x16x32_bf16 a[4:7], a[188:191], a[72:75], a[4:7]
    buffer_load_dwordx4 v10, s[24:27], s68 offen offset:2048 sc1 lds
    v_mfma_f32_16x16x32_bf16 a[4:7], a[204:207], a[76:79], a[4:7]
    s_add_u32 m0, s56, 12288
    ds_read_b64_tr_b16 a[90:91], v14 offset:2048
    v_mfma_f32_16x16x32_bf16 a[0:3], a[200:203], a[76:79], a[0:3]
    s_add_u32 s68, s76, 194560
    ds_read_b64_tr_b16 a[94:95], v15 offset:2048
    v_mfma_f32_16x16x32_bf16 a[0:3], a[184:187], a[72:75], a[0:3]
    ds_read_b64_tr_b16 a[98:99], v16 offset:2048
    v_mfma_f32_16x16x32_bf16 a[0:3], a[168:171], a[68:71], a[0:3]
    buffer_load_dwordx4 v13, s[16:19], s68 offen offset:2048 lds
    s_add_u32 m0, s0, 73728
    v_mfma_f32_16x16x32_bf16 a[0:3], a[152:155], a[64:67], a[0:3]
    s_waitcnt lgkmcnt(10)
    ds_read_b64_tr_b16 a[102:103], v17 offset:2048
    s_add_u32 s68, s92, 69632
    v_mfma_f32_16x16x32_bf16 a[16:19], a[152:155], a[80:83], a[16:19]
    s_waitcnt lgkmcnt(9)
    ds_read_b128 a[64:67], v6 offset:40960
    v_mfma_f32_16x16x32_bf16 a[16:19], a[168:171], a[84:87], a[16:19]
    s_waitcnt lgkmcnt(8)
    buffer_load_dwordx4 v10, s[24:27], s68 offen offset:0 sc1 lds
    s_waitcnt vmcnt(13)
    v_mfma_f32_16x16x32_bf16 a[16:19], a[184:187], a[248:251], a[16:19]
    s_waitcnt lgkmcnt(6)
    ds_read_b128 a[68:71], v6 offset:41984
    v_mfma_f32_16x16x32_bf16 a[16:19], a[200:203], a[252:255], a[16:19]
    ds_read_b64_tr_b16 a[104:105], v14 offset:4096
    v_mfma_f32_16x16x32_bf16 a[20:23], a[204:207], a[252:255], a[20:23]
    ds_read_b128 a[72:75], v6 offset:43008
    v_mfma_f32_16x16x32_bf16 a[20:23], a[188:191], a[248:251], a[20:23]
    ds_read_b64_tr_b16 a[108:109], v15 offset:4096
    v_mfma_f32_16x16x32_bf16 a[20:23], a[172:175], a[84:87], a[20:23]
    ds_read_b128 a[76:79], v6 offset:44032
    v_mfma_f32_16x16x32_bf16 a[20:23], a[156:159], a[80:83], a[20:23]
    s_add_u32 s68, s93, 67584
    ds_read_b64_tr_b16 a[112:113], v16 offset:4096
    v_mfma_f32_16x16x32_bf16 a[24:27], a[160:163], a[80:83], a[24:27]
    ds_read_b64_tr_b16 a[116:117], v17 offset:4096
    v_mfma_f32_16x16x32_bf16 a[24:27], a[176:179], a[84:87], a[24:27]
    s_waitcnt vmcnt(9)
    buffer_load_dwordx4 v10, s[24:27], s68 offen offset:2048 sc1 lds
    s_add_u32 m0, s56, 12288
    v_mfma_f32_16x16x32_bf16 a[24:27], a[192:195], a[248:251], a[24:27]
    s_add_u32 s68, s76, 209920
    ds_read_b64_tr_b16 a[106:107], v14 offset:6144
    v_mfma_f32_16x16x32_bf16 a[24:27], a[208:211], a[252:255], a[24:27]
    v_mfma_f32_16x16x32_bf16 a[28:31], a[212:215], a[252:255], a[28:31]
    buffer_load_dwordx4 v13, s[16:19], s68 offen offset:3072 lds
    v_mfma_f32_16x16x32_bf16 a[28:31], a[196:199], a[248:251], a[28:31]
    ds_read_b64_tr_b16 a[110:111], v15 offset:6144
    v_mfma_f32_16x16x32_bf16 a[28:31], a[180:183], a[84:87], a[28:31]
    s_add_u32 m0, s0, 77824
    ds_read_b64_tr_b16 a[114:115], v16 offset:6144
    v_mfma_f32_16x16x32_bf16 a[28:31], a[164:167], a[80:83], a[28:31]
    s_waitcnt lgkmcnt(10)
    s_add_u32 s68, s92, 70656
    v_mfma_f32_16x16x32_bf16 v[204:207], a[164:167], a[64:67], v[204:207]
    s_waitcnt lgkmcnt(9)
    ds_read_b128 a[80:83], v6 offset:45056
    v_mfma_f32_16x16x32_bf16 v[204:207], a[180:183], a[68:71], v[204:207]
    s_waitcnt lgkmcnt(8)
    buffer_load_dwordx4 v10, s[24:27], s68 offen offset:0 sc1 lds
    v_mfma_f32_16x16x32_bf16 v[204:207], a[196:199], a[72:75], v[204:207]
    s_waitcnt lgkmcnt(6)
    ds_read_b64_tr_b16 a[118:119], v17 offset:6144
    s_add_u32 m0, s56, 8192
    v_mfma_f32_16x16x32_bf16 v[204:207], a[212:215], a[76:79], v[204:207]
    s_add_u32 s68, s77, 163840
    ds_read_b128 a[84:87], v6 offset:46080
    v_mfma_f32_16x16x32_bf16 v[200:203], a[208:211], a[76:79], v[200:203]
    ds_read_b128 a[248:251], v6 offset:47104
    v_mfma_f32_16x16x32_bf16 v[200:203], a[192:195], a[72:75], v[200:203]
    buffer_load_dwordx4 v13, s[16:19], s68 offen offset:0 lds
    v_mfma_f32_16x16x32_bf16 v[200:203], a[176:179], a[68:71], v[200:203]
    s_add_u32 m0, s0, 77824
    ds_read_b128 a[252:255], v6 offset:48128
    v_mfma_f32_16x16x32_bf16 v[200:203], a[160:163], a[64:67], v[200:203]
    s_add_u32 s68, s93, 68608
    v_mfma_f32_16x16x32_bf16 v[196:199], a[156:159], a[64:67], v[196:199]
    v_mfma_f32_16x16x32_bf16 v[196:199], a[172:175], a[68:71], v[196:199]
    buffer_load_dwordx4 v10, s[24:27], s68 offen offset:2048 sc1 lds
    v_mfma_f32_16x16x32_bf16 v[196:199], a[188:191], a[72:75], v[196:199]
    v_mfma_f32_16x16x32_bf16 v[196:199], a[204:207], a[76:79], v[196:199]
    s_add_u32 m0, s56, 8192
    v_mfma_f32_16x16x32_bf16 v[192:195], a[200:203], a[76:79], v[192:195]
    s_add_u32 s68, s77, 179200
    v_mfma_f32_16x16x32_bf16 v[192:195], a[184:187], a[72:75], v[192:195]
    v_mfma_f32_16x16x32_bf16 v[192:195], a[168:171], a[68:71], v[192:195]
    s_waitcnt lgkmcnt(0)
    buffer_load_dwordx4 v13, s[16:19], s68 offen offset:1024 lds
    s_add_u32 m0, s0, 98304
    v_mfma_f32_16x16x32_bf16 v[192:195], a[152:155], a[64:67], v[192:195]
    s_barrier
    s_add_u32 s68, s92, 71680
    v_mfma_f32_16x16x32_bf16 v[208:211], a[152:155], a[80:83], v[208:211]
L_pad9:
    s_cbranch_vccnz L_warm
    ds_read_b128 a[64:67], v7 offset:0
    v_mfma_f32_16x16x32_bf16 v[208:211], a[168:171], a[84:87], v[208:211]
    buffer_load_dwordx4 v10, s[24:27], s68 offen offset:0 sc1 lds
    v_mfma_f32_16x16x32_bf16 v[208:211], a[184:187], a[248:251], v[208:211]
    ds_read_b128 a[68:71], v7 offset:1024
    v_mfma_f32_16x16x32_bf16 v[208:211], a[200:203], a[252:255], v[208:211]
    v_mfma_f32_16x16x32_bf16 v[212:215], a[204:207], a[252:255], v[212:215]
    ds_read_b128 a[72:75], v7 offset:2048
    v_mfma_f32_16x16x32_bf16 v[212:215], a[188:191], a[248:251], v[212:215]
    v_mfma_f32_16x16x32_bf16 v[212:215], a[172:175], a[84:87], v[212:215]
    ds_read_b128 a[76:79], v7 offset:3072
    v_mfma_f32_16x16x32_bf16 v[212:215], a[156:159], a[80:83], v[212:215]
    s_add_u32 s68, s93, 69632
    v_mfma_f32_16x16x32_bf16 v[216:219], a[160:163], a[80:83], v[216:219]
    v_mfma_f32_16x16x32_bf16 v[216:219], a[176:179], a[84:87], v[216:219]
    buffer_load_dwordx4 v10, s[24:27], s68 offen offset:2048 sc1 lds
    s_add_u32 m0, s56, 8192
    v_mfma_f32_16x16x32_bf16 v[216:219], a[192:195], a[248:251], v[216:219]
    s_add_u32 s68, s77, 194560
    v_mfma_f32_16x16x32_bf16 v[216:219], a[208:211], a[252:255], v[216:219]
    v_mfma_f32_16x16x32_bf16 v[220:223], a[212:215], a[252:255], v[220:223]
    buffer_load_dwordx4 v13, s[16:19], s68 offen offset:2048 lds
    v_mfma_f32_16x16x32_bf16 v[220:223], a[196:199], a[248:251], v[220:223]
    v_mfma_f32_16x16x32_bf16 v[220:223], a[180:183], a[84:87], v[220:223]
    s_add_u32 m0, s0, 102400
    v_mfma_f32_16x16x32_bf16 v[220:223], a[164:167], a[80:83], v[220:223]
    s_waitcnt lgkmcnt(3)
    s_waitcnt vmcnt(12)
    s_add_u32 s68, s92, 72704
    v_mfma_f32_16x16x32_bf16 a[44:47], a[164:167], a[64:67], a[44:47]
    s_waitcnt lgkmcnt(2)
    ds_read_b128 a[80:83], v7 offset:4096
    v_mfma_f32_16x16x32_bf16 a[44:47], a[180:183], a[68:71], a[44:47]
    s_waitcnt lgkmcnt(2)
    buffer_load_dwordx4 v10, s[24:27], s68 offen offset:0 sc1 lds
    v_mfma_f32_16x16x32_bf16 a[44:47], a[196:199], a[72:75], a[44:47]
    s_waitcnt lgkmcnt(1)
    ds_read_b64_tr_b16 a[120:121], v14 offset:12288
    s_add_u32 m0, s56, 8192
    v_mfma_f32_16x16x32_bf16 a[44:47], a[212:215], a[76:79], a[44:47]
    s_add_u32 s68, s77, 209920
    ds_read_b128 a[84:87], v7 offset:5120
    v_mfma_f32_16x16x32_bf16 a[40:43], a[208:211], a[76:79], a[40:43]
    ds_read_b64_tr_b16 a[124:125], v15 offset:12288
    v_mfma_f32_16x16x32_bf16 a[40:43], a[192:195], a[72:75], a[40:43]
    buffer_load_dwordx4 v13, s[16:19], s68 offen offset:3072 lds
    v_mfma_f32_16x16x32_bf16 a[40:43], a[176:179], a[68:71], a[40:43]
    s_add_u32 m0, s0, 102400
    ds_read_b128 a[248:251], v7 offset:6144
    v_mfma_f32_16x16x32_bf16 a[40:43], a[160:163], a[64:67], a[40:43]
    s_waitcnt vmcnt(9)
    ds_read_b64_tr_b16 a[128:129], v16 offset:12288
    s_add_u32 s68, s93, 70656
    v_mfma_f32_16x16x32_bf16 a[36:39], a[156:159], a[64:67], a[36:39]
    ds_read_b128 a[252:255], v7 offset:7168
    v_mfma_f32_16x16x32_bf16 a[36:39], a[172:175], a[68:71], a[36:39]
    buffer_load_dword v21, v20, s[32:35], s64 offen sc1
    v_mfma_f32_16x16x32_bf16 a[36:39], a[188:191], a[72:75], a[36:39]
    ds_read_b64_tr_b16 a[132:133], v17 offset:12288
    v_mfma_f32_16x16x32_bf16 a[36:39], a[204:207], a[76:79], a[36:39]
    buffer_load_dwordx4 v10, s[24:27], s68 offen offset:2048 sc1 lds
    s_mov_b32 m0, s56
    v_mfma_f32_16x16x32_bf16 a[32:35], a[200:203], a[76:79], a[32:35]
    s_add_u32 s68, s74, 1081344
    ds_read_b64_tr_b16 a[122:123], v14 offset:14336
    v_mfma_f32_16x16x32_bf16 a[32:35], a[184:187], a[72:75], a[32:35]
    ds_read_b64_tr_b16 a[126:127], v15 offset:14336
    v_mfma_f32_16x16x32_bf16 a[32:35], a[168:171], a[68:71], a[32:35]
    buffer_load_dwordx4 v13, s[16:19], s68 offen offset:0 lds
    s_add_u32 m0, s0, 106496
    v_mfma_f32_16x16x32_bf16 a[32:35], a[152:155], a[64:67], a[32:35]
    s_waitcnt lgkmcnt(9)
    ds_read_b64_tr_b16 a[130:131], v16 offset:14336
    s_add_u32 s68, s92, 73728
    v_mfma_f32_16x16x32_bf16 a[48:51], a[152:155], a[80:83], a[48:51]
    s_waitcnt lgkmcnt(8)
    ds_read_b64_tr_b16 a[134:135], v17 offset:14336
    v_mfma_f32_16x16x32_bf16 a[48:51], a[168:171], a[84:87], a[48:51]
    s_waitcnt lgkmcnt(7)
    buffer_load_dwordx4 v10, s[24:27], s68 offen offset:0 sc1 lds
    v_mfma_f32_16x16x32_bf16 a[48:51], a[184:187], a[248:251], a[48:51]
    s_waitcnt lgkmcnt(5)
    ds_read_b128 a[64:67], v7 offset:8192
    v_mfma_f32_16x16x32_bf16 a[48:51], a[200:203], a[252:255], a[48:51]
    ds_read_b128 a[68:71], v7 offset:9216
    v_mfma_f32_16x16x32_bf16 a[52:55], a[204:207], a[252:255], a[52:55]
    ds_read_b128 a[72:75], v7 offset:10240
    v_mfma_f32_16x16x32_bf16 a[52:55], a[188:191], a[248:251], a[52:55]
    v_mfma_f32_16x16x32_bf16 a[52:55], a[172:175], a[84:87], a[52:55]
    ds_read_b128 a[76:79], v7 offset:11264
    v_mfma_f32_16x16x32_bf16 a[52:55], a[156:159], a[80:83], a[52:55]
    s_add_u32 s68, s93, 71680
    v_mfma_f32_16x16x32_bf16 a[56:59], a[160:163], a[80:83], a[56:59]
    v_mfma_f32_16x16x32_bf16 a[56:59], a[176:179], a[84:87], a[56:59]
    buffer_load_dwordx4 v10, s[24:27], s68 offen offset:2048 sc1 lds
    s_mov_b32 m0, s56
    v_mfma_f32_16x16x32_bf16 a[56:59], a[192:195], a[248:251], a[56:59]
    s_add_u32 s68, s74, 1096704
    v_mfma_f32_16x16x32_bf16 a[56:59], a[208:211], a[252:255], a[56:59]
    v_mfma_f32_16x16x32_bf16 a[60:63], a[212:215], a[252:255], a[60:63]
    buffer_load_dwordx4 v13, s[16:19], s68 offen offset:1024 lds
    v_mfma_f32_16x16x32_bf16 a[60:63], a[196:199], a[248:251], a[60:63]
    v_mfma_f32_16x16x32_bf16 a[60:63], a[180:183], a[84:87], a[60:63]
    s_add_u32 m0, s0, 110592
    v_mfma_f32_16x16x32_bf16 a[60:63], a[164:167], a[80:83], a[60:63]
    s_waitcnt lgkmcnt(3)
    s_add_u32 s68, s92, 74752
    v_mfma_f32_16x16x32_bf16 v[236:239], a[164:167], a[64:67], v[236:239]
    s_waitcnt lgkmcnt(2)
    ds_read_b128 a[80:83], v7 offset:12288
    v_mfma_f32_16x16x32_bf16 v[236:239], a[180:183], a[68:71], v[236:239]
    s_waitcnt lgkmcnt(2)
    buffer_load_dwordx4 v10, s[24:27], s68 offen offset:0 sc1 lds
    v_mfma_f32_16x16x32_bf16 v[236:239], a[196:199], a[72:75], v[236:239]
    s_waitcnt lgkmcnt(1)
    ds_read_b128 a[84:87], v7 offset:13312
    s_mov_b32 m0, s56
    v_mfma_f32_16x16x32_bf16 v[236:239], a[212:215], a[76:79], v[236:239]
    s_add_u32 s68, s74, 1112064
    v_mfma_f32_16x16x32_bf16 v[232:235], a[208:211], a[76:79], v[232:235]
    ds_read_b128 a[248:251], v7 offset:14336
    v_mfma_f32_16x16x32_bf16 v[232:235], a[192:195], a[72:75], v[232:235]
    buffer_load_dwordx4 v13, s[16:19], s68 offen offset:2048 lds
    v_mfma_f32_16x16x32_bf16 v[232:235], a[176:179], a[68:71], v[232:235]
    s_add_u32 m0, s0, 110592
    ds_read_b128 a[252:255], v7 offset:15360
    v_mfma_f32_16x16x32_bf16 v[232:235], a[160:163], a[64:67], v[232:235]
    s_add_u32 s68, s93, 72704
    v_mfma_f32_16x16x32_bf16 v[228:231], a[156:159], a[64:67], v[228:231]
    s_waitcnt vmcnt(13)
    v_mfma_f32_16x16x32_bf16 v[228:231], a[172:175], a[68:71], v[228:231]
    buffer_load_dwordx4 v10, s[24:27], s68 offen offset:2048 sc1 lds
    v_mfma_f32_16x16x32_bf16 v[228:231], a[188:191], a[72:75], v[228:231]
    ds_read_b64_tr_b16 a[136:137], v14 offset:8192
    v_mfma_f32_16x16x32_bf16 v[228:231], a[204:207], a[76:79], v[228:231]
    s_mov_b32 m0, s56
    ds_read_b64_tr_b16 a[140:141], v15 offset:8192
    v_mfma_f32_16x16x32_bf16 v[224:227], a[200:203], a[76:79], v[224:227]
    s_add_u32 s68, s74, 1127424
    v_mfma_f32_16x16x32_bf16 v[224:227], a[184:187], a[72:75], v[224:227]
    ds_read_b64_tr_b16 a[144:145], v16 offset:8192
    v_mfma_f32_16x16x32_bf16 v[224:227], a[168:171], a[68:71], v[224:227]
    s_waitcnt lgkmcnt(3)
    buffer_load_dwordx4 v13, s[16:19], s68 offen offset:3072 lds
    s_add_u32 m0, s0, 131072
    v_mfma_f32_16x16x32_bf16 v[224:227], a[152:155], a[64:67], v[224:227]
    s_barrier
    ds_read_b64_tr_b16 a[148:149], v17 offset:8192
    s_waitcnt vmcnt(9)
    v_mfma_f32_16x16x32_bf16 v[240:243], a[152:155], a[80:83], v[240:243]
    s_add_u32 s68, s92, 100352
    v_cmp_gt_u32 vcc, 4, v21
    s_cbranch_vccnz L_slow_f4
L_back_f4:
    v_mfma_f32_16x16x32_bf16 v[240:243], a[168:171], a[84:87], v[240:243]
    buffer_load_dwordx4 v10, s[24:27], s68 offen offset:0 sc1 lds
    v_mfma_f32_16x16x32_bf16 v[240:243], a[184:187], a[248:251], v[240:243]
    ds_read_b128 a[64:67], v6 offset:0
    v_mfma_f32_16x16x32_bf16 v[240:243], a[200:203], a[252:255], v[240:243]
    ds_read_b128 a[68:71], v6 offset:1024
    v_mfma_f32_16x16x32_bf16 v[244:247], a[204:207], a[252:255], v[244:247]
    ds_read_b64_tr_b16 a[138:139], v14 offset:10240
    v_mfma_f32_16x16x32_bf16 v[244:247], a[188:191], a[248:251], v[244:247]
    ds_read_b128 a[72:75], v6 offset:2048
    v_mfma_f32_16x16x32_bf16 v[244:247], a[172:175], a[84:87], v[244:247]
    ds_read_b64_tr_b16 a[142:143], v15 offset:10240
    v_mfma_f32_16x16x32_bf16 v[244:247], a[156:159], a[80:83], v[244:247]
    s_add_u32 s68, s93, 98304
    ds_read_b128 a[76:79], v6 offset:3072
    v_mfma_f32_16x16x32_bf16 v[248:251], a[160:163], a[80:83], v[248:251]
    ds_read_b64_tr_b16 a[146:147], v16 offset:10240
    v_mfma_f32_16x16x32_bf16 v[248:251], a[176:179], a[84:87], v[248:251]
    buffer_load_dwordx4 v10, s[24:27], s68 offen offset:2048 sc1 lds
    s_add_u32 m0, s56, 4096
    v_mfma_f32_16x16x32_bf16 v[248:251], a[192:195], a[248:251], v[248:251]
    s_add_u32 s68, s75, 1081344
    ds_read_b64_tr_b16 a[150:151], v17 offset:10240
    v_mfma_f32_16x16x32_bf16 v[248:251], a[208:211], a[252:255], v[248:251]
    v_mfma_f32_16x16x32_bf16 v[252:255], a[212:215], a[252:255], v[252:255]
    buffer_load_dwordx4 v13, s[16:19], s68 offen offset:0 lds
    v_mfma_f32_16x16x32_bf16 v[252:255], a[196:199], a[248:251], v[252:255]
    v_mfma_f32_16x16x32_bf16 v[252:255], a[180:183], a[84:87], v[252:255]
    s_add_u32 m0, s0, 135168
    v_mfma_f32_16x16x32_bf16 v[252:255], a[164:167], a[80:83], v[252:255]
    s_waitcnt lgkmcnt(7)
    s_add_u32 s68, s92, 133120
    v_mfma_f32_16x16x32_bf16 a[12:15], a[228:231], a[64:67], a[12:15]
    s_waitcnt lgkmcnt(6)
    ds_read_b128 a[80:83], v6 offset:4096
    v_mfma_f32_16x16x32_bf16 a[12:15], a[244:247], a[68:71], a[12:15]
    s_waitcnt lgkmcnt(5)
    buffer_load_dwordx4 v10, s[24:27], s68 offen offset:0 sc1 lds
    v_mfma_f32_16x16x32_bf16 a[12:15], v[60:63], a[72:75], a[12:15]
    s_waitcnt lgkmcnt(3)
    ds_read_b128 a[84:87], v6 offset:5120
    s_add_u32 m0, s56, 4096
    v_mfma_f32_16x16x32_bf16 a[12:15], v[44:47], a[76:79], a[12:15]
    s_add_u32 s68, s75, 1096704
    v_mfma_f32_16x16x32_bf16 a[8:11], v[40:43], a[76:79], a[8:11]
    ds_read_b128 a[248:251], v6 offset:6144
    v_mfma_f32_16x16x32_bf16 a[8:11], v[56:59], a[72:75], a[8:11]
    buffer_load_dwordx4 v13, s[16:19], s68 offen offset:1024 lds
    v_mfma_f32_16x16x32_bf16 a[8:11], a[240:243], a[68:71], a[8:11]
    s_add_u32 m0, s0, 135168
    ds_read_b128 a[252:255], v6 offset:7168
    v_mfma_f32_16x16x32_bf16 a[8:11], a[224:227], a[64:67], a[8:11]
    s_add_u32 s68, s93, 131072
    v_mfma_f32_16x16x32_bf16 a[4:7], a[220:223], a[64:67], a[4:7]
    v_mfma_f32_16x16x32_bf16 a[4:7], a[236:239], a[68:71], a[4:7]
    buffer_load_dwordx4 v10, s[24:27], s68 offen offset:2048 sc1 lds
    v_mfma_f32_16x16x32_bf16 a[4:7], v[52:55], a[72:75], a[4:7]
    v_mfma_f32_16x16x32_bf16 a[4:7], v[36:39], a[76:79], a[4:7]
    s_add_u32 m0, s56, 4096
    v_mfma_f32_16x16x32_bf16 a[0:3], v[32:35], a[76:79], a[0:3]
    s_add_u32 s68, s75, 1112064
    v_mfma_f32_16x16x32_bf16 a[0:3], v[48:51], a[72:75], a[0:3]
    v_mfma_f32_16x16x32_bf16 a[0:3], a[232:235], a[68:71], a[0:3]
    buffer_load_dwordx4 v13, s[16:19], s68 offen offset:2048 lds
    s_add_u32 m0, s0, 139264
    v_mfma_f32_16x16x32_bf16 a[0:3], a[216:219], a[64:67], a[0:3]
    s_waitcnt lgkmcnt(3)
    s_add_u32 s68, s92, 165888
    v_mfma_f32_16x16x32_bf16 a[16:19], a[216:219], a[80:83], a[16:19]
    s_waitcnt lgkmcnt(2)
    ds_read_b128 a[64:67], v6 offset:8192
    v_mfma_f32_16x16x32_bf16 a[16:19], a[232:235], a[84:87], a[16:19]
    s_waitcnt lgkmcnt(2)
    buffer_load_dwordx4 v10, s[24:27], s68 offen offset:0 sc1 lds
    s_waitcnt vmcnt(12)
    v_mfma_f32_16x16x32_bf16 a[16:19], v[48:51], a[248:251], a[16:19]
    s_waitcnt lgkmcnt(1)
    ds_read_b128 a[68:71], v6 offset:9216
    v_mfma_f32_16x16x32_bf16 a[16:19], v[32:35], a[252:255], a[16:19]
    ds_read_b64_tr_b16 a[152:153], v14 offset:0
    v_mfma_f32_16x16x32_bf16 a[20:23], v[36:39], a[252:255], a[20:23]
    ds_read_b128 a[72:75], v6 offset:10240
    v_mfma_f32_16x16x32_bf16 a[20:23], v[52:55], a[248:251], a[20:23]
    ds_read_b64_tr_b16 a[156:157], v15 offset:0
    v_mfma_f32_16x16x32_bf16 a[20:23], a[236:239], a[84:87], a[20:23]
    ds_read_b128 a[76:79], v6 offset:11264
    v_mfma_f32_16x16x32_bf16 a[20:23], a[220:223], a[80:83], a[20:23]
    s_add_u32 s68, s93, 163840
    ds_read_b64_tr_b16 a[160:161], v16 offset:0
    v_mfma_f32_16x16x32_bf16 a[24:27], a[224:227], a[80:83], a[24:27]
    ds_read_b64_tr_b16 a[164:165], v17 offset:0
    v_mfma_f32_16x16x32_bf16 a[24:27], a[240:243], a[84:87], a[24:27]
    s_waitcnt vmcnt(8)
    buffer_load_dwordx4 v10, s[24:27], s68 offen offset:2048 sc1 lds
    s_add_u32 m0, s56, 4096
    v_mfma_f32_16x16x32_bf16 a[24:27], v[56:59], a[248:251], a[24:27]
    s_add_u32 s68, s75, 1127424
    ds_read_b64_tr_b16 a[154:155], v14 offset:2048
    v_mfma_f32_16x16x32_bf16 a[24:27], v[40:43], a[252:255], a[24:27]
    v_mfma_f32_16x16x32_bf16 a[28:31], v[44:47], a[252:255], a[28:31]
    buffer_load_dwordx4 v13, s[16:19], s68 offen offset:3072 lds
    v_mfma_f32_16x16x32_bf16 a[28:31], v[60:63], a[248:251], a[28:31]
    ds_read_b64_tr_b16 a[158:159], v15 offset:2048
    v_mfma_f32_16x16x32_bf16 a[28:31], a[244:247], a[84:87], a[28:31]
    s_add_u32 m0, s0, 143360
    ds_read_b64_tr_b16 a[162:163], v16 offset:2048
    v_mfma_f32_16x16x32_bf16 a[28:31], a[228:231], a[80:83], a[28:31]
    s_waitcnt lgkmcnt(10)
    s_add_u32 s68, s92, 198656
    v_mfma_f32_16x16x32_bf16 v[204:207], a[228:231], a[64:67], v[204:207]
    s_waitcnt lgkmcnt(9)
    ds_read_b128 a[80:83], v6 offset:12288
    v_mfma_f32_16x16x32_bf16 v[204:207], a[244:247], a[68:71], v[204:207]
    s_waitcnt lgkmcnt(8)
    buffer_load_dwordx4 v10, s[24:27], s68 offen offset:0 sc1 lds
    v_mfma_f32_16x16x32_bf16 v[204:207], v[60:63], a[72:75], v[204:207]
    s_waitcnt lgkmcnt(6)
    ds_read_b64_tr_b16 a[166:167], v17 offset:2048
    s_add_u32 m0, s56, 12288
    v_mfma_f32_16x16x32_bf16 v[204:207], v[44:47], a[76:79], v[204:207]
    s_add_u32 s68, s76, 1081344
    ds_read_b128 a[84:87], v6 offset:13312
    v_mfma_f32_16x16x32_bf16 v[200:203], v[40:43], a[76:79], v[200:203]
    ds_read_b128 a[248:251], v6 offset:14336
    v_mfma_f32_16x16x32_bf16 v[200:203], v[56:59], a[72:75], v[200:203]
    buffer_load_dwordx4 v13, s[16:19], s68 offen offset:0 lds
    v_mfma_f32_16x16x32_bf16 v[200:203], a[240:243], a[68:71], v[200:203]
    s_add_u32 m0, s0, 143360
    ds_read_b128 a[252:255], v6 offset:15360
    v_mfma_f32_16x16x32_bf16 v[200:203], a[224:227], a[64:67], v[200:203]
    s_add_u32 s68, s93, 196608
    v_mfma_f32_16x16x32_bf16 v[196:199], a[220:223], a[64:67], v[196:199]
    v_mfma_f32_16x16x32_bf16 v[196:199], a[236:239], a[68:71], v[196:199]
    buffer_load_dwordx4 v10, s[24:27], s68 offen offset:2048 sc1 lds
    v_mfma_f32_16x16x32_bf16 v[196:199], v[52:55], a[72:75], v[196:199]
    v_mfma_f32_16x16x32_bf16 v[196:199], v[36:39], a[76:79], v[196:199]
    s_add_u32 m0, s56, 12288
    v_mfma_f32_16x16x32_bf16 v[192:195], v[32:35], a[76:79], v[192:195]
    s_add_u32 s68, s76, 1096704
    v_mfma_f32_16x16x32_bf16 v[192:195], v[48:51], a[72:75], v[192:195]
    v_mfma_f32_16x16x32_bf16 v[192:195], a[232:235], a[68:71], v[192:195]
    s_waitcnt lgkmcnt(0)
    buffer_load_dwordx4 v13, s[16:19], s68 offen offset:1024 lds
    s_add_u32 m0, s0, 65536
    v_mfma_f32_16x16x32_bf16 v[192:195], a[216:219], a[64:67], v[192:195]
    s_barrier
    s_add_u32 s68, s92, 102400
    v_mfma_f32_16x16x32_bf16 v[208:211], a[216:219], a[80:83], v[208:211]
    ds_read_b128 a[64:67], v6 offset:32768
    v_mfma_f32_16x16x32_bf16 v[208:211], a[232:235], a[84:87], v[208:211]
    buffer_load_dwordx4 v10, s[24:27], s68 offen offset:0 sc1 lds
    v_mfma_f32_16x16x32_bf16 v[208:211], v[48:51], a[248:251], v[208:211]
    ds_read_b128 a[68:71], v6 offset:33792
    v_mfma_f32_16x16x32_bf16 v[208:211], v[32:35], a[252:255], v[208:211]
    v_mfma_f32_16x16x32_bf16 v[212:215], v[36:39], a[252:255], v[212:215]
    ds_read_b128 a[72:75], v6 offset:34816
    v_mfma_f32_16x16x32_bf16 v[212:215], v[52:55], a[248:251], v[212:215]
    v_mfma_f32_16x16x32_bf16 v[212:215], a[236:239], a[84:87], v[212:215]
    ds_read_b128 a[76:79], v6 offset:35840
    v_mfma_f32_16x16x32_bf16 v[212:215], a[220:223], a[80:83], v[212:215]
    s_add_u32 s68, s93, 100352
    v_mfma_f32_16x16x32_bf16 v[216:219], a[224:227], a[80:83], v[216:219]
    v_mfma_f32_16x16x32_bf16 v[216:219], a[240:243], a[84:87], v[216:219]
    buffer_load_dwordx4 v10, s[24:27], s68 offen offset:2048 sc1 lds
    s_add_u32 m0, s56, 12288
    v_mfma_f32_16x16x32_bf16 v[216:219], v[56:59], a[248:251], v[216:219]
    s_add_u32 s68, s76, 1112064
    v_mfma_f32_16x16x32_bf16 v[216:219], v[40:43], a[252:255], v[216:219]
    v_mfma_f32_16x16x32_bf16 v[220:223], v[44:47], a[252:255], v[220:223]
    buffer_load_dwordx4 v13, s[16:19], s68 offen offset:2048 lds
    v_mfma_f32_16x16x32_bf16 v[220:223], v[60:63], a[248:251], v[220:223]
    v_mfma_f32_16x16x32_bf16 v[220:223], a[244:247], a[84:87], v[220:223]
    s_add_u32 m0, s0, 69632
    v_mfma_f32_16x16x32_bf16 v[220:223], a[228:231], a[80:83], v[220:223]
    s_waitcnt lgkmcnt(3)
    s_waitcnt vmcnt(12)
    s_add_u32 s68, s92, 135168
    v_mfma_f32_16x16x32_bf16 a[44:47], a[228:231], a[64:67], a[44:47]
    s_waitcnt lgkmcnt(2)
    ds_read_b128 a[80:83], v6 offset:36864
    v_mfma_f32_16x16x32_bf16 a[44:47], a[244:247], a[68:71], a[44:47]
    s_waitcnt lgkmcnt(2)
    buffer_load_dwordx4 v10, s[24:27], s68 offen offset:0 sc1 lds
    v_mfma_f32_16x16x32_bf16 a[44:47], v[60:63], a[72:75], a[44:47]
    s_waitcnt lgkmcnt(1)
    ds_read_b64_tr_b16 a[168:169], v14 offset:4096
    s_add_u32 m0, s56, 12288
    v_mfma_f32_16x16x32_bf16 a[44:47], v[44:47], a[76:79], a[44:47]
    s_add_u32 s68, s76, 1127424
    ds_read_b128 a[84:87], v6 offset:37888
    v_mfma_f32_16x16x32_bf16 a[40:43], v[40:43], a[76:79], a[40:43]
    ds_read_b64_tr_b16 a[172:173], v15 offset:4096
    v_mfma_f32_16x16x32_bf16 a[40:43], v[56:59], a[72:75], a[40:43]
    buffer_load_dwordx4 v13, s[16:19], s68 offen offset:3072 lds
    v_mfma_f32_16x16x32_bf16 a[40:43], a[240:243], a[68:71], a[40:43]
    s_add_u32 m0, s0, 69632
    ds_read_b128 a[248:251], v6 offset:38912
    v_mfma_f32_16x16x32_bf16 a[40:43], a[224:227], a[64:67], a[40:43]
    s_waitcnt vmcnt(9)
    ds_read_b64_tr_b16 a[176:177], v16 offset:4096
    s_add_u32 s68, s93, 133120
    v_mfma_f32_16x16x32_bf16 a[36:39], a[220:223], a[64:67], a[36:39]
    ds_read_b128 a[252:255], v6 offset:39936
    v_mfma_f32_16x16x32_bf16 a[36:39], a[236:239], a[68:71], a[36:39]
    ds_read_b64_tr_b16 a[180:181], v17 offset:4096
    v_mfma_f32_16x16x32_bf16 a[36:39], v[52:55], a[72:75], a[36:39]
    buffer_load_dwordx4 v10, s[24:27], s68 offen offset:2048 sc1 lds
    v_mfma_f32_16x16x32_bf16 a[36:39], v[36:39], a[76:79], a[36:39]
    s_add_u32 m0, s56, 8192
    ds_read_b64_tr_b16 a[170:171], v14 offset:6144
    v_mfma_f32_16x16x32_bf16 a[32:35], v[32:35], a[76:79], a[32:35]
    s_add_u32 s68, s77, 1081344
    ds_read_b64_tr_b16 a[174:175], v15 offset:6144
    v_mfma_f32_16x16x32_bf16 a[32:35], v[48:51], a[72:75], a[32:35]
    ds_read_b64_tr_b16 a[178:179], v16 offset:6144
    v_mfma_f32_16x16x32_bf16 a[32:35], a[232:235], a[68:71], a[32:35]
    buffer_load_dwordx4 v13, s[16:19], s68 offen offset:0 lds
    s_add_u32 m0, s0, 73728
    v_mfma_f32_16x16x32_bf16 a[32:35], a[216:219], a[64:67], a[32:35]
    s_waitcnt lgkmcnt(10)
    ds_read_b64_tr_b16 a[182:183], v17 offset:6144
    s_add_u32 s68, s92, 167936
    v_mfma_f32_16x16x32_bf16 a[48:51], a[216:219], a[80:83], a[48:51]
    s_waitcnt lgkmcnt(9)
    ds_read_b128 a[64:67], v6 offset:40960
    v_mfma_f32_16x16x32_bf16 a[48:51], a[232:235], a[84:87], a[48:51]
    s_waitcnt lgkmcnt(8)
    buffer_load_dwordx4 v10, s[24:27], s68 offen offset:0 sc1 lds
    v_mfma_f32_16x16x32_bf16 a[48:51], v[48:51], a[248:251], a[48:51]
    s_waitcnt lgkmcnt(6)
    ds_read_b128 a[68:71], v6 offset:41984
    v_mfma_f32_16x16x32_bf16 a[48:51], v[32:35], a[252:255], a[48:51]
    v_mfma_f32_16x16x32_bf16 a[52:55], v[36:39], a[252:255], a[52:55]
    ds_read_b128 a[72:75], v6 offset:43008
    v_mfma_f32_16x16x32_bf16 a[52:55], v[52:55], a[248:251], a[52:55]
    v_mfma_f32_16x16x32_bf16 a[52:55], a[236:239], a[84:87], a[52:55]
    ds_read_b128 a[76:79], v6 offset:44032
    v_mfma_f32_16x16x32_bf16 a[52:55], a[220:223], a[80:83], a[52:55]
    s_add_u32 s68, s93, 165888
    v_mfma_f32_16x16x32_bf16 a[56:59], a[224:227], a[80:83], a[56:59]
    v_mfma_f32_16x16x32_bf16 a[56:59], a[240:243], a[84:87], a[56:59]
    buffer_load_dwordx4 v10, s[24:27], s68 offen offset:2048 sc1 lds
    s_add_u32 m0, s56, 8192
    v_mfma_f32_16x16x32_bf16 a[56:59], v[56:59], a[248:251], a[56:59]
    s_add_u32 s68, s77, 1096704
    v_mfma_f32_16x16x32_bf16 a[56:59], v[40:43], a[252:255], a[56:59]
    v_mfma_f32_16x16x32_bf16 a[60:63], v[44:47], a[252:255], a[60:63]
    buffer_load_dwordx4 v13, s[16:19], s68 offen offset:1024 lds
    v_mfma_f32_16x16x32_bf16 a[60:63], v[60:63], a[248:251], a[60:63]
    v_mfma_f32_16x16x32_bf16 a[60:63], a[244:247], a[84:87], a[60:63]
    s_add_u32 m0, s0, 77824
    v_mfma_f32_16x16x32_bf16 a[60:63], a[228:231], a[80:83], a[60:63]
    s_waitcnt lgkmcnt(3)
    s_add_u32 s68, s92, 200704
    v_mfma_f32_16x16x32_bf16 v[236:239], a[228:231], a[64:67], v[236:239]
    s_waitcnt lgkmcnt(2)
    ds_read_b128 a[80:83], v6 offset:45056
    v_mfma_f32_16x16x32_bf16 v[236:239], a[244:247], a[68:71], v[236:239]
    s_waitcnt lgkmcnt(2)
    buffer_load_dwordx4 v10, s[24:27], s68 offen offset:0 sc1 lds
    v_mfma_f32_16x16x32_bf16 v[236:239], v[60:63], a[72:75], v[236:239]
    s_waitcnt lgkmcnt(1)
    ds_read_b128 a[84:87], v6 offset:46080
    s_add_u32 m0, s56, 8192
    v_mfma_f32_16x16x32_bf16 v[236:239], v[44:47], a[76:79], v[236:239]
    s_add_u32 s68, s77, 1112064
    v_mfma_f32_16x16x32_bf16 v[232:235], v[40:43], a[76:79], v[232:235]
    ds_read_b128 a[248:251], v6 offset:47104
    v_mfma_f32_16x16x32_bf16 v[232:235], v[56:59], a[72:75], v[232:235]
    buffer_load_dwordx4 v13, s[16:19], s68 offen offset:2048 lds
    v_mfma_f32_16x16x32_bf16 v[232:235], a[240:243], a[68:71], v[232:235]
    s_add_u32 m0, s0, 77824
    ds_read_b128 a[252:255], v6 offset:48128
    v_mfma_f32_16x16x32_bf16 v[232:235], a[224:227], a[64:67], v[232:235]
    s_add_u32 s68, s93, 198656
    v_mfma_f32_16x16x32_bf16 v[228:231], a[220:223], a[64:67], v[228:231]
    s_waitcnt vmcnt(12)
    v_mfma_f32_16x16x32_bf16 v[228:231], a[236:239], a[68:71], v[228:231]
    buffer_load_dwordx4 v10, s[24:27], s68 offen offset:2048 sc1 lds
    v_mfma_f32_16x16x32_bf16 v[228:231], v[52:55], a[72:75], v[228:231]
    ds_read_b64_tr_b16 a[184:185], v14 offset:12288
    v_mfma_f32_16x16x32_bf16 v[228:231], v[36:39], a[76:79], v[228:231]
    s_add_u32 m0, s56, 8192
    ds_read_b64_tr_b16 a[188:189], v15 offset:12288
    v_mfma_f32_16x16x32_bf16 v[224:227], v[32:35], a[76:79], v[224:227]
    s_add_u32 s68, s77, 1127424
    v_mfma_f32_16x16x32_bf16 v[224:227], v[48:51], a[72:75], v[224:227]
    ds_read_b64_tr_b16 a[192:193], v16 offset:12288
    v_mfma_f32_16x16x32_bf16 v[224:227], a[232:235], a[68:71], v[224:227]
    s_waitcnt lgkmcnt(3)
    buffer_load_dwordx4 v13, s[16:19], s68 offen offset:3072 lds
    s_add_u32 m0, s0, 98304
    v_mfma_f32_16x16x32_bf16 v[224:227], a[216:219], a[64:67], v[224:227]
    s_barrier
    ds_read_b64_tr_b16 a[196:197], v17 offset:12288
    s_add_u32 s68, s92, 101376
    v_mfma_f32_16x16x32_bf16 v[240:243], a[216:219], a[80:83], v[240:243]
    s_waitcnt vmcnt(9)
    ds_read_b128 a[64:67], v7 offset:0
    v_mfma_f32_16x16x32_bf16 v[240:243], a[232:235], a[84:87], v[240:243]
    buffer_load_dwordx4 v10, s[24:27], s68 offen offset:0 sc1 lds
    v_mfma_f32_16x16x32_bf16 v[240:243], v[48:51], a[248:251], v[240:243]
    ds_read_b128 a[68:71], v7 offset:1024
    v_mfma_f32_16x16x32_bf16 v[240:243], v[32:35], a[252:255], v[240:243]
    ds_read_b64_tr_b16 a[186:187], v14 offset:14336
    v_mfma_f32_16x16x32_bf16 v[244:247], v[36:39], a[252:255], v[244:247]
    ds_read_b128 a[72:75], v7 offset:2048
    v_mfma_f32_16x16x32_bf16 v[244:247], v[52:55], a[248:251], v[244:247]
    ds_read_b64_tr_b16 a[190:191], v15 offset:14336
    v_mfma_f32_16x16x32_bf16 v[244:247], a[236:239], a[84:87], v[244:247]
    ds_read_b128 a[76:79], v7 offset:3072
    v_mfma_f32_16x16x32_bf16 v[244:247], a[220:223], a[80:83], v[244:247]
    s_add_u32 s68, s93, 99328
    ds_read_b64_tr_b16 a[194:195], v16 offset:14336
    v_mfma_f32_16x16x32_bf16 v[248:251], a[224:227], a[80:83], v[248:251]
    ds_read_b64_tr_b16 a[198:199], v17 offset:14336
    v_mfma_f32_16x16x32_bf16 v[248:251], a[240:243], a[84:87], v[248:251]
    buffer_load_dwordx4 v10, s[24:27], s68 offen offset:2048 sc1 lds
    v_mfma_f32_16x16x32_bf16 v[248:251], v[56:59], a[248:251], v[248:251]
    v_mfma_f32_16x16x32_bf16 v[248:251], v[40:43], a[252:255], v[248:251]
    v_mfma_f32_16x16x32_bf16 v[252:255], v[44:47], a[252:255], v[252:255]
    v_mfma_f32_16x16x32_bf16 v[252:255], v[60:63], a[248:251], v[252:255]
    v_mfma_f32_16x16x32_bf16 v[252:255], a[244:247], a[84:87], v[252:255]
    s_add_u32 m0, s0, 102400
    v_mfma_f32_16x16x32_bf16 v[252:255], a[228:231], a[80:83], v[252:255]
    s_waitcnt lgkmcnt(7)
    s_add_u32 s68, s92, 134144
    v_mfma_f32_16x16x32_bf16 a[12:15], v[92:95], a[64:67], a[12:15]
    s_waitcnt lgkmcnt(6)
    ds_read_b128 a[80:83], v7 offset:4096
    s_add_u32 s20, s32, 16777216
    s_addc_u32 s21, s33, 0
    s_mov_b32 s22, 8388608
    v_mfma_f32_16x16x32_bf16 a[12:15], v[108:111], a[68:71], a[12:15]
    s_waitcnt lgkmcnt(5)
    buffer_load_dwordx4 v10, s[24:27], s68 offen offset:0 sc1 lds
    v_mfma_f32_16x16x32_bf16 a[12:15], v[76:79], a[72:75], a[12:15]
    s_waitcnt lgkmcnt(3)
    ds_read_b128 a[84:87], v7 offset:5120
    v_mfma_f32_16x16x32_bf16 a[12:15], v[156:159], a[76:79], a[12:15]
    v_mfma_f32_16x16x32_bf16 a[8:11], v[152:155], a[76:79], a[8:11]
    ds_read_b128 a[248:251], v7 offset:6144
    v_mfma_f32_16x16x32_bf16 a[8:11], v[72:75], a[72:75], a[8:11]
    v_mfma_f32_16x16x32_bf16 a[8:11], v[104:107], a[68:71], a[8:11]
    ds_read_b128 a[252:255], v7 offset:7168
    v_mfma_f32_16x16x32_bf16 a[8:11], v[88:91], a[64:67], a[8:11]
    s_add_u32 s68, s93, 132096
    v_mfma_f32_16x16x32_bf16 a[4:7], v[84:87], a[64:67], a[4:7]
    v_add_u32 v19, 4096, v18
    v_mfma_f32_16x16x32_bf16 a[4:7], v[100:103], a[68:71], a[4:7]
    buffer_load_dwordx4 v10, s[24:27], s68 offen offset:2048 sc1 lds
    v_mfma_f32_16x16x32_bf16 a[4:7], v[68:71], a[72:75], a[4:7]
    s_mov_b32 s69, 32768
    v_mfma_f32_16x16x32_bf16 a[4:7], v[148:151], a[76:79], a[4:7]
    v_mfma_f32_16x16x32_bf16 a[0:3], v[144:147], a[76:79], a[0:3]
    s_movk_i32 s48, 16384
    v_mfma_f32_16x16x32_bf16 a[0:3], v[64:67], a[72:75], a[0:3]
    v_mfma_f32_16x16x32_bf16 a[0:3], v[96:99], a[68:71], a[0:3]
    s_add_u32 m0, s0, 106496
    s_mov_b32 s49, 49152
    v_mfma_f32_16x16x32_bf16 a[0:3], v[80:83], a[64:67], a[0:3]
    s_waitcnt lgkmcnt(3)
    s_add_u32 s68, s92, 166912
    v_mfma_f32_16x16x32_bf16 a[0:3], v[160:163], a[80:83], a[0:3]
    s_waitcnt lgkmcnt(2)
    ds_read_b128 a[64:67], v7 offset:8192
    v_and_b32 v26, 15, v0
    v_mfma_f32_16x16x32_bf16 a[0:3], v[176:179], a[84:87], a[0:3]
    s_waitcnt lgkmcnt(2)
    buffer_load_dwordx4 v10, s[24:27], s68 offen offset:0 sc1 lds
    v_lshrrev_b32 v27, 5, v0
    v_mfma_f32_16x16x32_bf16 a[0:3], v[128:131], a[248:251], a[0:3]
    s_waitcnt lgkmcnt(1)
    ds_read_b128 a[68:71], v7 offset:9216
    v_and_b32 v28, 7, v0
    v_mfma_f32_16x16x32_bf16 a[0:3], v[112:115], a[252:255], a[0:3]
    s_waitcnt vmcnt(9)
    ds_read_b64_tr_b16 a[200:201], v14 offset:8192
    v_xor_b32 v27, v27, v28
    v_mfma_f32_16x16x32_bf16 a[4:7], v[116:119], a[252:255], a[4:7]
    ds_read_b128 a[72:75], v7 offset:10240
    v_lshlrev_b32 v27, 4, v27
    v_mfma_f32_16x16x32_bf16 a[4:7], v[132:135], a[248:251], a[4:7]
    ds_read_b64_tr_b16 a[204:205], v15 offset:8192
    v_lshl_add_u32 v27, v26, 7, v27
    v_mfma_f32_16x16x32_bf16 a[4:7], v[180:183], a[84:87], a[4:7]
    ds_read_b128 a[76:79], v7 offset:11264
    v_bfe_u32 v26, v0, 4, 1
    v_mfma_f32_16x16x32_bf16 a[4:7], v[164:167], a[80:83], a[4:7]
    s_add_u32 s68, s93, 164864
    ds_read_b64_tr_b16 a[208:209], v16 offset:8192
    v_lshl_add_u32 v27, v26, 3, v27
    v_mfma_f32_16x16x32_bf16 a[8:11], v[168:171], a[80:83], a[8:11]
L_pad10:
    s_cbranch_vccnz L_warm
    ds_read_b64_tr_b16 a[212:213], v17 offset:8192
    v_add_u32 v22, s56, v27
    v_mfma_f32_16x16x32_bf16 a[8:11], v[184:187], a[84:87], a[8:11]
    s_waitcnt vmcnt(5)
    buffer_load_dwordx4 v10, s[24:27], s68 offen offset:2048 sc1 lds
    v_xor_b32 v23, 32, v22
    v_mfma_f32_16x16x32_bf16 a[8:11], v[136:139], a[248:251], a[8:11]
    ds_read_b64_tr_b16 a[202:203], v14 offset:10240
    v_xor_b32 v24, 64, v22
    v_mfma_f32_16x16x32_bf16 a[8:11], v[120:123], a[252:255], a[8:11]
    v_xor_b32 v25, 96, v22
    v_mfma_f32_16x16x32_bf16 a[12:15], v[124:127], a[252:255], a[12:15]
    ds_read_b64_tr_b16 a[206:207], v15 offset:10240
    v_lshrrev_b32 v26, 3, v0
    v_mfma_f32_16x16x32_bf16 a[12:15], v[140:143], a[248:251], a[12:15]
    v_xor_b32 v27, v26, v28
    v_mfma_f32_16x16x32_bf16 a[12:15], v[188:191], a[84:87], a[12:15]
    s_add_u32 m0, s0, 110592
    ds_read_b64_tr_b16 a[210:211], v16 offset:10240
    v_lshlrev_b32 v27, 4, v27
    v_mfma_f32_16x16x32_bf16 a[12:15], v[172:175], a[80:83], a[12:15]
    s_waitcnt lgkmcnt(10)
    v_lshl_add_u32 v27, v26, 7, v27
    v_mfma_f32_16x16x32_bf16 a[12:15], a[100:103], a[64:67], a[12:15]
    s_waitcnt lgkmcnt(9)
    ds_read_b128 a[80:83], v7 offset:12288
    v_add_u32 v29, s56, v27
    v_mfma_f32_16x16x32_bf16 a[12:15], a[116:119], a[68:71], a[12:15]
    s_waitcnt lgkmcnt(8)
    ds_read_b64_tr_b16 a[214:215], v17 offset:10240
    v_lshlrev_b32 v26, 11, v26
    v_mfma_f32_16x16x32_bf16 a[12:15], a[132:135], a[72:75], a[12:15]
    s_waitcnt lgkmcnt(7)
    s_add_u32 s68, s92, 199680
    v_lshl_add_u32 v31, v28, 4, v26
    v_mfma_f32_16x16x32_bf16 a[12:15], a[148:151], a[76:79], a[12:15]
    buffer_load_dwordx4 v10, s[24:27], s68 offen offset:0 sc1 lds
    v_mfma_f32_16x16x32_bf16 a[8:11], a[144:147], a[76:79], a[8:11]
    ds_read_b128 a[84:87], v7 offset:13312
    v_mfma_f32_16x16x32_bf16 a[8:11], a[128:131], a[72:75], a[8:11]
    ds_read_b128 a[248:251], v7 offset:14336
    v_mfma_f32_16x16x32_bf16 a[8:11], a[112:115], a[68:71], a[8:11]
    ds_read_b128 a[252:255], v7 offset:15360
    v_mfma_f32_16x16x32_bf16 a[8:11], a[96:99], a[64:67], a[8:11]
    s_add_u32 s68, s93, 197632
    v_mfma_f32_16x16x32_bf16 a[4:7], a[92:95], a[64:67], a[4:7]
    v_mfma_f32_16x16x32_bf16 a[4:7], a[108:111], a[68:71], a[4:7]
    buffer_load_dwordx4 v10, s[24:27], s68 offen offset:2048 sc1 lds
    v_mfma_f32_16x16x32_bf16 a[4:7], a[124:127], a[72:75], a[4:7]
    v_mfma_f32_16x16x32_bf16 a[4:7], a[140:143], a[76:79], a[4:7]
    v_mfma_f32_16x16x32_bf16 a[0:3], a[136:139], a[76:79], a[0:3]
    v_mfma_f32_16x16x32_bf16 a[0:3], a[120:123], a[72:75], a[0:3]
    v_mfma_f32_16x16x32_bf16 a[0:3], a[104:107], a[68:71], a[0:3]
    s_waitcnt lgkmcnt(0)
    s_add_u32 m0, s0, 131072
    v_mfma_f32_16x16x32_bf16 a[0:3], a[88:91], a[64:67], a[0:3]
    s_barrier
    s_add_u32 s68, s92, 103424
    v_mfma_f32_16x16x32_bf16 a[0:3], a[152:155], a[80:83], a[0:3]
    ds_read_b128 a[64:67], v6 offset:0
    v_mfma_f32_16x16x32_bf16 a[0:3], a[168:171], a[84:87], a[0:3]
    buffer_load_dwordx4 v10, s[24:27], s68 offen offset:0 sc1 lds
    v_mfma_f32_16x16x32_bf16 a[0:3], a[184:187], a[248:251], a[0:3]
    ds_read_b128 a[68:71], v6 offset:1024
    v_mfma_f32_16x16x32_bf16 a[0:3], a[200:203], a[252:255], a[0:3]
    v_mfma_f32_16x16x32_bf16 a[4:7], a[204:207], a[252:255], a[4:7]
    ds_read_b128 a[72:75], v6 offset:2048
    v_mfma_f32_16x16x32_bf16 a[4:7], a[188:191], a[248:251], a[4:7]
    v_mfma_f32_16x16x32_bf16 a[4:7], a[172:175], a[84:87], a[4:7]
    ds_read_b128 a[76:79], v6 offset:3072
    v_mfma_f32_16x16x32_bf16 a[4:7], a[156:159], a[80:83], a[4:7]
    s_add_u32 s68, s93, 101376
    v_mfma_f32_16x16x32_bf16 a[8:11], a[160:163], a[80:83], a[8:11]
    v_mfma_f32_16x16x32_bf16 a[8:11], a[176:179], a[84:87], a[8:11]
    buffer_load_dwordx4 v10, s[24:27], s68 offen offset:2048 sc1 lds
    v_mfma_f32_16x16x32_bf16 a[8:11], a[192:195], a[248:251], a[8:11]
    v_mfma_f32_16x16x32_bf16 a[8:11], a[208:211], a[252:255], a[8:11]
    v_mfma_f32_16x16x32_bf16 a[12:15], a[212:215], a[252:255], a[12:15]
    v_mfma_f32_16x16x32_bf16 a[12:15], a[196:199], a[248:251], a[12:15]
    v_mfma_f32_16x16x32_bf16 a[12:15], a[180:183], a[84:87], a[12:15]
    s_add_u32 m0, s0, 135168
    v_mfma_f32_16x16x32_bf16 a[12:15], a[164:167], a[80:83], a[12:15]
    s_waitcnt lgkmcnt(3)
    s_add_u32 s68, s92, 136192
    v_mfma_f32_16x16x32_bf16 v[204:207], v[92:95], a[64:67], v[204:207]
    s_waitcnt lgkmcnt(2)
    ds_read_b128 a[80:83], v6 offset:4096
    v_mfma_f32_16x16x32_bf16 v[204:207], v[108:111], a[68:71], v[204:207]
    s_waitcnt lgkmcnt(2)
    buffer_load_dwordx4 v10, s[24:27], s68 offen offset:0 sc1 lds
    v_mfma_f32_16x16x32_bf16 v[204:207], v[76:79], a[72:75], v[204:207]
    s_waitcnt lgkmcnt(1)
    ds_read_b128 a[84:87], v6 offset:5120
    v_mfma_f32_16x16x32_bf16 v[204:207], v[156:159], a[76:79], v[204:207]
    v_mfma_f32_16x16x32_bf16 v[200:203], v[152:155], a[76:79], v[200:203]
    ds_read_b128 a[248:251], v6 offset:6144
    v_mfma_f32_16x16x32_bf16 v[200:203], v[72:75], a[72:75], v[200:203]
    v_mfma_f32_16x16x32_bf16 v[200:203], v[104:107], a[68:71], v[200:203]
    ds_write_b32 v8, a0 offset:0
    v_mfma_f32_16x16x32_bf16 v[200:203], v[88:91], a[64:67], v[200:203]
    s_add_u32 s68, s93, 134144
    ds_write_b32 v8, a1 offset:256
    v_mfma_f32_16x16x32_bf16 v[196:199], v[84:87], a[64:67], v[196:199]
    ds_read_b128 a[252:255], v6 offset:7168
    v_mfma_f32_16x16x32_bf16 v[196:199], v[100:103], a[68:71], v[196:199]
    buffer_load_dwordx4 v10, s[24:27], s68 offen offset:2048 sc1 lds
    v_mfma_f32_16x16x32_bf16 v[196:199], v[68:71], a[72:75], v[196:199]
    ds_write_b32 v8, a2 offset:512
    v_mfma_f32_16x16x32_bf16 v[196:199], v[148:151], a[76:79], v[196:199]
    ds_write_b32 v8, a3 offset:768
    v_mfma_f32_16x16x32_bf16 v[192:195], v[144:147], a[76:79], v[192:195]
    ds_write_b32 v8, a4 offset:1024
    v_mfma_f32_16x16x32_bf16 v[192:195], v[64:67], a[72:75], v[192:195]
    ds_write_b32 v8, a5 offset:1280
    v_mfma_f32_16x16x32_bf16 v[192:195], v[96:99], a[68:71], v[192:195]
    s_add_u32 m0, s0, 139264
    v_mfma_f32_16x16x32_bf16 v[192:195], v[80:83], a[64:67], v[192:195]
    s_waitcnt lgkmcnt(9)
    ds_write_b32 v8, a6 offset:1536
    s_add_u32 s68, s92, 168960
    v_mfma_f32_16x16x32_bf16 v[192:195], v[160:163], a[80:83], v[192:195]
    s_waitcnt lgkmcnt(9)
    ds_write_b32 v8, a7 offset:1792
    v_mfma_f32_16x16x32_bf16 v[192:195], v[176:179], a[84:87], v[192:195]
    s_waitcnt lgkmcnt(9)
    buffer_load_dwordx4 v10, s[24:27], s68 offen offset:0 sc1 lds
    v_mfma_f32_16x16x32_bf16 v[192:195], v[128:131], a[248:251], v[192:195]
    s_waitcnt lgkmcnt(6)
    ds_read_b128 a[64:67], v6 offset:8192
    v_mfma_f32_16x16x32_bf16 v[192:195], v[112:115], a[252:255], v[192:195]
    ds_write_b32 v8, a8 offset:2048
    v_mfma_f32_16x16x32_bf16 v[196:199], v[116:119], a[252:255], v[196:199]
    ds_write_b32 v8, a9 offset:2304
    v_mfma_f32_16x16x32_bf16 v[196:199], v[132:135], a[248:251], v[196:199]
    ds_read_b128 a[68:71], v6 offset:9216
    v_mfma_f32_16x16x32_bf16 v[196:199], v[180:183], a[84:87], v[196:199]
    ds_write_b32 v8, a10 offset:2560
    v_mfma_f32_16x16x32_bf16 v[196:199], v[164:167], a[80:83], v[196:199]
    s_add_u32 s68, s93, 166912
    ds_read_b128 a[72:75], v6 offset:10240
    v_mfma_f32_16x16x32_bf16 v[200:203], v[168:171], a[80:83], v[200:203]
    ds_write_b32 v8, a11 offset:2816
    v_mfma_f32_16x16x32_bf16 v[200:203], v[184:187], a[84:87], v[200:203]
    ds_read_b128 a[76:79], v6 offset:11264
    v_mfma_f32_16x16x32_bf16 v[200:203], v[136:139], a[248:251], v[200:203]
    ds_write_b32 v8, a12 offset:3072
    v_mfma_f32_16x16x32_bf16 v[200:203], v[120:123], a[252:255], v[200:203]
    buffer_load_dwordx4 v10, s[24:27], s68 offen offset:2048 sc1 lds
    ds_write_b32 v8, a13 offset:3328
    v_mfma_f32_16x16x32_bf16 v[204:207], v[124:127], a[252:255], v[204:207]
    ds_write_b32 v8, a14 offset:3584
    v_mfma_f32_16x16x32_bf16 v[204:207], v[140:143], a[248:251], v[204:207]
    ds_write_b32 v8, a15 offset:3840
    v_mfma_f32_16x16x32_bf16 v[204:207], v[188:191], a[84:87], v[204:207]
    s_add_u32 m0, s0, 143360
    v_mfma_f32_16x16x32_bf16 v[204:207], v[172:175], a[80:83], v[204:207]
    s_waitcnt lgkmcnt(11)
    s_add_u32 s68, s92, 201728
    v_mfma_f32_16x16x32_bf16 v[204:207], a[100:103], a[64:67], v[204:207]
    s_waitcnt lgkmcnt(8)
    ds_read_b128 a[80:83], v6 offset:12288
    v_mfma_f32_16x16x32_bf16 v[204:207], a[116:119], a[68:71], v[204:207]
    s_waitcnt lgkmcnt(7)
    buffer_load_dwordx4 v10, s[24:27], s68 offen offset:0 sc1 lds
    v_mfma_f32_16x16x32_bf16 v[204:207], a[132:135], a[72:75], v[204:207]
    s_waitcnt lgkmcnt(5)
    ds_read_b128 a[84:87], v6 offset:13312
    v_mfma_f32_16x16x32_bf16 v[204:207], a[148:151], a[76:79], v[204:207]
    v_mfma_f32_16x16x32_bf16 v[200:203], a[144:147], a[76:79], v[200:203]
    ds_read_b128 a[248:251], v6 offset:14336
    v_mfma_f32_16x16x32_bf16 v[200:203], a[128:131], a[72:75], v[200:203]
    v_mfma_f32_16x16x32_bf16 v[200:203], a[112:115], a[68:71], v[200:203]
    ds_read_b128 a[252:255], v6 offset:15360
    v_mfma_f32_16x16x32_bf16 v[200:203], a[96:99], a[64:67], v[200:203]
    s_add_u32 s68, s93, 199680
    v_mfma_f32_16x16x32_bf16 v[196:199], a[92:95], a[64:67], v[196:199]
    v_mfma_f32_16x16x32_bf16 v[196:199], a[108:111], a[68:71], v[196:199]
    buffer_load_dwordx4 v10, s[24:27], s68 offen offset:2048 sc1 lds
    v_mfma_f32_16x16x32_bf16 v[196:199], a[124:127], a[72:75], v[196:199]
    v_mfma_f32_16x16x32_bf16 v[196:199], a[140:143], a[76:79], v[196:199]
    v_mfma_f32_16x16x32_bf16 v[192:195], a[136:139], a[76:79], v[192:195]
    v_mfma_f32_16x16x32_bf16 v[192:195], a[120:123], a[72:75], v[192:195]
    v_mfma_f32_16x16x32_bf16 v[192:195], a[104:107], a[68:71], v[192:195]
    s_waitcnt vmcnt(8) lgkmcnt(0)
    s_add_u32 m0, s0, 65536
    v_mfma_f32_16x16x32_bf16 v[192:195], a[88:91], a[64:67], v[192:195]
    s_barrier
    s_add_u32 s68, s92, 104448
    v_mfma_f32_16x16x32_bf16 v[192:195], a[152:155], a[80:83], v[192:195]
    ds_read_b128 a[64:67], v6 offset:32768
    v_mfma_f32_16x16x32_bf16 v[192:195], a[168:171], a[84:87], v[192:195]
    buffer_load_dwordx4 v10, s[24:27], s68 offen offset:0 sc1 lds
    v_mfma_f32_16x16x32_bf16 v[192:195], a[184:187], a[248:251], v[192:195]
    ds_read2st64_b32 v[48:49], v9 offset0:0 offset1:1
    v_mfma_f32_16x16x32_bf16 v[192:195], a[200:203], a[252:255], v[192:195]
    ds_read2st64_b32 v[50:51], v9 offset0:2 offset1:3
    v_mfma_f32_16x16x32_bf16 v[196:199], a[204:207], a[252:255], v[196:199]
    ds_read_b128 a[68:71], v6 offset:33792
    v_mfma_f32_16x16x32_bf16 v[196:199], a[188:191], a[248:251], v[196:199]
    ds_read2st64_b32 v[52:53], v9 offset0:4 offset1:5
    v_mfma_f32_16x16x32_bf16 v[196:199], a[172:175], a[84:87], v[196:199]
    ds_read_b128 a[72:75], v6 offset:34816
    v_mfma_f32_16x16x32_bf16 v[196:199], a[156:159], a[80:83], v[196:199]
    s_add_u32 s68, s93, 102400
    ds_read2st64_b32 v[54:55], v9 offset0:6 offset1:7
    v_mfma_f32_16x16x32_bf16 v[200:203], a[160:163], a[80:83], v[200:203]
    ds_read_b128 a[76:79], v6 offset:35840
    v_mfma_f32_16x16x32_bf16 v[200:203], a[176:179], a[84:87], v[200:203]
    ds_read2st64_b32 v[56:57], v9 offset0:8 offset1:9
    v_mfma_f32_16x16x32_bf16 v[200:203], a[192:195], a[248:251], v[200:203]
    buffer_load_dwordx4 v10, s[24:27], s68 offen offset:2048 sc1 lds
    v_mfma_f32_16x16x32_bf16 v[200:203], a[208:211], a[252:255], v[200:203]
    ds_read2st64_b32 v[58:59], v9 offset0:10 offset1:11
    v_mfma_f32_16x16x32_bf16 v[204:207], a[212:215], a[252:255], v[204:207]
    ds_read2st64_b32 v[60:61], v9 offset0:12 offset1:13
    v_mfma_f32_16x16x32_bf16 v[204:207], a[196:199], a[248:251], v[204:207]
    ds_read2st64_b32 v[62:63], v9 offset0:14 offset1:15
    v_mfma_f32_16x16x32_bf16 v[204:207], a[180:183], a[84:87], v[204:207]
    s_add_u32 m0, s0, 69632
    v_mfma_f32_16x16x32_bf16 v[204:207], a[164:167], a[80:83], v[204:207]
    s_waitcnt lgkmcnt(11)
    s_add_u32 s68, s92, 137216
    v_mfma_f32_16x16x32_bf16 a[28:31], v[92:95], a[64:67], a[28:31]
    s_waitcnt lgkmcnt(8)
    ds_read_b128 a[80:83], v6 offset:36864
    v_mfma_f32_16x16x32_bf16 a[28:31], v[108:111], a[68:71], a[28:31]
    s_waitcnt lgkmcnt(7)
    buffer_load_dwordx4 v10, s[24:27], s68 offen offset:0 sc1 lds
    v_mfma_f32_16x16x32_bf16 a[28:31], v[76:79], a[72:75], a[28:31]
    s_waitcnt lgkmcnt(5)
    ds_read_b128 a[84:87], v6 offset:37888
    v_mfma_f32_16x16x32_bf16 a[28:31], v[156:159], a[76:79], a[28:31]
    s_waitcnt lgkmcnt(2)
    v_mfma_f32_16x16x32_bf16 a[24:27], v[152:155], a[76:79], a[24:27]
    ds_read_b128 a[248:251], v6 offset:38912
    v_add_f32 v192, v192, v48
    v_add_f32 v193, v193, v49
    v_mfma_f32_16x16x32_bf16 a[24:27], v[72:75], a[72:75], a[24:27]
    v_add_f32 v194, v194, v50
    v_add_f32 v195, v195, v51
    v_mfma_f32_16x16x32_bf16 a[24:27], v[104:107], a[68:71], a[24:27]
    buffer_store_dwordx4 v[192:195], v18, s[20:23], s1 offen offset:0 sc1
    v_add_f32 v196, v196, v52
    v_add_f32 v197, v197, v53
    v_mfma_f32_16x16x32_bf16 a[24:27], v[88:91], a[64:67], a[24:27]
    s_add_u32 s68, s93, 135168
    ds_read_b128 a[252:255], v6 offset:39936
    v_add_f32 v198, v198, v54
    v_add_f32 v199, v199, v55
    v_mfma_f32_16x16x32_bf16 a[20:23], v[84:87], a[64:67], a[20:23]
    v_add_f32 v200, v200, v56
    v_add_f32 v201, v201, v57
    v_mfma_f32_16x16x32_bf16 a[20:23], v[100:103], a[68:71], a[20:23]
    buffer_load_dwordx4 v10, s[24:27], s68 offen offset:2048 sc1 lds
    v_add_f32 v202, v202, v58
    v_add_f32 v203, v203, v59
    v_mfma_f32_16x16x32_bf16 a[20:23], v[68:71], a[72:75], a[20:23]
    v_add_f32 v204, v204, v60
    v_add_f32 v205, v205, v61
    v_mfma_f32_16x16x32_bf16 a[20:23], v[148:151], a[76:79], a[20:23]
    v_add_f32 v206, v206, v62
    v_add_f32 v207, v207, v63
    v_mfma_f32_16x16x32_bf16 a[16:19], v[144:147], a[76:79], a[16:19]
    v_mfma_f32_16x16x32_bf16 a[16:19], v[64:67], a[72:75], a[16:19]
    v_mfma_f32_16x16x32_bf16 a[16:19], v[96:99], a[68:71], a[16:19]
    s_add_u32 m0, s0, 73728
    buffer_store_dwordx4 v[196:199], v18, s[20:23], s1 offen offset:1024 sc1
    v_mfma_f32_16x16x32_bf16 a[16:19], v[80:83], a[64:67], a[16:19]
    s_waitcnt lgkmcnt(3)
    s_add_u32 s68, s92, 169984
    v_mfma_f32_16x16x32_bf16 a[16:19], v[160:163], a[80:83], a[16:19]
    s_waitcnt lgkmcnt(2)
    ds_read_b128 a[64:67], v6 offset:40960
    v_mfma_f32_16x16x32_bf16 a[16:19], v[176:179], a[84:87], a[16:19]
    s_waitcnt lgkmcnt(2)
    buffer_load_dwordx4 v10, s[24:27], s68 offen offset:0 sc1 lds
    v_mfma_f32_16x16x32_bf16 a[16:19], v[128:131], a[248:251], a[16:19]
    s_waitcnt lgkmcnt(1)
    ds_read_b128 a[68:71], v6 offset:41984
    v_mfma_f32_16x16x32_bf16 a[16:19], v[112:115], a[252:255], a[16:19]
    v_mfma_f32_16x16x32_bf16 a[20:23], v[116:119], a[252:255], a[20:23]
    ds_read_b128 a[72:75], v6 offset:43008
    v_mfma_f32_16x16x32_bf16 a[20:23], v[132:135], a[248:251], a[20:23]
    v_mfma_f32_16x16x32_bf16 a[20:23], v[180:183], a[84:87], a[20:23]
    buffer_store_dwordx4 v[200:203], v18, s[20:23], s1 offen offset:2048 sc1
    v_mfma_f32_16x16x32_bf16 a[20:23], v[164:167], a[80:83], a[20:23]
    s_add_u32 s68, s93, 167936
    ds_read_b128 a[76:79], v6 offset:44032
    v_mfma_f32_16x16x32_bf16 a[24:27], v[168:171], a[80:83], a[24:27]
    v_mfma_f32_16x16x32_bf16 a[24:27], v[184:187], a[84:87], a[24:27]
    buffer_load_dwordx4 v10, s[24:27], s68 offen offset:2048 sc1 lds
    v_mfma_f32_16x16x32_bf16 a[24:27], v[136:139], a[248:251], a[24:27]
    v_mfma_f32_16x16x32_bf16 a[24:27], v[120:123], a[252:255], a[24:27]
    v_mfma_f32_16x16x32_bf16 a[28:31], v[124:127], a[252:255], a[28:31]
    v_mfma_f32_16x16x32_bf16 a[28:31], v[140:143], a[248:251], a[28:31]
    v_mfma_f32_16x16x32_bf16 a[28:31], v[188:191], a[84:87], a[28:31]
    s_add_u32 m0, s0, 77824
    buffer_store_dwordx4 v[204:207], v18, s[20:23], s1 offen offset:3072 sc1
    v_mfma_f32_16x16x32_bf16 a[28:31], v[172:175], a[80:83], a[28:31]
    s_waitcnt lgkmcnt(3)
    s_add_u32 s68, s92, 202752
    v_mfma_f32_16x16x32_bf16 a[28:31], a[100:103], a[64:67], a[28:31]
    s_waitcnt lgkmcnt(2)
    ds_read_b128 a[80:83], v6 offset:45056
    v_mfma_f32_16x16x32_bf16 a[28:31], a[116:119], a[68:71], a[28:31]
    s_waitcnt lgkmcnt(2)
    buffer_load_dwordx4 v10, s[24:27], s68 offen offset:0 sc1 lds
    v_mfma_f32_16x16x32_bf16 a[28:31], a[132:135], a[72:75], a[28:31]
    s_waitcnt lgkmcnt(1)
    ds_read_b128 a[84:87], v6 offset:46080
    v_mfma_f32_16x16x32_bf16 a[28:31], a[148:151], a[76:79], a[28:31]
    v_mfma_f32_16x16x32_bf16 a[24:27], a[144:147], a[76:79], a[24:27]
    ds_read_b128 a[248:251], v6 offset:47104
    v_mfma_f32_16x16x32_bf16 a[24:27], a[128:131], a[72:75], a[24:27]
    v_mfma_f32_16x16x32_bf16 a[24:27], a[112:115], a[68:71], a[24:27]
    ds_read_b128 a[252:255], v6 offset:48128
    v_mfma_f32_16x16x32_bf16 a[24:27], a[96:99], a[64:67], a[24:27]
    s_add_u32 s68, s93, 200704
    v_mfma_f32_16x16x32_bf16 a[20:23], a[92:95], a[64:67], a[20:23]
    v_mfma_f32_16x16x32_bf16 a[20:23], a[108:111], a[68:71], a[20:23]
    buffer_load_dwordx4 v10, s[24:27], s68 offen offset:2048 sc1 lds
    v_mfma_f32_16x16x32_bf16 a[20:23], a[124:127], a[72:75], a[20:23]
    v_mfma_f32_16x16x32_bf16 a[20:23], a[140:143], a[76:79], a[20:23]
    v_mfma_f32_16x16x32_bf16 a[16:19], a[136:139], a[76:79], a[16:19]
    v_mfma_f32_16x16x32_bf16 a[16:19], a[120:123], a[72:75], a[16:19]
    v_mfma_f32_16x16x32_bf16 a[16:19], a[104:107], a[68:71], a[16:19]
    s_waitcnt vmcnt(12) lgkmcnt(0)
    s_add_u32 m0, s0, 98304
    v_mfma_f32_16x16x32_bf16 a[16:19], a[88:91], a[64:67], a[16:19]
    s_barrier
    s_add_u32 s68, s92, 105472
    v_mfma_f32_16x16x32_bf16 a[16:19], a[152:155], a[80:83], a[16:19]
    ds_read_b128 a[64:67], v7 offset:0
    v_mfma_f32_16x16x32_bf16 a[16:19], a[168:171], a[84:87], a[16:19]
    buffer_load_dwordx4 v10, s[24:27], s68 offen offset:0 sc1 lds
    v_mfma_f32_16x16x32_bf16 a[16:19], a[184:187], a[248:251], a[16:19]
    ds_read_b128 a[68:71], v7 offset:1024
    v_mfma_f32_16x16x32_bf16 a[16:19], a[200:203], a[252:255], a[16:19]
    v_mfma_f32_16x16x32_bf16 a[20:23], a[204:207], a[252:255], a[20:23]
    ds_read_b128 a[72:75], v7 offset:2048
    v_mfma_f32_16x16x32_bf16 a[20:23], a[188:191], a[248:251], a[20:23]
    v_mfma_f32_16x16x32_bf16 a[20:23], a[172:175], a[84:87], a[20:23]
    ds_read_b128 a[76:79], v7 offset:3072
    v_mfma_f32_16x16x32_bf16 a[20:23], a[156:159], a[80:83], a[20:23]
    s_add_u32 s68, s93, 103424
    v_mfma_f32_16x16x32_bf16 a[24:27], a[160:163], a[80:83], a[24:27]
    v_mfma_f32_16x16x32_bf16 a[24:27], a[176:179], a[84:87], a[24:27]
    buffer_load_dwordx4 v10, s[24:27], s68 offen offset:2048 sc1 lds
    v_mfma_f32_16x16x32_bf16 a[24:27], a[192:195], a[248:251], a[24:27]
    v_mfma_f32_16x16x32_bf16 a[24:27], a[208:211], a[252:255], a[24:27]
    v_mfma_f32_16x16x32_bf16 a[28:31], a[212:215], a[252:255], a[28:31]
    v_mfma_f32_16x16x32_bf16 a[28:31], a[196:199], a[248:251], a[28:31]
    v_mfma_f32_16x16x32_bf16 a[28:31], a[180:183], a[84:87], a[28:31]
    s_add_u32 m0, s0, 102400
    v_mfma_f32_16x16x32_bf16 a[28:31], a[164:167], a[80:83], a[28:31]
    s_waitcnt lgkmcnt(3)
    s_add_u32 s68, s92, 138240
    v_mfma_f32_16x16x32_bf16 v[220:223], v[92:95], a[64:67], v[220:223]
    s_waitcnt lgkmcnt(2)
    ds_read_b128 a[80:83], v7 offset:4096
    v_mfma_f32_16x16x32_bf16 v[220:223], v[108:111], a[68:71], v[220:223]
    s_waitcnt lgkmcnt(2)
    buffer_load_dwordx4 v10, s[24:27], s68 offen offset:0 sc1 lds
    v_mfma_f32_16x16x32_bf16 v[220:223], v[76:79], a[72:75], v[220:223]
    s_waitcnt lgkmcnt(1)
    ds_read_b128 a[84:87], v7 offset:5120
    v_mfma_f32_16x16x32_bf16 v[220:223], v[156:159], a[76:79], v[220:223]
    v_mfma_f32_16x16x32_bf16 v[216:219], v[152:155], a[76:79], v[216:219]
    ds_read_b128 a[248:251], v7 offset:6144
    v_mfma_f32_16x16x32_bf16 v[216:219], v[72:75], a[72:75], v[216:219]
    v_mfma_f32_16x16x32_bf16 v[216:219], v[104:107], a[68:71], v[216:219]
    ds_write_b32 v8, a16 offset:4096
    v_mfma_f32_16x16x32_bf16 v[216:219], v[88:91], a[64:67], v[216:219]
    s_add_u32 s68, s93, 136192
    ds_write_b32 v8, a17 offset:4352
    v_mfma_f32_16x16x32_bf16 v[212:215], v[84:87], a[64:67], v[212:215]
    ds_read_b128 a[252:255], v7 offset:7168
    v_mfma_f32_16x16x32_bf16 v[212:215], v[100:103], a[68:71], v[212:215]
    buffer_load_dwordx4 v10, s[24:27], s68 offen offset:2048 sc1 lds
    v_mfma_f32_16x16x32_bf16 v[212:215], v[68:71], a[72:75], v[212:215]
    ds_write_b32 v8, a18 offset:4608
    v_mfma_f32_16x16x32_bf16 v[212:215], v[148:151], a[76:79], v[212:215]
    ds_write_b32 v8, a19 offset:4864
    v_mfma_f32_16x16x32_bf16 v[208:211], v[144:147], a[76:79], v[208:211]
    ds_write_b32 v8, a20 offset:5120
    v_mfma_f32_16x16x32_bf16 v[208:211], v[64:67], a[72:75], v[208:211]
    ds_write_b32 v8, a21 offset:5376
    v_mfma_f32_16x16x32_bf16 v[208:211], v[96:99], a[68:71], v[208:211]
    s_add_u32 m0, s0, 106496
    v_mfma_f32_16x16x32_bf16 v[208:211], v[80:83], a[64:67], v[208:211]
    s_waitcnt lgkmcnt(9)
    ds_write_b32 v8, a22 offset:5632
    s_add_u32 s68, s92, 171008
    v_mfma_f32_16x16x32_bf16 v[208:211], v[160:163], a[80:83], v[208:211]
    s_waitcnt lgkmcnt(9)
    ds_write_b32 v8, a23 offset:5888
    v_mfma_f32_16x16x32_bf16 v[208:211], v[176:179], a[84:87], v[208:211]
    s_waitcnt lgkmcnt(9)
    buffer_load_dwordx4 v10, s[24:27], s68 offen offset:0 sc1 lds
    v_mfma_f32_16x16x32_bf16 v[208:211], v[128:131], a[248:251], v[208:211]
    s_waitcnt lgkmcnt(6)
    ds_read_b128 a[64:67], v7 offset:8192
    v_mfma_f32_16x16x32_bf16 v[208:211], v[112:115], a[252:255], v[208:211]
    ds_write_b32 v8, a24 offset:6144
    v_mfma_f32_16x16x32_bf16 v[212:215], v[116:119], a[252:255], v[212:215]
    ds_write_b32 v8, a25 offset:6400
    v_mfma_f32_16x16x32_bf16 v[212:215], v[132:135], a[248:251], v[212:215]
    ds_read_b128 a[68:71], v7 offset:9216
    v_mfma_f32_16x16x32_bf16 v[212:215], v[180:183], a[84:87], v[212:215]
    ds_write_b32 v8, a26 offset:6656
    v_mfma_f32_16x16x32_bf16 v[212:215], v[164:167], a[80:83], v[212:215]
    s_add_u32 s68, s93, 168960
    ds_read_b128 a[72:75], v7 offset:10240
    v_mfma_f32_16x16x32_bf16 v[216:219], v[168:171], a[80:83], v[216:219]
    ds_write_b32 v8, a27 offset:6912
    v_mfma_f32_16x16x32_bf16 v[216:219], v[184:187], a[84:87], v[216:219]
    ds_read_b128 a[76:79], v7 offset:11264
    v_mfma_f32_16x16x32_bf16 v[216:219], v[136:139], a[248:251], v[216:219]
    ds_write_b32 v8, a28 offset:7168
    v_mfma_f32_16x16x32_bf16 v[216:219], v[120:123], a[252:255], v[216:219]
    buffer_load_dwordx4 v10, s[24:27], s68 offen offset:2048 sc1 lds
    ds_write_b32 v8, a29 offset:7424
    v_mfma_f32_16x16x32_bf16 v[220:223], v[124:127], a[252:255], v[220:223]
    ds_write_b32 v8, a30 offset:7680
    v_mov_b32 v2, 1
    v_mfma_f32_16x16x32_bf16 v[220:223], v[140:143], a[248:251], v[220:223]
    s_waitcnt vmcnt(8)
    ds_write_b32 v8, a31 offset:7936
    v_mfma_f32_16x16x32_bf16 v[220:223], v[188:191], a[84:87], v[220:223]
    s_add_u32 m0, s0, 110592
    s_mov_b64 exec, 1
    buffer_store_dword v2, off, s[32:35], s42 sc1
    s_mov_b64 exec, -1
    v_mfma_f32_16x16x32_bf16 v[220:223], v[172:175], a[80:83], v[220:223]
    s_waitcnt lgkmcnt(11)
    s_add_u32 s68, s92, 203776
    v_mfma_f32_16x16x32_bf16 v[220:223], a[100:103], a[64:67], v[220:223]
    s_waitcnt lgkmcnt(8)
    ds_read_b128 a[80:83], v7 offset:12288
    v_mfma_f32_16x16x32_bf16 v[220:223], a[116:119], a[68:71], v[220:223]
    s_waitcnt lgkmcnt(7)
    buffer_load_dwordx4 v10, s[24:27], s68 offen offset:0 sc1 lds
    v_mfma_f32_16x16x32_bf16 v[220:223], a[132:135], a[72:75], v[220:223]
    s_waitcnt lgkmcnt(5)
    ds_read_b128 a[84:87], v7 offset:13312
    v_mfma_f32_16x16x32_bf16 v[220:223], a[148:151], a[76:79], v[220:223]
    v_mfma_f32_16x16x32_bf16 v[216:219], a[144:147], a[76:79], v[216:219]
    ds_read_b128 a[248:251], v7 offset:14336
    v_mfma_f32_16x16x32_bf16 v[216:219], a[128:131], a[72:75], v[216:219]
    v_mfma_f32_16x16x32_bf16 v[216:219], a[112:115], a[68:71], v[216:219]
    ds_read_b128 a[252:255], v7 offset:15360
    v_mfma_f32_16x16x32_bf16 v[216:219], a[96:99], a[64:67], v[216:219]
    s_add_u32 s68, s93, 201728
    v_mfma_f32_16x16x32_bf16 v[212:215], a[92:95], a[64:67], v[212:215]
    v_mfma_f32_16x16x32_bf16 v[212:215], a[108:111], a[68:71], v[212:215]
    buffer_load_dwordx4 v10, s[24:27], s68 offen offset:2048 sc1 lds
    v_mfma_f32_16x16x32_bf16 v[212:215], a[124:127], a[72:75], v[212:215]
    v_mfma_f32_16x16x32_bf16 v[212:215], a[140:143], a[76:79], v[212:215]
    v_mfma_f32_16x16x32_bf16 v[208:211], a[136:139], a[76:79], v[208:211]
    v_mfma_f32_16x16x32_bf16 v[208:211], a[120:123], a[72:75], v[208:211]
    v_mfma_f32_16x16x32_bf16 v[208:211], a[104:107], a[68:71], v[208:211]
    s_waitcnt vmcnt(9) lgkmcnt(0)
    s_add_u32 m0, s0, 131072
    v_mfma_f32_16x16x32_bf16 v[208:211], a[88:91], a[64:67], v[208:211]
    s_barrier
    s_add_u32 s68, s92, 106496
    v_mfma_f32_16x16x32_bf16 v[208:211], a[152:155], a[80:83], v[208:211]
    ds_read_b128 a[64:67], v6 offset:0
    v_mfma_f32_16x16x32_bf16 v[208:211], a[168:171], a[84:87], v[208:211]
    buffer_load_dwordx4 v10, s[24:27], s68 offen offset:0 sc1 lds
    v_mfma_f32_16x16x32_bf16 v[208:211], a[184:187], a[248:251], v[208:211]
    ds_read2st64_b32 v[32:33], v9 offset0:16 offset1:17
    v_mfma_f32_16x16x32_bf16 v[208:211], a[200:203], a[252:255], v[208:211]
    ds_read2st64_b32 v[34:35], v9 offset0:18 offset1:19
    v_mfma_f32_16x16x32_bf16 v[212:215], a[204:207], a[252:255], v[212:215]
    ds_read_b128 a[68:71], v6 offset:1024
    v_mfma_f32_16x16x32_bf16 v[212:215], a[188:191], a[248:251], v[212:215]
    ds_read2st64_b32 v[36:37], v9 offset0:20 offset1:21
    v_mfma_f32_16x16x32_bf16 v[212:215], a[172:175], a[84:87], v[212:215]
    ds_read_b128 a[72:75], v6 offset:2048
    v_mfma_f32_16x16x32_bf16 v[212:215], a[156:159], a[80:83], v[212:215]
    s_add_u32 s68, s93, 104448
    ds_read2st64_b32 v[38:39], v9 offset0:22 offset1:23
    v_mfma_f32_16x16x32_bf16 v[216:219], a[160:163], a[80:83], v[216:219]
    ds_read_b128 a[76:79], v6 offset:3072
    v_mfma_f32_16x16x32_bf16 v[216:219], a[176:179], a[84:87], v[216:219]
    ds_read2st64_b32 v[40:41], v9 offset0:24 offset1:25
    v_mfma_f32_16x16x32_bf16 v[216:219], a[192:195], a[248:251], v[216:219]
    buffer_load_dwordx4 v10, s[24:27], s68 offen offset:2048 sc1 lds
    v_mfma_f32_16x16x32_bf16 v[216:219], a[208:211], a[252:255], v[216:219]
    ds_read2st64_b32 v[42:43], v9 offset0:26 offset1:27
    v_mfma_f32_16x16x32_bf16 v[220:223], a[212:215], a[252:255], v[220:223]
    ds_read2st64_b32 v[44:45], v9 offset0:28 offset1:29
    v_mfma_f32_16x16x32_bf16 v[220:223], a[196:199], a[248:251], v[220:223]
    ds_read2st64_b32 v[46:47], v9 offset0:30 offset1:31
    v_mfma_f32_16x16x32_bf16 v[220:223], a[180:183], a[84:87], v[220:223]
    s_add_u32 m0, s0, 135168
    v_mfma_f32_16x16x32_bf16 v[220:223], a[164:167], a[80:83], v[220:223]
    s_waitcnt lgkmcnt(11)
    s_add_u32 s68, s92, 139264
    v_mfma_f32_16x16x32_bf16 a[44:47], v[92:95], a[64:67], a[44:47]
    s_waitcnt lgkmcnt(8)
    ds_read_b128 a[80:83], v6 offset:4096
    v_mfma_f32_16x16x32_bf16 a[44:47], v[108:111], a[68:71], a[44:47]
    s_waitcnt lgkmcnt(7)
    buffer_load_dwordx4 v10, s[24:27], s68 offen offset:0 sc1 lds
    v_mfma_f32_16x16x32_bf16 a[44:47], v[76:79], a[72:75], a[44:47]
    s_waitcnt lgkmcnt(5)
    ds_read_b128 a[84:87], v6 offset:5120
    v_mfma_f32_16x16x32_bf16 a[44:47], v[156:159], a[76:79], a[44:47]
    s_waitcnt lgkmcnt(2)
    v_mfma_f32_16x16x32_bf16 a[40:43], v[152:155], a[76:79], a[40:43]
    ds_read_b128 a[248:251], v6 offset:6144
    v_add_f32 v208, v208, v32
    v_add_f32 v209, v209, v33
    v_mfma_f32_16x16x32_bf16 a[40:43], v[72:75], a[72:75], a[40:43]
    v_add_f32 v210, v210, v34
    v_add_f32 v211, v211, v35
    v_mfma_f32_16x16x32_bf16 a[40:43], v[104:107], a[68:71], a[40:43]
    buffer_store_dwordx4 v[208:211], v19, s[20:23], s1 offen offset:0 sc1
    v_add_f32 v212, v212, v36
    v_add_f32 v213, v213, v37
    v_mfma_f32_16x16x32_bf16 a[40:43], v[88:91], a[64:67], a[40:43]
    s_add_u32 s68, s93, 137216
    ds_read_b128 a[252:255], v6 offset:7168
    v_add_f32 v214, v214, v38
    v_add_f32 v215, v215, v39
    v_mfma_f32_16x16x32_bf16 a[36:39], v[84:87], a[64:67], a[36:39]
    v_add_f32 v216, v216, v40
    v_add_f32 v217, v217, v41
    v_mfma_f32_16x16x32_bf16 a[36:39], v[100:103], a[68:71], a[36:39]
    buffer_load_dwordx4 v10, s[24:27], s68 offen offset:2048 sc1 lds
    v_add_f32 v218, v218, v42
    v_add_f32 v219, v219, v43
    v_mfma_f32_16x16x32_bf16 a[36:39], v[68:71], a[72:75], a[36:39]
    buffer_store_dwordx4 v[212:215], v19, s[20:23], s1 offen offset:1024 sc1
    v_add_f32 v220, v220, v44
    v_add_f32 v221, v221, v45
    v_mfma_f32_16x16x32_bf16 a[36:39], v[148:151], a[76:79], a[36:39]
    v_add_f32 v222, v222, v46
    v_add_f32 v223, v223, v47
    v_mfma_f32_16x16x32_bf16 a[32:35], v[144:147], a[76:79], a[32:35]
    v_mfma_f32_16x16x32_bf16 a[32:35], v[64:67], a[72:75], a[32:35]
    v_mfma_f32_16x16x32_bf16 a[32:35], v[96:99], a[68:71], a[32:35]
    s_add_u32 m0, s0, 139264
    buffer_store_dwordx4 v[216:219], v19, s[20:23], s1 offen offset:2048 sc1
    v_mfma_f32_16x16x32_bf16 a[32:35], v[80:83], a[64:67], a[32:35]
    s_waitcnt lgkmcnt(3)
    s_add_u32 s68, s92, 172032
    v_mfma_f32_16x16x32_bf16 a[32:35], v[160:163], a[80:83], a[32:35]
    s_waitcnt lgkmcnt(2)
    ds_read_b128 a[64:67], v6 offset:8192
    v_mfma_f32_16x16x32_bf16 a[32:35], v[176:179], a[84:87], a[32:35]
    s_waitcnt lgkmcnt(2)
    buffer_load_dwordx4 v10, s[24:27], s68 offen offset:0 sc1 lds
    v_mfma_f32_16x16x32_bf16 a[32:35], v[128:131], a[248:251], a[32:35]
    s_waitcnt lgkmcnt(1)
    buffer_store_dwordx4 v[220:223], v19, s[20:23], s1 offen offset:3072 sc1
    v_mfma_f32_16x16x32_bf16 a[32:35], v[112:115], a[252:255], a[32:35]
    ds_read_b128 a[68:71], v6 offset:9216
    v_mfma_f32_16x16x32_bf16 a[36:39], v[116:119], a[252:255], a[36:39]
    ds_read_b128 a[72:75], v6 offset:10240
    v_mfma_f32_16x16x32_bf16 a[36:39], v[132:135], a[248:251], a[36:39]
L_pad11:
    s_cbranch_vccnz L_warm
    v_mfma_f32_16x16x32_bf16 a[36:39], v[180:183], a[84:87], a[36:39]
    ds_read_b128 a[76:79], v6 offset:11264
    v_mfma_f32_16x16x32_bf16 a[36:39], v[164:167], a[80:83], a[36:39]
    s_add_u32 s68, s93, 169984
    v_mfma_f32_16x16x32_bf16 a[40:43], v[168:171], a[80:83], a[40:43]
    v_mfma_f32_16x16x32_bf16 a[40:43], v[184:187], a[84:87], a[40:43]
    buffer_load_dwordx4 v10, s[24:27], s68 offen offset:2048 sc1 lds
    v_mfma_f32_16x16x32_bf16 a[40:43], v[136:139], a[248:251], a[40:43]
    v_mfma_f32_16x16x32_bf16 a[40:43], v[120:123], a[252:255], a[40:43]
    v_mfma_f32_16x16x32_bf16 a[44:47], v[124:127], a[252:255], a[44:47]
    v_mfma_f32_16x16x32_bf16 a[44:47], v[140:143], a[248:251], a[44:47]
    v_mfma_f32_16x16x32_bf16 a[44:47], v[188:191], a[84:87], a[44:47]
    s_add_u32 m0, s0, 143360
    v_mfma_f32_16x16x32_bf16 a[44:47], v[172:175], a[80:83], a[44:47]
    s_waitcnt lgkmcnt(3)
    s_add_u32 s68, s92, 204800
    v_mfma_f32_16x16x32_bf16 a[44:47], a[100:103], a[64:67], a[44:47]
    s_waitcnt lgkmcnt(2)
    ds_read_b128 a[80:83], v6 offset:12288
    v_mfma_f32_16x16x32_bf16 a[44:47], a[116:119], a[68:71], a[44:47]
    s_waitcnt lgkmcnt(2)
    buffer_load_dwordx4 v10, s[24:27], s68 offen offset:0 sc1 lds
    v_mfma_f32_16x16x32_bf16 a[44:47], a[132:135], a[72:75], a[44:47]
    s_waitcnt lgkmcnt(1)
    ds_read_b128 a[84:87], v6 offset:13312
    v_mfma_f32_16x16x32_bf16 a[44:47], a[148:151], a[76:79], a[44:47]
    v_mfma_f32_16x16x32_bf16 a[40:43], a[144:147], a[76:79], a[40:43]
    ds_read_b128 a[248:251], v6 offset:14336
    v_mfma_f32_16x16x32_bf16 a[40:43], a[128:131], a[72:75], a[40:43]
    v_mfma_f32_16x16x32_bf16 a[40:43], a[112:115], a[68:71], a[40:43]
    ds_read_b128 a[252:255], v6 offset:15360
    v_mfma_f32_16x16x32_bf16 a[40:43], a[96:99], a[64:67], a[40:43]
    s_add_u32 s68, s93, 202752
    v_mfma_f32_16x16x32_bf16 a[36:39], a[92:95], a[64:67], a[36:39]
    v_mfma_f32_16x16x32_bf16 a[36:39], a[108:111], a[68:71], a[36:39]
    buffer_load_dwordx4 v10, s[24:27], s68 offen offset:2048 sc1 lds
    v_mfma_f32_16x16x32_bf16 a[36:39], a[124:127], a[72:75], a[36:39]
    v_mfma_f32_16x16x32_bf16 a[36:39], a[140:143], a[76:79], a[36:39]
    v_mfma_f32_16x16x32_bf16 a[32:35], a[136:139], a[76:79], a[32:35]
    v_mfma_f32_16x16x32_bf16 a[32:35], a[120:123], a[72:75], a[32:35]
    v_mfma_f32_16x16x32_bf16 a[32:35], a[104:107], a[68:71], a[32:35]
    s_waitcnt vmcnt(12) lgkmcnt(0)
    s_add_u32 m0, s0, 65536
    v_mfma_f32_16x16x32_bf16 a[32:35], a[88:91], a[64:67], a[32:35]
    s_barrier
    s_add_u32 s68, s92, 107520
    v_mfma_f32_16x16x32_bf16 a[32:35], a[152:155], a[80:83], a[32:35]
    ds_read_b128 a[64:67], v6 offset:32768
    v_mfma_f32_16x16x32_bf16 a[32:35], a[168:171], a[84:87], a[32:35]
    buffer_load_dwordx4 v10, s[24:27], s68 offen offset:0 sc1 lds
    v_mfma_f32_16x16x32_bf16 a[32:35], a[184:187], a[248:251], a[32:35]
    ds_read_b128 a[68:71], v6 offset:33792
    v_mfma_f32_16x16x32_bf16 a[32:35], a[200:203], a[252:255], a[32:35]
    v_mfma_f32_16x16x32_bf16 a[36:39], a[204:207], a[252:255], a[36:39]
    ds_read_b128 a[72:75], v6 offset:34816
    v_mfma_f32_16x16x32_bf16 a[36:39], a[188:191], a[248:251], a[36:39]
    v_mfma_f32_16x16x32_bf16 a[36:39], a[172:175], a[84:87], a[36:39]
    ds_read_b128 a[76:79], v6 offset:35840
    v_mfma_f32_16x16x32_bf16 a[36:39], a[156:159], a[80:83], a[36:39]
    s_add_u32 s68, s93, 105472
    v_mfma_f32_16x16x32_bf16 a[40:43], a[160:163], a[80:83], a[40:43]
    buffer_load_dword v21, off, s[32:35], s43 sc1
    v_mfma_f32_16x16x32_bf16 a[40:43], a[176:179], a[84:87], a[40:43]
    buffer_load_dwordx4 v10, s[24:27], s68 offen offset:2048 sc1 lds
    v_mfma_f32_16x16x32_bf16 a[40:43], a[192:195], a[248:251], a[40:43]
    v_mfma_f32_16x16x32_bf16 a[40:43], a[208:211], a[252:255], a[40:43]
    v_mfma_f32_16x16x32_bf16 a[44:47], a[212:215], a[252:255], a[44:47]
    v_mfma_f32_16x16x32_bf16 a[44:47], a[196:199], a[248:251], a[44:47]
    v_mfma_f32_16x16x32_bf16 a[44:47], a[180:183], a[84:87], a[44:47]
    s_add_u32 m0, s0, 69632
    v_mfma_f32_16x16x32_bf16 a[44:47], a[164:167], a[80:83], a[44:47]
    s_waitcnt lgkmcnt(3)
    s_add_u32 s68, s92, 140288
    v_mfma_f32_16x16x32_bf16 a[60:63], v[92:95], a[64:67], a[60:63]
    s_waitcnt lgkmcnt(2)
    ds_read_b128 a[80:83], v6 offset:36864
    v_mfma_f32_16x16x32_bf16 a[60:63], v[108:111], a[68:71], a[60:63]
    s_waitcnt lgkmcnt(2)
    buffer_load_dwordx4 v10, s[24:27], s68 offen offset:0 sc1 lds
    v_mfma_f32_16x16x32_bf16 a[60:63], v[76:79], a[72:75], a[60:63]
    s_waitcnt lgkmcnt(1)
    ds_read_b128 a[84:87], v6 offset:37888
    v_mov_b32 v2, 2
    v_mfma_f32_16x16x32_bf16 a[60:63], v[156:159], a[76:79], a[60:63]
    s_waitcnt vmcnt(7)
    v_mfma_f32_16x16x32_bf16 a[56:59], v[152:155], a[76:79], a[56:59]
    ds_read_b128 a[248:251], v6 offset:38912
    s_mov_b64 exec, 1
    buffer_store_dword v2, off, s[32:35], s42 sc1
    s_mov_b64 exec, -1
    v_mfma_f32_16x16x32_bf16 a[56:59], v[72:75], a[72:75], a[56:59]
    v_mfma_f32_16x16x32_bf16 a[56:59], v[104:107], a[68:71], a[56:59]
    ds_write_b32 v8, a32 offset:8192
    v_mfma_f32_16x16x32_bf16 a[56:59], v[88:91], a[64:67], a[56:59]
    s_add_u32 s68, s93, 138240
    ds_write_b32 v8, a33 offset:8448
    v_mfma_f32_16x16x32_bf16 a[52:55], v[84:87], a[64:67], a[52:55]
    ds_read_b128 a[252:255], v6 offset:39936
    v_mfma_f32_16x16x32_bf16 a[52:55], v[100:103], a[68:71], a[52:55]
    buffer_load_dwordx4 v10, s[24:27], s68 offen offset:2048 sc1 lds
    v_mfma_f32_16x16x32_bf16 a[52:55], v[68:71], a[72:75], a[52:55]
    ds_write_b32 v8, a34 offset:8704
    v_mfma_f32_16x16x32_bf16 a[52:55], v[148:151], a[76:79], a[52:55]
    ds_write_b32 v8, a35 offset:8960
    v_mfma_f32_16x16x32_bf16 a[48:51], v[144:147], a[76:79], a[48:51]
    ds_write_b32 v8, a36 offset:9216
    v_mfma_f32_16x16x32_bf16 a[48:51], v[64:67], a[72:75], a[48:51]
    ds_write_b32 v8, a37 offset:9472
    v_mfma_f32_16x16x32_bf16 a[48:51], v[96:99], a[68:71], a[48:51]
    s_add_u32 m0, s0, 73728
    v_mfma_f32_16x16x32_bf16 a[48:51], v[80:83], a[64:67], a[48:51]
    s_waitcnt lgkmcnt(9)
    ds_write_b32 v8, a38 offset:9728
    s_add_u32 s68, s92, 173056
    v_mfma_f32_16x16x32_bf16 a[48:51], v[160:163], a[80:83], a[48:51]
    s_waitcnt lgkmcnt(9)
    ds_write_b32 v8, a39 offset:9984
    v_mfma_f32_16x16x32_bf16 a[48:51], v[176:179], a[84:87], a[48:51]
    s_waitcnt lgkmcnt(9)
    buffer_load_dwordx4 v10, s[24:27], s68 offen offset:0 sc1 lds
    v_mfma_f32_16x16x32_bf16 a[48:51], v[128:131], a[248:251], a[48:51]
    s_waitcnt lgkmcnt(6)
    ds_read_b128 a[64:67], v6 offset:40960
    v_mfma_f32_16x16x32_bf16 a[48:51], v[112:115], a[252:255], a[48:51]
    ds_write_b32 v8, a40 offset:10240
    v_mfma_f32_16x16x32_bf16 a[52:55], v[116:119], a[252:255], a[52:55]
    ds_write_b32 v8, a41 offset:10496
    v_mfma_f32_16x16x32_bf16 a[52:55], v[132:135], a[248:251], a[52:55]
    ds_read_b128 a[68:71], v6 offset:41984
    v_mfma_f32_16x16x32_bf16 a[52:55], v[180:183], a[84:87], a[52:55]
    ds_write_b32 v8, a42 offset:10752
    v_mfma_f32_16x16x32_bf16 a[52:55], v[164:167], a[80:83], a[52:55]
    s_add_u32 s68, s93, 171008
    ds_read_b128 a[72:75], v6 offset:43008
    v_mfma_f32_16x16x32_bf16 a[56:59], v[168:171], a[80:83], a[56:59]
    ds_write_b32 v8, a43 offset:11008
    v_mfma_f32_16x16x32_bf16 a[56:59], v[184:187], a[84:87], a[56:59]
    ds_read_b128 a[76:79], v6 offset:44032
    v_mfma_f32_16x16x32_bf16 a[56:59], v[136:139], a[248:251], a[56:59]
    ds_write_b32 v8, a44 offset:11264
    v_mfma_f32_16x16x32_bf16 a[56:59], v[120:123], a[252:255], a[56:59]
    buffer_load_dwordx4 v10, s[24:27], s68 offen offset:2048 sc1 lds
    ds_write_b32 v8, a45 offset:11520
    v_mfma_f32_16x16x32_bf16 a[60:63], v[124:127], a[252:255], a[60:63]
    ds_write_b32 v8, a46 offset:11776
    v_mfma_f32_16x16x32_bf16 a[60:63], v[140:143], a[248:251], a[60:63]
    ds_write_b32 v8, a47 offset:12032
    v_mfma_f32_16x16x32_bf16 a[60:63], v[188:191], a[84:87], a[60:63]
    s_add_u32 m0, s0, 77824
    v_mfma_f32_16x16x32_bf16 a[60:63], v[172:175], a[80:83], a[60:63]
    s_waitcnt lgkmcnt(11)
    s_add_u32 s68, s92, 205824
    v_mfma_f32_16x16x32_bf16 a[60:63], a[100:103], a[64:67], a[60:63]
    s_waitcnt lgkmcnt(8)
    ds_read_b128 a[80:83], v6 offset:45056
    v_mfma_f32_16x16x32_bf16 a[60:63], a[116:119], a[68:71], a[60:63]
    s_waitcnt lgkmcnt(7)
    buffer_load_dwordx4 v10, s[24:27], s68 offen offset:0 sc1 lds
    v_mfma_f32_16x16x32_bf16 a[60:63], a[132:135], a[72:75], a[60:63]
    s_waitcnt lgkmcnt(5)
    ds_read_b128 a[84:87], v6 offset:46080
    v_mfma_f32_16x16x32_bf16 a[60:63], a[148:151], a[76:79], a[60:63]
    v_mfma_f32_16x16x32_bf16 a[56:59], a[144:147], a[76:79], a[56:59]
    ds_read_b128 a[248:251], v6 offset:47104
    v_mfma_f32_16x16x32_bf16 a[56:59], a[128:131], a[72:75], a[56:59]
    v_mfma_f32_16x16x32_bf16 a[56:59], a[112:115], a[68:71], a[56:59]
    ds_read_b128 a[252:255], v6 offset:48128
    v_mfma_f32_16x16x32_bf16 a[56:59], a[96:99], a[64:67], a[56:59]
    s_add_u32 s68, s93, 203776
    v_mfma_f32_16x16x32_bf16 a[52:55], a[92:95], a[64:67], a[52:55]
    v_mfma_f32_16x16x32_bf16 a[52:55], a[108:111], a[68:71], a[52:55]
    s_waitcnt vmcnt(7)
    buffer_load_dwordx4 v10, s[24:27], s68 offen offset:2048 sc1 lds
    v_mfma_f32_16x16x32_bf16 a[52:55], a[124:127], a[72:75], a[52:55]
    v_cmp_gt_u32 vcc, 1, v21
    s_cbranch_vccnz L_slow_fx0
L_back_fx0:
    v_mfma_f32_16x16x32_bf16 a[52:55], a[140:143], a[76:79], a[52:55]
    buffer_load_dwordx4 v[192:195], v18, s[20:23], s41 offen offset:0 sc1
    v_mfma_f32_16x16x32_bf16 a[48:51], a[136:139], a[76:79], a[48:51]
    buffer_load_dwordx4 v[196:199], v18, s[20:23], s41 offen offset:1024 sc1
    v_mfma_f32_16x16x32_bf16 a[48:51], a[120:123], a[72:75], a[48:51]
    buffer_load_dwordx4 v[200:203], v18, s[20:23], s41 offen offset:2048 sc1
    v_mfma_f32_16x16x32_bf16 a[48:51], a[104:107], a[68:71], a[48:51]
    s_waitcnt lgkmcnt(0)
    buffer_load_dwordx4 v[204:207], v18, s[20:23], s41 offen offset:3072 sc1
    v_mfma_f32_16x16x32_bf16 a[48:51], a[88:91], a[64:67], a[48:51]
    s_barrier
    v_mfma_f32_16x16x32_bf16 a[48:51], a[152:155], a[80:83], a[48:51]
    ds_read_b128 a[64:67], v7 offset:0
    v_mfma_f32_16x16x32_bf16 a[48:51], a[168:171], a[84:87], a[48:51]
    ds_read2st64_b32 v[48:49], v9 offset0:32 offset1:33
    v_mfma_f32_16x16x32_bf16 a[48:51], a[184:187], a[248:251], a[48:51]
    ds_read2st64_b32 v[50:51], v9 offset0:34 offset1:35
    v_mfma_f32_16x16x32_bf16 a[48:51], a[200:203], a[252:255], a[48:51]
    ds_read_b128 a[68:71], v7 offset:1024
    v_mfma_f32_16x16x32_bf16 a[52:55], a[204:207], a[252:255], a[52:55]
    ds_read2st64_b32 v[52:53], v9 offset0:36 offset1:37
    v_mfma_f32_16x16x32_bf16 a[52:55], a[188:191], a[248:251], a[52:55]
    ds_read_b128 a[72:75], v7 offset:2048
    v_mfma_f32_16x16x32_bf16 a[52:55], a[172:175], a[84:87], a[52:55]
    ds_read2st64_b32 v[54:55], v9 offset0:38 offset1:39
    v_mfma_f32_16x16x32_bf16 a[52:55], a[156:159], a[80:83], a[52:55]
    ds_read_b128 a[76:79], v7 offset:3072
    v_mfma_f32_16x16x32_bf16 a[56:59], a[160:163], a[80:83], a[56:59]
    ds_read2st64_b32 v[56:57], v9 offset0:40 offset1:41
    v_mfma_f32_16x16x32_bf16 a[56:59], a[176:179], a[84:87], a[56:59]
    ds_read2st64_b32 v[58:59], v9 offset0:42 offset1:43
    v_mfma_f32_16x16x32_bf16 a[56:59], a[192:195], a[248:251], a[56:59]
    ds_read2st64_b32 v[60:61], v9 offset0:44 offset1:45
    v_mfma_f32_16x16x32_bf16 a[56:59], a[208:211], a[252:255], a[56:59]
    ds_read2st64_b32 v[62:63], v9 offset0:46 offset1:47
    v_mfma_f32_16x16x32_bf16 a[60:63], a[212:215], a[252:255], a[60:63]
    v_mfma_f32_16x16x32_bf16 a[60:63], a[196:199], a[248:251], a[60:63]
    v_mfma_f32_16x16x32_bf16 a[60:63], a[180:183], a[84:87], a[60:63]
    v_mfma_f32_16x16x32_bf16 a[60:63], a[164:167], a[80:83], a[60:63]
    s_waitcnt lgkmcnt(11)
    v_mfma_f32_16x16x32_bf16 v[236:239], v[92:95], a[64:67], v[236:239]
    s_waitcnt lgkmcnt(8)
    ds_read_b128 a[80:83], v7 offset:4096
    v_mfma_f32_16x16x32_bf16 v[236:239], v[108:111], a[68:71], v[236:239]
    s_waitcnt lgkmcnt(7)
    v_mfma_f32_16x16x32_bf16 v[236:239], v[76:79], a[72:75], v[236:239]
    s_waitcnt lgkmcnt(5)
    ds_read_b128 a[84:87], v7 offset:5120
    v_mfma_f32_16x16x32_bf16 v[236:239], v[156:159], a[76:79], v[236:239]
    v_mfma_f32_16x16x32_bf16 v[232:235], v[152:155], a[76:79], v[232:235]
    ds_read_b128 a[248:251], v7 offset:6144
    v_mfma_f32_16x16x32_bf16 v[232:235], v[72:75], a[72:75], v[232:235]
    v_mfma_f32_16x16x32_bf16 v[232:235], v[104:107], a[68:71], v[232:235]
    ds_write_b32 v8, a48 offset:12288
    v_mfma_f32_16x16x32_bf16 v[232:235], v[88:91], a[64:67], v[232:235]
    ds_write_b32 v8, a49 offset:12544
    v_mfma_f32_16x16x32_bf16 v[228:231], v[84:87], a[64:67], v[228:231]
    ds_read_b128 a[252:255], v7 offset:7168
    v_mfma_f32_16x16x32_bf16 v[228:231], v[100:103], a[68:71], v[228:231]
    ds_write_b32 v8, a50 offset:12800
    v_mfma_f32_16x16x32_bf16 v[228:231], v[68:71], a[72:75], v[228:231]
    ds_write_b32 v8, a51 offset:13056
    v_mfma_f32_16x16x32_bf16 v[228:231], v[148:151], a[76:79], v[228:231]
    v_mfma_f32_16x16x32_bf16 v[224:227], v[144:147], a[76:79], v[224:227]
    ds_write_b32 v8, a52 offset:13312
    v_mfma_f32_16x16x32_bf16 v[224:227], v[64:67], a[72:75], v[224:227]
    ds_write_b32 v8, a53 offset:13568
    v_mfma_f32_16x16x32_bf16 v[224:227], v[96:99], a[68:71], v[224:227]
    v_mfma_f32_16x16x32_bf16 v[224:227], v[80:83], a[64:67], v[224:227]
    s_waitcnt lgkmcnt(9)
    ds_write_b32 v8, a54 offset:13824
    v_mfma_f32_16x16x32_bf16 v[224:227], v[160:163], a[80:83], v[224:227]
    s_waitcnt lgkmcnt(9)
    ds_write_b32 v8, a55 offset:14080
    v_mfma_f32_16x16x32_bf16 v[224:227], v[176:179], a[84:87], v[224:227]
    s_waitcnt lgkmcnt(9)
    ds_read_b128 a[64:67], v7 offset:8192
    v_mfma_f32_16x16x32_bf16 v[224:227], v[128:131], a[248:251], v[224:227]
    s_waitcnt lgkmcnt(7)
    ds_write_b32 v8, a56 offset:14336
    v_mfma_f32_16x16x32_bf16 v[224:227], v[112:115], a[252:255], v[224:227]
    ds_write_b32 v8, a57 offset:14592
    v_mfma_f32_16x16x32_bf16 v[228:231], v[116:119], a[252:255], v[228:231]
    ds_read_b128 a[68:71], v7 offset:9216
    v_mfma_f32_16x16x32_bf16 v[228:231], v[132:135], a[248:251], v[228:231]
    buffer_load_dword v21, off, s[32:35], s43 sc1
    v_mfma_f32_16x16x32_bf16 v[228:231], v[180:183], a[84:87], v[228:231]
    ds_write_b32 v8, a58 offset:14848
    v_mfma_f32_16x16x32_bf16 v[228:231], v[164:167], a[80:83], v[228:231]
    ds_read_b128 a[72:75], v7 offset:10240
    v_mfma_f32_16x16x32_bf16 v[232:235], v[168:171], a[80:83], v[232:235]
    ds_write_b32 v8, a59 offset:15104
    v_mfma_f32_16x16x32_bf16 v[232:235], v[184:187], a[84:87], v[232:235]
    ds_read_b128 a[76:79], v7 offset:11264
    v_mfma_f32_16x16x32_bf16 v[232:235], v[136:139], a[248:251], v[232:235]
    ds_write_b32 v8, a60 offset:15360
    v_mfma_f32_16x16x32_bf16 v[232:235], v[120:123], a[252:255], v[232:235]
    ds_write_b32 v8, a61 offset:15616
    v_mfma_f32_16x16x32_bf16 v[236:239], v[124:127], a[252:255], v[236:239]
    ds_write_b32 v8, a62 offset:15872
    v_mfma_f32_16x16x32_bf16 v[236:239], v[140:143], a[248:251], v[236:239]
    ds_write_b32 v8, a63 offset:16128
    v_mfma_f32_16x16x32_bf16 v[236:239], v[188:191], a[84:87], v[236:239]
    v_mfma_f32_16x16x32_bf16 v[236:239], v[172:175], a[80:83], v[236:239]
    s_waitcnt lgkmcnt(11)
    v_mfma_f32_16x16x32_bf16 v[236:239], a[100:103], a[64:67], v[236:239]
    s_waitcnt lgkmcnt(8)
    ds_read_b128 a[80:83], v7 offset:12288
    v_mfma_f32_16x16x32_bf16 v[236:239], a[116:119], a[68:71], v[236:239]
    s_waitcnt lgkmcnt(7)
    v_mfma_f32_16x16x32_bf16 v[236:239], a[132:135], a[72:75], v[236:239]
    s_waitcnt lgkmcnt(5)
    ds_read_b128 a[84:87], v7 offset:13312
    v_mfma_f32_16x16x32_bf16 v[236:239], a[148:151], a[76:79], v[236:239]
    v_mfma_f32_16x16x32_bf16 v[232:235], a[144:147], a[76:79], v[232:235]
    ds_read_b128 a[248:251], v7 offset:14336
    v_mfma_f32_16x16x32_bf16 v[232:235], a[128:131], a[72:75], v[232:235]
    v_mfma_f32_16x16x32_bf16 v[232:235], a[112:115], a[68:71], v[232:235]
    ds_read_b128 a[252:255], v7 offset:15360
    v_mfma_f32_16x16x32_bf16 v[232:235], a[96:99], a[64:67], v[232:235]
    v_mfma_f32_16x16x32_bf16 v[228:231], a[92:95], a[64:67], v[228:231]
    v_mfma_f32_16x16x32_bf16 v[228:231], a[108:111], a[68:71], v[228:231]
    v_mfma_f32_16x16x32_bf16 v[228:231], a[124:127], a[72:75], v[228:231]
    v_mfma_f32_16x16x32_bf16 v[228:231], a[140:143], a[76:79], v[228:231]
    v_mfma_f32_16x16x32_bf16 v[224:227], a[136:139], a[76:79], v[224:227]
    v_mfma_f32_16x16x32_bf16 v[224:227], a[120:123], a[72:75], v[224:227]
    v_mfma_f32_16x16x32_bf16 v[224:227], a[104:107], a[68:71], v[224:227]
    s_waitcnt vmcnt(5) lgkmcnt(0)
    v_mfma_f32_16x16x32_bf16 v[224:227], a[88:91], a[64:67], v[224:227]
    s_barrier
    v_mfma_f32_16x16x32_bf16 v[224:227], a[152:155], a[80:83], v[224:227]
    ds_read_b128 a[64:67], v6 offset:0
    v_mfma_f32_16x16x32_bf16 v[224:227], a[168:171], a[84:87], v[224:227]
    s_waitcnt vmcnt(0)
    ds_read2st64_b32 v[32:33], v9 offset0:48 offset1:49
    v_mfma_f32_16x16x32_bf16 v[224:227], a[184:187], a[248:251], v[224:227]
    v_cmp_gt_u32 vcc, 2, v21
    s_cbranch_vccnz L_slow_fx1
L_back_fx1:
    v_mfma_f32_16x16x32_bf16 v[224:227], a[200:203], a[252:255], v[224:227]
    buffer_load_dwordx4 v[208:211], v19, s[20:23], s41 offen offset:0 sc1
    v_mfma_f32_16x16x32_bf16 v[228:231], a[204:207], a[252:255], v[228:231]
    buffer_load_dwordx4 v[212:215], v19, s[20:23], s41 offen offset:1024 sc1
    v_mfma_f32_16x16x32_bf16 v[228:231], a[188:191], a[248:251], v[228:231]
    ds_read2st64_b32 v[34:35], v9 offset0:50 offset1:51
    v_mfma_f32_16x16x32_bf16 v[228:231], a[172:175], a[84:87], v[228:231]
    ds_read_b128 a[68:71], v6 offset:1024
    buffer_load_dwordx4 v[216:219], v19, s[20:23], s41 offen offset:2048 sc1
    v_mfma_f32_16x16x32_bf16 v[228:231], a[156:159], a[80:83], v[228:231]
    buffer_load_dwordx4 v[220:223], v19, s[20:23], s41 offen offset:3072 sc1
    ds_read2st64_b32 v[36:37], v9 offset0:52 offset1:53
    v_mfma_f32_16x16x32_bf16 v[232:235], a[160:163], a[80:83], v[232:235]
    ds_read_b128 a[72:75], v6 offset:2048
    ds_read2st64_b32 v[38:39], v9 offset0:54 offset1:55
    v_mfma_f32_16x16x32_bf16 v[232:235], a[176:179], a[84:87], v[232:235]
    ds_read_b128 a[76:79], v6 offset:3072
    v_mfma_f32_16x16x32_bf16 v[232:235], a[192:195], a[248:251], v[232:235]
    ds_read2st64_b32 v[40:41], v9 offset0:56 offset1:57
    v_mfma_f32_16x16x32_bf16 v[232:235], a[208:211], a[252:255], v[232:235]
    ds_read2st64_b32 v[42:43], v9 offset0:58 offset1:59
    v_mfma_f32_16x16x32_bf16 v[236:239], a[212:215], a[252:255], v[236:239]
    ds_read2st64_b32 v[44:45], v9 offset0:60 offset1:61
    v_mfma_f32_16x16x32_bf16 v[236:239], a[196:199], a[248:251], v[236:239]
    ds_read2st64_b32 v[46:47], v9 offset0:62 offset1:63
    v_mfma_f32_16x16x32_bf16 v[236:239], a[180:183], a[84:87], v[236:239]
    v_mfma_f32_16x16x32_bf16 v[236:239], a[164:167], a[80:83], v[236:239]
    s_waitcnt lgkmcnt(11)
    v_mfma_f32_16x16x32_bf16 v[252:255], v[92:95], a[64:67], v[252:255]
    s_waitcnt lgkmcnt(8)
    ds_read_b128 a[80:83], v6 offset:4096
    v_mfma_f32_16x16x32_bf16 v[252:255], v[108:111], a[68:71], v[252:255]
    s_waitcnt lgkmcnt(7)
    v_mfma_f32_16x16x32_bf16 v[252:255], v[76:79], a[72:75], v[252:255]
    s_waitcnt lgkmcnt(5)
    ds_read_b128 a[84:87], v6 offset:5120
    v_mfma_f32_16x16x32_bf16 v[252:255], v[156:159], a[76:79], v[252:255]
    v_mfma_f32_16x16x32_bf16 v[248:251], v[152:155], a[76:79], v[248:251]
    ds_read_b128 a[248:251], v6 offset:6144
    v_mfma_f32_16x16x32_bf16 v[248:251], v[72:75], a[72:75], v[248:251]
    v_add_f32 v224, v224, v48
    v_add_f32 v225, v225, v49
    v_mfma_f32_16x16x32_bf16 v[248:251], v[104:107], a[68:71], v[248:251]
    ds_read_b128 a[252:255], v6 offset:7168
    v_add_f32 v226, v226, v50
    v_add_f32 v227, v227, v51
    v_mfma_f32_16x16x32_bf16 v[248:251], v[88:91], a[64:67], v[248:251]
    v_add_f32 v224, v224, v192
    v_add_f32 v225, v225, v193
    v_mfma_f32_16x16x32_bf16 v[244:247], v[84:87], a[64:67], v[244:247]
    v_add_f32 v226, v226, v194
    v_add_f32 v227, v227, v195
    v_mfma_f32_16x16x32_bf16 v[244:247], v[100:103], a[68:71], v[244:247]
    v_cvt_pk_bf16_f32 v224, v224, v225
    v_cvt_pk_bf16_f32 v225, v226, v227
    v_mfma_f32_16x16x32_bf16 v[244:247], v[68:71], a[72:75], v[244:247]
    ds_write_b64 v22, v[224:225] offset:0
    v_add_f32 v228, v228, v52
    v_add_f32 v229, v229, v53
    v_mfma_f32_16x16x32_bf16 v[244:247], v[148:151], a[76:79], v[244:247]
    v_add_f32 v230, v230, v54
    v_add_f32 v231, v231, v55
    v_mfma_f32_16x16x32_bf16 v[240:243], v[144:147], a[76:79], v[240:243]
    v_add_f32 v228, v228, v196
    v_add_f32 v229, v229, v197
    v_mfma_f32_16x16x32_bf16 v[240:243], v[64:67], a[72:75], v[240:243]
    v_add_f32 v230, v230, v198
    v_add_f32 v231, v231, v199
    v_mfma_f32_16x16x32_bf16 v[240:243], v[96:99], a[68:71], v[240:243]
    v_cvt_pk_bf16_f32 v228, v228, v229
    v_cvt_pk_bf16_f32 v229, v230, v231
    v_mfma_f32_16x16x32_bf16 v[240:243], v[80:83], a[64:67], v[240:243]
    s_waitcnt lgkmcnt(4)
    ds_write_b64 v23, v[228:229] offset:0
    v_add_f32 v232, v232, v56
    v_add_f32 v233, v233, v57
    v_mfma_f32_16x16x32_bf16 v[240:243], v[160:163], a[80:83], v[240:243]
    s_waitcnt lgkmcnt(4)
    ds_read_b128 a[64:67], v6 offset:8192
    v_add_f32 v234, v234, v58
    v_add_f32 v235, v235, v59
    v_mfma_f32_16x16x32_bf16 v[240:243], v[176:179], a[84:87], v[240:243]
    s_waitcnt lgkmcnt(4)
    v_add_f32 v232, v232, v200
    v_add_f32 v233, v233, v201
    v_mfma_f32_16x16x32_bf16 v[240:243], v[128:131], a[248:251], v[240:243]
    s_waitcnt lgkmcnt(3)
    ds_read_b128 a[68:71], v6 offset:9216
    v_add_f32 v234, v234, v202
    v_add_f32 v235, v235, v203
    v_mfma_f32_16x16x32_bf16 v[240:243], v[112:115], a[252:255], v[240:243]
    v_cvt_pk_bf16_f32 v232, v232, v233
    v_cvt_pk_bf16_f32 v233, v234, v235
    v_mfma_f32_16x16x32_bf16 v[244:247], v[116:119], a[252:255], v[244:247]
    ds_write_b64 v24, v[232:233] offset:0
    v_add_f32 v236, v236, v60
    v_add_f32 v237, v237, v61
    v_mfma_f32_16x16x32_bf16 v[244:247], v[132:135], a[248:251], v[244:247]
    ds_read_b128 a[72:75], v6 offset:10240
    v_add_f32 v238, v238, v62
    v_add_f32 v239, v239, v63
    v_mfma_f32_16x16x32_bf16 v[244:247], v[180:183], a[84:87], v[244:247]
    ds_read_b128 a[76:79], v6 offset:11264
    v_add_f32 v236, v236, v204
    v_add_f32 v237, v237, v205
    v_mfma_f32_16x16x32_bf16 v[244:247], v[164:167], a[80:83], v[244:247]
    v_add_f32 v238, v238, v206
    v_add_f32 v239, v239, v207
    v_mfma_f32_16x16x32_bf16 v[248:251], v[168:171], a[80:83], v[248:251]
    v_cvt_pk_bf16_f32 v236, v236, v237
    v_cvt_pk_bf16_f32 v237, v238, v239
    v_mfma_f32_16x16x32_bf16 v[248:251], v[184:187], a[84:87], v[248:251]
    ds_write_b64 v25, v[236:237] offset:0
    v_mfma_f32_16x16x32_bf16 v[248:251], v[136:139], a[248:251], v[248:251]
    v_mfma_f32_16x16x32_bf16 v[248:251], v[120:123], a[252:255], v[248:251]
    v_mfma_f32_16x16x32_bf16 v[252:255], v[124:127], a[252:255], v[252:255]
    s_waitcnt lgkmcnt(0)
    v_mfma_f32_16x16x32_bf16 v[252:255], v[140:143], a[248:251], v[252:255]
    ds_read_b128 v[48:51], v29 offset:0
    v_mfma_f32_16x16x32_bf16 v[252:255], v[188:191], a[84:87], v[252:255]
    ds_read_b128 v[52:55], v29 offset:1024
    v_mfma_f32_16x16x32_bf16 v[252:255], v[172:175], a[80:83], v[252:255]
    v_mfma_f32_16x16x32_bf16 v[252:255], a[100:103], a[64:67], v[252:255]
    ds_read_b128 a[80:83], v6 offset:12288
    v_mfma_f32_16x16x32_bf16 v[252:255], a[116:119], a[68:71], v[252:255]
    v_mfma_f32_16x16x32_bf16 v[252:255], a[132:135], a[72:75], v[252:255]
    ds_read_b128 a[84:87], v6 offset:13312
    v_mfma_f32_16x16x32_bf16 v[252:255], a[148:151], a[76:79], v[252:255]
    s_waitcnt lgkmcnt(3)
    v_mfma_f32_16x16x32_bf16 v[248:251], a[144:147], a[76:79], v[248:251]
    buffer_store_dwordx4 v[48:51], v31, s[28:31], 0 offen sc1
    v_mfma_f32_16x16x32_bf16 v[248:251], a[128:131], a[72:75], v[248:251]
    s_waitcnt lgkmcnt(2)
    ds_read_b128 a[248:251], v6 offset:14336
    v_mfma_f32_16x16x32_bf16 v[248:251], a[112:115], a[68:71], v[248:251]
    buffer_store_dwordx4 v[52:55], v31, s[28:31], s48 offen sc1
    v_mfma_f32_16x16x32_bf16 v[248:251], a[96:99], a[64:67], v[248:251]
    ds_read_b128 a[252:255], v6 offset:15360
    v_mfma_f32_16x16x32_bf16 v[244:247], a[92:95], a[64:67], v[244:247]
    v_mfma_f32_16x16x32_bf16 v[244:247], a[108:111], a[68:71], v[244:247]
    v_mfma_f32_16x16x32_bf16 v[244:247], a[124:127], a[72:75], v[244:247]
    v_mfma_f32_16x16x32_bf16 v[244:247], a[140:143], a[76:79], v[244:247]
    v_mfma_f32_16x16x32_bf16 v[240:243], a[136:139], a[76:79], v[240:243]
    v_mfma_f32_16x16x32_bf16 v[240:243], a[120:123], a[72:75], v[240:243]
    v_mfma_f32_16x16x32_bf16 v[240:243], a[104:107], a[68:71], v[240:243]
    s_waitcnt vmcnt(2)
    v_mfma_f32_16x16x32_bf16 v[240:243], a[88:91], a[64:67], v[240:243]
    s_waitcnt lgkmcnt(3)
    v_add_f32 v32, v32, v208
    v_add_f32 v33, v33, v209
    v_mfma_f32_16x16x32_bf16 v[240:243], a[152:155], a[80:83], v[240:243]
    s_waitcnt lgkmcnt(2)
    v_add_f32 v34, v34, v210
    v_add_f32 v35, v35, v211
    v_mfma_f32_16x16x32_bf16 v[240:243], a[168:171], a[84:87], v[240:243]
    s_waitcnt lgkmcnt(1)
    v_add_f32 v36, v36, v212
    v_add_f32 v37, v37, v213
    v_mfma_f32_16x16x32_bf16 v[240:243], a[184:187], a[248:251], v[240:243]
    s_waitcnt lgkmcnt(0)
    v_add_f32 v38, v38, v214
    v_add_f32 v39, v39, v215
    v_mfma_f32_16x16x32_bf16 v[240:243], a[200:203], a[252:255], v[240:243]
    v_add_f32 v40, v40, v216
    v_add_f32 v41, v41, v217
    v_mfma_f32_16x16x32_bf16 v[244:247], a[204:207], a[252:255], v[244:247]
    v_add_f32 v42, v42, v218
    v_add_f32 v43, v43, v219
    v_mfma_f32_16x16x32_bf16 v[244:247], a[188:191], a[248:251], v[244:247]
    v_add_f32 v44, v44, v220
    v_add_f32 v45, v45, v221
    v_mfma_f32_16x16x32_bf16 v[244:247], a[172:175], a[84:87], v[244:247]
    v_add_f32 v46, v46, v222
    v_add_f32 v47, v47, v223
    v_mfma_f32_16x16x32_bf16 v[244:247], a[156:159], a[80:83], v[244:247]
    v_mfma_f32_16x16x32_bf16 v[248:251], a[160:163], a[80:83], v[248:251]
    v_add_f32 v240, v240, v32
    v_add_f32 v241, v241, v33
    v_mfma_f32_16x16x32_bf16 v[248:251], a[176:179], a[84:87], v[248:251]
    v_add_f32 v242, v242, v34
    v_add_f32 v243, v243, v35
    v_mfma_f32_16x16x32_bf16 v[248:251], a[192:195], a[248:251], v[248:251]
    v_cvt_pk_bf16_f32 v240, v240, v241
    v_cvt_pk_bf16_f32 v241, v242, v243
    v_mfma_f32_16x16x32_bf16 v[248:251], a[208:211], a[252:255], v[248:251]
    ds_write_b64 v22, v[240:241] offset:4096
    v_mfma_f32_16x16x32_bf16 v[252:255], a[212:215], a[252:255], v[252:255]
    v_add_f32 v244, v244, v36
    v_add_f32 v245, v245, v37
    v_mfma_f32_16x16x32_bf16 v[252:255], a[196:199], a[248:251], v[252:255]
    v_add_f32 v246, v246, v38
    v_add_f32 v247, v247, v39
    v_mfma_f32_16x16x32_bf16 v[252:255], a[180:183], a[84:87], v[252:255]
    v_cvt_pk_bf16_f32 v244, v244, v245
    v_cvt_pk_bf16_f32 v245, v246, v247
    v_mfma_f32_16x16x32_bf16 v[252:255], a[164:167], a[80:83], v[252:255]
    ds_write_b64 v23, v[244:245] offset:4096
    s_nop 0
    v_pk_add_f32 v[248:249], v[248:249], v[40:41]
    v_pk_add_f32 v[250:251], v[250:251], v[42:43]
    v_cvt_pk_bf16_f32 v248, v248, v249
    v_cvt_pk_bf16_f32 v249, v250, v251
    ds_write_b64 v24, v[248:249] offset:4096
    s_nop 1
    v_pk_add_f32 v[252:253], v[252:253], v[44:45]
    v_pk_add_f32 v[254:255], v[254:255], v[46:47]
    v_cvt_pk_bf16_f32 v252, v252, v253
    v_cvt_pk_bf16_f32 v253, v254, v255
    ds_write_b64 v25, v[252:253] offset:4096
    s_waitcnt lgkmcnt(0)
    ds_read_b128 v[32:35], v29 offset:4096
    ds_read_b128 v[36:39], v29 offset:5120
    s_waitcnt lgkmcnt(1)
    buffer_store_dwordx4 v[32:35], v31, s[28:31], s69 offen sc1
    s_waitcnt lgkmcnt(0)
    buffer_store_dwordx4 v[36:39], v31, s[28:31], s49 offen sc1
    s_endpgm
L_end:
    s_endpgm
.section .rodata,"a"
.p2align 6
.amdhsa_kernel standalone__swiglu_ffn__prompt_kernel
  .amdhsa_next_free_vgpr 512
  .amdhsa_next_free_sgpr 102
  .amdhsa_accum_offset 256
  .amdhsa_group_segment_fixed_size 0
  .amdhsa_kernarg_size 56
  .amdhsa_user_sgpr_count 2
  .amdhsa_user_sgpr_kernarg_segment_ptr 1
  .amdhsa_system_sgpr_workgroup_id_x 1
  .amdhsa_float_denorm_mode_32 3
.end_amdhsa_kernel
```
